```python
import torch

def _softmax(x, axis=-1):
    return torch.softmax(x, dim=axis)

def _gelu(x):
    return torch.nn.functional.gelu(x, approximate='tanh')

def _silu(x):
    return torch.nn.functional.silu(x)

def _sigmoid(x):
    return torch.sigmoid(x)

def _layernorm(x, axis=-1, eps=1e-05):
    m = x.mean(dim=axis, keepdim=True)
    v = x.var(dim=axis, keepdim=True, unbiased=False)
    return (x - m) / torch.sqrt(v + eps)

def _scatter_add(tgt, idx, src, axis=0):
    return tgt.clone().index_add_(axis, idx, src)

def _segment_sum(src, seg, n):
    out = torch.zeros((n,) + src.shape[1:], dtype=src.dtype)
    return out.index_add_(0, seg, src)

def _pad(x, pw):
    flat = tuple((v for pair in reversed(pw) for v in pair))
    return torch.nn.functional.pad(x, flat)
kernel_name = 'adaLN_cond__sliding_local_dilated__glu_gated_geglu__prompt'

def setup_inputs():

    _w = lambda a: (lambda t: t.to(torch.bfloat16) if t.is_floating_point() else t)(torch.as_tensor(a))

    def _A_setup():
        B, S, D = (1, 2048, 512)
        return {'x': _w((lambda *s: torch.randn(*s, dtype=torch.bfloat16) * 0.05)(B, S, D)), 'wqkv': _w((lambda *s: torch.randn(*s, dtype=torch.bfloat16) * 0.05)(D, 3 * D)), 'wo': _w((lambda *s: torch.randn(*s, dtype=torch.bfloat16) * 0.05)(D, D))}
    _A_in = _A_setup()

    def _B_setup():
        B, S, Dm, Df = (1, 2048, 512, 1792)
        return {'x': _w((lambda *s: torch.randn(*s, dtype=torch.bfloat16) * 0.05)(B, S, Dm)), 'w_gate': _w((lambda *s: torch.randn(*s, dtype=torch.bfloat16) * 0.8)(Dm, Df) * Dm ** (-0.5)), 'w_up': _w((lambda *s: torch.randn(*s, dtype=torch.bfloat16) * 0.8)(Dm, Df) * Dm ** (-0.5)), 'w_down': _w((lambda *s: torch.randn(*s, dtype=torch.bfloat16) * 0.8)(Df, Dm) * Df ** (-0.5))}
    _B_in = _B_setup()
    return {'A_x': _A_in['x'], 'A_wqkv': _A_in['wqkv'], 'A_wo': _A_in['wo'], 'B_x': _B_in['x'], 'B_w_gate': _B_in['w_gate'], 'B_w_up': _B_in['w_up'], 'B_w_down': _B_in['w_down'], 'c': _w((lambda *s: torch.randn(*s, dtype=torch.bfloat16) * 0.2)(1, 512) * 8.0), 'w_mod': _w((lambda *s: torch.randn(*s, dtype=torch.bfloat16) * 0.2)(512, 6 * 512) * 512 ** (-0.5) * 8.0)}

def reference(A_x, A_wqkv, A_wo, B_x, B_w_gate, B_w_up, B_w_down, c, w_mod):

    def _A_ref(x, wqkv, wo):
        B, S, D = x.shape
        H = 32
        Dh = D // H
        W, dil = (8, 2)
        qkv = (lambda x, *d: x.permute(*d))((x @ wqkv).reshape(B, S, 3, H, Dh), 2, 0, 3, 1, 4)
        q, k, v = (qkv[0], qkv[1], qkv[2])
        scale = Dh ** (-0.5)
        pos = torch.arange(S)
        off = torch.arange(W) * dil
        idx = pos[:, None] - off[None, :]
        mask = idx >= 0
        idx_c = torch.where(mask, idx, 0).reshape(-1)
        kg = k[:, :, idx_c, :].reshape(B, H, S, W, Dh)
        vg = v[:, :, idx_c, :].reshape(B, H, S, W, Dh)
        logits = torch.einsum('bhsd,bhswd->bhsw', q, kg) * scale
        logits = torch.where(mask[None, None, :, :], logits, -1000000000.0)
        attn = _softmax(logits, axis=-1)
        o = torch.einsum('bhsw,bhswd->bhsd', attn, vg)
        return (lambda x, *d: x.permute(*d))(o, 0, 2, 1, 3).reshape(B, S, D) @ wo

    def _B_ref(x, w_gate, w_up, w_down):
        g = torch.einsum('bsd,df->bsf', x, w_gate)
        u = torch.einsum('bsd,df->bsf', x, w_up)
        h = _gelu(g) * u
        return torch.einsum('bsf,fd->bsd', h, w_down)
    x = A_x
    mod = (_silu(c) @ w_mod).reshape(c.shape[0], 6, 1, -1)
    sa, ca, ga, sb, cb, gb = (mod[:, 0].clone(), mod[:, 1].clone(), mod[:, 2].clone(), mod[:, 3].clone(), mod[:, 4].clone(), mod[:, 5].clone())
    h = _layernorm(x, axis=-1) * (1 + ca) + sa
    x = x + ga * _A_ref(h, A_wqkv, A_wo)
    h = _layernorm(x, axis=-1) * (1 + cb) + sb
    x = x + gb * _B_ref(h, B_w_gate, B_w_up, B_w_down)
    return x
```

```asm
; @launch kernel=k0_kernel grid=(160,1,1) block=(256,1,1) lds=16384
; @launch kernel=k1_kernel grid=(256,1,1) block=(256,1,1) lds=155648
; @launch kernel=k2_kernel grid=(284,1,1) block=(256,1,1) lds=65536
; @launch kernel=k3_kernel grid=(256,1,1) block=(256,1,1) lds=151552
; @launch kernel=k4_kernel grid=(256,1,1) block=(256,1,1) lds=131072
.amdgcn_target "amdgcn-amd-amdhsa--gfx950"
.text
.globl k0_kernel
.p2align 8
.type k0_kernel,@function
k0_kernel:

    s_load_dwordx2 s[4:5], s[0:1], 64
    s_load_dwordx2 s[6:7], s[0:1], 56
    s_load_dwordx2 s[8:9], s[0:1], 88
    s_load_dwordx2 s[10:11], s[0:1], 0
    s_cmp_ge_u32 s2, 160
    s_cbranch_scc1 K0_END
    s_cmp_ge_u32 s2, 96
    s_waitcnt lgkmcnt(0)
    s_cbranch_scc1 K0_STATS
    s_mov_b32 s12, s4
    s_mov_b32 s13, s5
    s_mov_b32 s14, 3145728
    s_mov_b32 s15, 0x00020000
    s_mov_b32 s16, s6
    s_mov_b32 s17, s7
    s_mov_b32 s18, 1024
    s_mov_b32 s19, 0x00020000
    s_mov_b32 s20, s8
    s_mov_b32 s21, s9
    s_mov_b32 s22, 16777216
    s_mov_b32 s23, 0x00020000
    v_and_b32 v1, 3, v0
    v_lshrrev_b32 v2, 2, v0
    v_mul_u32_u24 v3, 49152, v2
    v_lshl_add_u32 v3, v1, 4, v3
    v_lshlrev_b32 v4, 4, v2
    s_lshl_b32 s24, s2, 6
    buffer_load_dwordx4 v[8:11], v4, s[16:19], 0 offen
    s_add_u32 s25, s24, 0
    buffer_load_dwordx4 v[16:19], v3, s[12:15], s25 offen
    s_add_u32 s25, s24, 6144
    buffer_load_dwordx4 v[20:23], v3, s[12:15], s25 offen
    s_add_u32 s25, s24, 12288
    buffer_load_dwordx4 v[24:27], v3, s[12:15], s25 offen
    s_add_u32 s25, s24, 18432
    buffer_load_dwordx4 v[28:31], v3, s[12:15], s25 offen
    s_add_u32 s25, s24, 24576
    buffer_load_dwordx4 v[32:35], v3, s[12:15], s25 offen
    s_add_u32 s25, s24, 30720
    buffer_load_dwordx4 v[36:39], v3, s[12:15], s25 offen
    s_add_u32 s25, s24, 36864
    buffer_load_dwordx4 v[40:43], v3, s[12:15], s25 offen
    s_add_u32 s25, s24, 43008
    buffer_load_dwordx4 v[44:47], v3, s[12:15], s25 offen
    s_waitcnt vmcnt(8)
    v_lshlrev_b32 v48, 16, v8
    v_and_b32 v49, 0xffff0000, v8
    v_lshlrev_b32 v50, 16, v9
    v_and_b32 v51, 0xffff0000, v9
    v_lshlrev_b32 v52, 16, v10
    v_and_b32 v53, 0xffff0000, v10
    v_lshlrev_b32 v54, 16, v11
    v_and_b32 v55, 0xffff0000, v11
    v_mul_f32 v56, 0xbfb8aa3b, v48
    v_mul_f32 v57, 0xbfb8aa3b, v49
    v_mul_f32 v58, 0xbfb8aa3b, v50
    v_mul_f32 v59, 0xbfb8aa3b, v51
    v_mul_f32 v60, 0xbfb8aa3b, v52
    v_mul_f32 v61, 0xbfb8aa3b, v53
    v_mul_f32 v62, 0xbfb8aa3b, v54
    v_mul_f32 v63, 0xbfb8aa3b, v55
    v_exp_f32 v56, v56
    v_exp_f32 v57, v57
    v_exp_f32 v58, v58
    v_exp_f32 v59, v59
    v_exp_f32 v60, v60
    v_exp_f32 v61, v61
    v_exp_f32 v62, v62
    v_exp_f32 v63, v63
    v_add_f32 v56, 1.0, v56
    v_add_f32 v57, 1.0, v57
    v_add_f32 v58, 1.0, v58
    v_add_f32 v59, 1.0, v59
    v_add_f32 v60, 1.0, v60
    v_add_f32 v61, 1.0, v61
    v_add_f32 v62, 1.0, v62
    v_add_f32 v63, 1.0, v63
    v_rcp_f32 v56, v56
    v_rcp_f32 v57, v57
    v_rcp_f32 v58, v58
    v_rcp_f32 v59, v59
    v_rcp_f32 v60, v60
    v_rcp_f32 v61, v61
    v_rcp_f32 v62, v62
    v_rcp_f32 v63, v63
    s_nop 0
    v_mul_f32 v48, v48, v56
    v_mul_f32 v49, v49, v57
    v_mul_f32 v50, v50, v58
    v_mul_f32 v51, v51, v59
    v_mul_f32 v52, v52, v60
    v_mul_f32 v53, v53, v61
    v_mul_f32 v54, v54, v62
    v_mul_f32 v55, v55, v63
    v_mov_b32 v64, 0
    v_mov_b32 v65, 0
    v_mov_b32 v66, 0
    v_mov_b32 v67, 0
    v_mov_b32 v68, 0
    v_mov_b32 v69, 0
    v_mov_b32 v70, 0
    v_mov_b32 v71, 0
    s_waitcnt vmcnt(7)
    v_lshlrev_b32 v72, 16, v16
    v_and_b32 v73, 0xffff0000, v16
    v_fmac_f32 v64, v72, v48
    v_fmac_f32 v65, v73, v48
    v_lshlrev_b32 v72, 16, v17
    v_and_b32 v73, 0xffff0000, v17
    v_fmac_f32 v66, v72, v48
    v_fmac_f32 v67, v73, v48
    v_lshlrev_b32 v72, 16, v18
    v_and_b32 v73, 0xffff0000, v18
    v_fmac_f32 v68, v72, v48
    v_fmac_f32 v69, v73, v48
    v_lshlrev_b32 v72, 16, v19
    v_and_b32 v73, 0xffff0000, v19
    v_fmac_f32 v70, v72, v48
    v_fmac_f32 v71, v73, v48
    s_waitcnt vmcnt(6)
    v_lshlrev_b32 v72, 16, v20
    v_and_b32 v73, 0xffff0000, v20
    v_fmac_f32 v64, v72, v49
    v_fmac_f32 v65, v73, v49
    v_lshlrev_b32 v72, 16, v21
    v_and_b32 v73, 0xffff0000, v21
    v_fmac_f32 v66, v72, v49
    v_fmac_f32 v67, v73, v49
    v_lshlrev_b32 v72, 16, v22
    v_and_b32 v73, 0xffff0000, v22
    v_fmac_f32 v68, v72, v49
    v_fmac_f32 v69, v73, v49
    v_lshlrev_b32 v72, 16, v23
    v_and_b32 v73, 0xffff0000, v23
    v_fmac_f32 v70, v72, v49
    v_fmac_f32 v71, v73, v49
    s_waitcnt vmcnt(5)
    v_lshlrev_b32 v72, 16, v24
    v_and_b32 v73, 0xffff0000, v24
    v_fmac_f32 v64, v72, v50
    v_fmac_f32 v65, v73, v50
    v_lshlrev_b32 v72, 16, v25
    v_and_b32 v73, 0xffff0000, v25
    v_fmac_f32 v66, v72, v50
    v_fmac_f32 v67, v73, v50
    v_lshlrev_b32 v72, 16, v26
    v_and_b32 v73, 0xffff0000, v26
    v_fmac_f32 v68, v72, v50
    v_fmac_f32 v69, v73, v50
    v_lshlrev_b32 v72, 16, v27
    v_and_b32 v73, 0xffff0000, v27
    v_fmac_f32 v70, v72, v50
    v_fmac_f32 v71, v73, v50
    s_waitcnt vmcnt(4)
    v_lshlrev_b32 v72, 16, v28
    v_and_b32 v73, 0xffff0000, v28
    v_fmac_f32 v64, v72, v51
    v_fmac_f32 v65, v73, v51
    v_lshlrev_b32 v72, 16, v29
    v_and_b32 v73, 0xffff0000, v29
    v_fmac_f32 v66, v72, v51
    v_fmac_f32 v67, v73, v51
    v_lshlrev_b32 v72, 16, v30
    v_and_b32 v73, 0xffff0000, v30
    v_fmac_f32 v68, v72, v51
    v_fmac_f32 v69, v73, v51
    v_lshlrev_b32 v72, 16, v31
    v_and_b32 v73, 0xffff0000, v31
    v_fmac_f32 v70, v72, v51
    v_fmac_f32 v71, v73, v51
    s_waitcnt vmcnt(3)
    v_lshlrev_b32 v72, 16, v32
    v_and_b32 v73, 0xffff0000, v32
    v_fmac_f32 v64, v72, v52
    v_fmac_f32 v65, v73, v52
    v_lshlrev_b32 v72, 16, v33
    v_and_b32 v73, 0xffff0000, v33
    v_fmac_f32 v66, v72, v52
    v_fmac_f32 v67, v73, v52
    v_lshlrev_b32 v72, 16, v34
    v_and_b32 v73, 0xffff0000, v34
    v_fmac_f32 v68, v72, v52
    v_fmac_f32 v69, v73, v52
    v_lshlrev_b32 v72, 16, v35
    v_and_b32 v73, 0xffff0000, v35
    v_fmac_f32 v70, v72, v52
    v_fmac_f32 v71, v73, v52
    s_waitcnt vmcnt(2)
    v_lshlrev_b32 v72, 16, v36
    v_and_b32 v73, 0xffff0000, v36
    v_fmac_f32 v64, v72, v53
    v_fmac_f32 v65, v73, v53
    v_lshlrev_b32 v72, 16, v37
    v_and_b32 v73, 0xffff0000, v37
    v_fmac_f32 v66, v72, v53
    v_fmac_f32 v67, v73, v53
    v_lshlrev_b32 v72, 16, v38
    v_and_b32 v73, 0xffff0000, v38
    v_fmac_f32 v68, v72, v53
    v_fmac_f32 v69, v73, v53
    v_lshlrev_b32 v72, 16, v39
    v_and_b32 v73, 0xffff0000, v39
    v_fmac_f32 v70, v72, v53
    v_fmac_f32 v71, v73, v53
    s_waitcnt vmcnt(1)
    v_lshlrev_b32 v72, 16, v40
    v_and_b32 v73, 0xffff0000, v40
    v_fmac_f32 v64, v72, v54
    v_fmac_f32 v65, v73, v54
    v_lshlrev_b32 v72, 16, v41
    v_and_b32 v73, 0xffff0000, v41
    v_fmac_f32 v66, v72, v54
    v_fmac_f32 v67, v73, v54
    v_lshlrev_b32 v72, 16, v42
    v_and_b32 v73, 0xffff0000, v42
    v_fmac_f32 v68, v72, v54
    v_fmac_f32 v69, v73, v54
    v_lshlrev_b32 v72, 16, v43
    v_and_b32 v73, 0xffff0000, v43
    v_fmac_f32 v70, v72, v54
    v_fmac_f32 v71, v73, v54
    s_waitcnt vmcnt(0)
    v_lshlrev_b32 v72, 16, v44
    v_and_b32 v73, 0xffff0000, v44
    v_fmac_f32 v64, v72, v55
    v_fmac_f32 v65, v73, v55
    v_lshlrev_b32 v72, 16, v45
    v_and_b32 v73, 0xffff0000, v45
    v_fmac_f32 v66, v72, v55
    v_fmac_f32 v67, v73, v55
    v_lshlrev_b32 v72, 16, v46
    v_and_b32 v73, 0xffff0000, v46
    v_fmac_f32 v68, v72, v55
    v_fmac_f32 v69, v73, v55
    v_lshlrev_b32 v72, 16, v47
    v_and_b32 v73, 0xffff0000, v47
    v_fmac_f32 v70, v72, v55
    v_fmac_f32 v71, v73, v55
    v_lshlrev_b32 v5, 7, v2
    v_lshl_add_u32 v5, v1, 5, v5
    ds_write_b128 v5, v[64:67]
    ds_write_b128 v5, v[68:71] offset:16
    s_waitcnt lgkmcnt(0)
    s_barrier
    v_and_b32 v6, 31, v0
    v_lshrrev_b32 v7, 5, v0
    v_lshlrev_b32 v6, 2, v6
    v_lshl_add_u32 v6, v7, 10, v6
    ds_read_b32 v16, v6 offset:0
    ds_read_b32 v17, v6 offset:128
    ds_read_b32 v18, v6 offset:256
    ds_read_b32 v19, v6 offset:384
    ds_read_b32 v20, v6 offset:512
    ds_read_b32 v21, v6 offset:640
    ds_read_b32 v22, v6 offset:768
    ds_read_b32 v23, v6 offset:896
    s_waitcnt lgkmcnt(0)
    v_add_f32 v16, v16, v17
    v_add_f32 v16, v16, v18
    v_add_f32 v16, v16, v19
    v_add_f32 v16, v16, v20
    v_add_f32 v16, v16, v21
    v_add_f32 v16, v16, v22
    v_add_f32 v16, v16, v23
    v_lshlrev_b32 v6, 2, v0
    ds_write_b32 v6, v16 offset:8192
    s_waitcnt lgkmcnt(0)
    s_barrier
    v_cmp_gt_u32 vcc, 32, v0
    s_and_saveexec_b64 s[30:31], vcc
    s_cbranch_execz K0_END
    ds_read_b32 v16, v6 offset:8192
    ds_read_b32 v17, v6 offset:8320
    ds_read_b32 v18, v6 offset:8448
    ds_read_b32 v19, v6 offset:8576
    ds_read_b32 v20, v6 offset:8704
    ds_read_b32 v21, v6 offset:8832
    ds_read_b32 v22, v6 offset:8960
    ds_read_b32 v23, v6 offset:9088
    s_waitcnt lgkmcnt(0)
    v_add_f32 v16, v16, v17
    v_add_f32 v16, v16, v18
    v_add_f32 v16, v16, v19
    v_add_f32 v16, v16, v20
    v_add_f32 v16, v16, v21
    v_add_f32 v16, v16, v22
    v_add_f32 v16, v16, v23
    s_lshl_b32 s24, s2, 7
    buffer_store_dword v16, v6, s[20:23], s24 offen offset:0
    s_endpgm
K0_STATS:
    s_mov_b32 s12, s10
    s_mov_b32 s13, s11
    s_mov_b32 s14, 2097152
    s_mov_b32 s15, 0x00020000
    s_mov_b32 s20, s8
    s_mov_b32 s21, s9
    s_mov_b32 s22, 16777216
    s_mov_b32 s23, 0x00020000
    v_and_b32 v1, 63, v0
    v_lshrrev_b32 v2, 6, v0
    v_lshlrev_b32 v3, 4, v1
    v_lshl_add_u32 v3, v2, 13, v3
    s_sub_u32 s24, s2, 96
    s_lshl_b32 s24, s24, 15
    buffer_load_dwordx4 v[16:19], v3, s[12:15], s24 offen offset:0
    buffer_load_dwordx4 v[20:23], v3, s[12:15], s24 offen offset:1024
    buffer_load_dwordx4 v[24:27], v3, s[12:15], s24 offen offset:2048
    buffer_load_dwordx4 v[28:31], v3, s[12:15], s24 offen offset:3072
    s_add_u32 s26, s24, 4096
    buffer_load_dwordx4 v[32:35], v3, s[12:15], s26 offen offset:0
    buffer_load_dwordx4 v[36:39], v3, s[12:15], s26 offen offset:1024
    buffer_load_dwordx4 v[40:43], v3, s[12:15], s26 offen offset:2048
    buffer_load_dwordx4 v[44:47], v3, s[12:15], s26 offen offset:3072
    v_lshlrev_b32 v4, 6, v2
    s_lshr_b32 s25, s24, 7
    s_add_u32 s25, s25, 16384
    s_waitcnt vmcnt(7)
    v_lshlrev_b32 v48, 16, v16
    v_and_b32 v49, 0xffff0000, v16
    v_lshlrev_b32 v50, 16, v17
    v_and_b32 v51, 0xffff0000, v17
    v_lshlrev_b32 v52, 16, v18
    v_and_b32 v53, 0xffff0000, v18
    v_lshlrev_b32 v54, 16, v19
    v_and_b32 v55, 0xffff0000, v19
    v_add_f32 v56, v48, v49
    v_add_f32 v57, v50, v51
    v_add_f32 v58, v52, v53
    v_add_f32 v59, v54, v55
    v_add_f32 v56, v56, v57
    v_add_f32 v58, v58, v59
    v_add_f32 v56, v56, v58
    s_nop 1
    v_add_f32_dpp v56, v56, v56 quad_perm:[1,0,3,2] row_mask:0xf bank_mask:0xf
    s_nop 1
    v_add_f32_dpp v56, v56, v56 quad_perm:[2,3,0,1] row_mask:0xf bank_mask:0xf
    s_nop 1
    v_add_f32_dpp v56, v56, v56 row_half_mirror row_mask:0xf bank_mask:0xf
    s_nop 1
    v_add_f32_dpp v56, v56, v56 row_mirror row_mask:0xf bank_mask:0xf
    s_nop 1
    v_mov_b32 v57, v56
    s_nop 1
    v_permlane16_swap_b32 v57, v56
    s_nop 1
    v_add_f32 v56, v56, v57
    v_mov_b32 v57, v56
    s_nop 1
    v_permlane32_swap_b32 v57, v56
    s_nop 1
    v_add_f32 v56, v56, v57
    v_mul_f32 v56, 0x3b000000, v56
    v_sub_f32 v48, v48, v56
    v_sub_f32 v49, v49, v56
    v_sub_f32 v50, v50, v56
    v_sub_f32 v51, v51, v56
    v_sub_f32 v52, v52, v56
    v_sub_f32 v53, v53, v56
    v_sub_f32 v54, v54, v56
    v_sub_f32 v55, v55, v56
    v_mul_f32 v58, v48, v48
    v_fmac_f32 v58, v49, v49
    v_fmac_f32 v58, v50, v50
    v_fmac_f32 v58, v51, v51
    v_fmac_f32 v58, v52, v52
    v_fmac_f32 v58, v53, v53
    v_fmac_f32 v58, v54, v54
    v_fmac_f32 v58, v55, v55
    s_nop 1
    v_add_f32_dpp v58, v58, v58 quad_perm:[1,0,3,2] row_mask:0xf bank_mask:0xf
    s_nop 1
    v_add_f32_dpp v58, v58, v58 quad_perm:[2,3,0,1] row_mask:0xf bank_mask:0xf
    s_nop 1
    v_add_f32_dpp v58, v58, v58 row_half_mirror row_mask:0xf bank_mask:0xf
    s_nop 1
    v_add_f32_dpp v58, v58, v58 row_mirror row_mask:0xf bank_mask:0xf
    s_nop 1
    v_mov_b32 v57, v58
    s_nop 1
    v_permlane16_swap_b32 v57, v58
    s_nop 1
    v_add_f32 v58, v58, v57
    v_mov_b32 v57, v58
    s_nop 1
    v_permlane32_swap_b32 v57, v58
    s_nop 1
    v_add_f32 v58, v58, v57
    v_mov_b32 v59, 0x3727c5ac
    v_fmac_f32 v59, 0x3b000000, v58
    v_rsq_f32 v60, v59
    s_nop 0
    v_mul_f32 v61, v56, v60
    v_sub_f32 v61, 0, v61
    buffer_store_dwordx2 v[60:61], v4, s[20:23], s25 offen offset:0
    s_waitcnt vmcnt(6)
    v_lshlrev_b32 v48, 16, v20
    v_and_b32 v49, 0xffff0000, v20
    v_lshlrev_b32 v50, 16, v21
    v_and_b32 v51, 0xffff0000, v21
    v_lshlrev_b32 v52, 16, v22
    v_and_b32 v53, 0xffff0000, v22
    v_lshlrev_b32 v54, 16, v23
    v_and_b32 v55, 0xffff0000, v23
    v_add_f32 v56, v48, v49
    v_add_f32 v57, v50, v51
    v_add_f32 v58, v52, v53
    v_add_f32 v59, v54, v55
    v_add_f32 v56, v56, v57
    v_add_f32 v58, v58, v59
    v_add_f32 v56, v56, v58
    s_nop 1
    v_add_f32_dpp v56, v56, v56 quad_perm:[1,0,3,2] row_mask:0xf bank_mask:0xf
    s_nop 1
    v_add_f32_dpp v56, v56, v56 quad_perm:[2,3,0,1] row_mask:0xf bank_mask:0xf
    s_nop 1
    v_add_f32_dpp v56, v56, v56 row_half_mirror row_mask:0xf bank_mask:0xf
    s_nop 1
    v_add_f32_dpp v56, v56, v56 row_mirror row_mask:0xf bank_mask:0xf
    s_nop 1
    v_mov_b32 v57, v56
    s_nop 1
    v_permlane16_swap_b32 v57, v56
    s_nop 1
    v_add_f32 v56, v56, v57
    v_mov_b32 v57, v56
    s_nop 1
    v_permlane32_swap_b32 v57, v56
    s_nop 1
    v_add_f32 v56, v56, v57
    v_mul_f32 v56, 0x3b000000, v56
    v_sub_f32 v48, v48, v56
    v_sub_f32 v49, v49, v56
    v_sub_f32 v50, v50, v56
    v_sub_f32 v51, v51, v56
    v_sub_f32 v52, v52, v56
    v_sub_f32 v53, v53, v56
    v_sub_f32 v54, v54, v56
    v_sub_f32 v55, v55, v56
    v_mul_f32 v58, v48, v48
    v_fmac_f32 v58, v49, v49
    v_fmac_f32 v58, v50, v50
    v_fmac_f32 v58, v51, v51
    v_fmac_f32 v58, v52, v52
    v_fmac_f32 v58, v53, v53
    v_fmac_f32 v58, v54, v54
    v_fmac_f32 v58, v55, v55
    s_nop 1
    v_add_f32_dpp v58, v58, v58 quad_perm:[1,0,3,2] row_mask:0xf bank_mask:0xf
    s_nop 1
    v_add_f32_dpp v58, v58, v58 quad_perm:[2,3,0,1] row_mask:0xf bank_mask:0xf
    s_nop 1
    v_add_f32_dpp v58, v58, v58 row_half_mirror row_mask:0xf bank_mask:0xf
    s_nop 1
    v_add_f32_dpp v58, v58, v58 row_mirror row_mask:0xf bank_mask:0xf
    s_nop 1
    v_mov_b32 v57, v58
    s_nop 1
    v_permlane16_swap_b32 v57, v58
    s_nop 1
    v_add_f32 v58, v58, v57
    v_mov_b32 v57, v58
    s_nop 1
    v_permlane32_swap_b32 v57, v58
    s_nop 1
    v_add_f32 v58, v58, v57
    v_mov_b32 v59, 0x3727c5ac
    v_fmac_f32 v59, 0x3b000000, v58
    v_rsq_f32 v60, v59
    s_nop 0
    v_mul_f32 v61, v56, v60
    v_sub_f32 v61, 0, v61
    buffer_store_dwordx2 v[60:61], v4, s[20:23], s25 offen offset:8
    s_waitcnt vmcnt(5)
    v_lshlrev_b32 v48, 16, v24
    v_and_b32 v49, 0xffff0000, v24
    v_lshlrev_b32 v50, 16, v25
    v_and_b32 v51, 0xffff0000, v25
    v_lshlrev_b32 v52, 16, v26
    v_and_b32 v53, 0xffff0000, v26
    v_lshlrev_b32 v54, 16, v27
    v_and_b32 v55, 0xffff0000, v27
    v_add_f32 v56, v48, v49
    v_add_f32 v57, v50, v51
    v_add_f32 v58, v52, v53
    v_add_f32 v59, v54, v55
    v_add_f32 v56, v56, v57
    v_add_f32 v58, v58, v59
    v_add_f32 v56, v56, v58
    s_nop 1
    v_add_f32_dpp v56, v56, v56 quad_perm:[1,0,3,2] row_mask:0xf bank_mask:0xf
    s_nop 1
    v_add_f32_dpp v56, v56, v56 quad_perm:[2,3,0,1] row_mask:0xf bank_mask:0xf
    s_nop 1
    v_add_f32_dpp v56, v56, v56 row_half_mirror row_mask:0xf bank_mask:0xf
    s_nop 1
    v_add_f32_dpp v56, v56, v56 row_mirror row_mask:0xf bank_mask:0xf
    s_nop 1
    v_mov_b32 v57, v56
    s_nop 1
    v_permlane16_swap_b32 v57, v56
    s_nop 1
    v_add_f32 v56, v56, v57
    v_mov_b32 v57, v56
    s_nop 1
    v_permlane32_swap_b32 v57, v56
    s_nop 1
    v_add_f32 v56, v56, v57
    v_mul_f32 v56, 0x3b000000, v56
    v_sub_f32 v48, v48, v56
    v_sub_f32 v49, v49, v56
    v_sub_f32 v50, v50, v56
    v_sub_f32 v51, v51, v56
    v_sub_f32 v52, v52, v56
    v_sub_f32 v53, v53, v56
    v_sub_f32 v54, v54, v56
    v_sub_f32 v55, v55, v56
    v_mul_f32 v58, v48, v48
    v_fmac_f32 v58, v49, v49
    v_fmac_f32 v58, v50, v50
    v_fmac_f32 v58, v51, v51
    v_fmac_f32 v58, v52, v52
    v_fmac_f32 v58, v53, v53
    v_fmac_f32 v58, v54, v54
    v_fmac_f32 v58, v55, v55
    s_nop 1
    v_add_f32_dpp v58, v58, v58 quad_perm:[1,0,3,2] row_mask:0xf bank_mask:0xf
    s_nop 1
    v_add_f32_dpp v58, v58, v58 quad_perm:[2,3,0,1] row_mask:0xf bank_mask:0xf
    s_nop 1
    v_add_f32_dpp v58, v58, v58 row_half_mirror row_mask:0xf bank_mask:0xf
    s_nop 1
    v_add_f32_dpp v58, v58, v58 row_mirror row_mask:0xf bank_mask:0xf
    s_nop 1
    v_mov_b32 v57, v58
    s_nop 1
    v_permlane16_swap_b32 v57, v58
    s_nop 1
    v_add_f32 v58, v58, v57
    v_mov_b32 v57, v58
    s_nop 1
    v_permlane32_swap_b32 v57, v58
    s_nop 1
    v_add_f32 v58, v58, v57
    v_mov_b32 v59, 0x3727c5ac
    v_fmac_f32 v59, 0x3b000000, v58
    v_rsq_f32 v60, v59
    s_nop 0
    v_mul_f32 v61, v56, v60
    v_sub_f32 v61, 0, v61
    buffer_store_dwordx2 v[60:61], v4, s[20:23], s25 offen offset:16
    s_waitcnt vmcnt(4)
    v_lshlrev_b32 v48, 16, v28
    v_and_b32 v49, 0xffff0000, v28
    v_lshlrev_b32 v50, 16, v29
    v_and_b32 v51, 0xffff0000, v29
    v_lshlrev_b32 v52, 16, v30
    v_and_b32 v53, 0xffff0000, v30
    v_lshlrev_b32 v54, 16, v31
    v_and_b32 v55, 0xffff0000, v31
    v_add_f32 v56, v48, v49
    v_add_f32 v57, v50, v51
    v_add_f32 v58, v52, v53
    v_add_f32 v59, v54, v55
    v_add_f32 v56, v56, v57
    v_add_f32 v58, v58, v59
    v_add_f32 v56, v56, v58
    s_nop 1
    v_add_f32_dpp v56, v56, v56 quad_perm:[1,0,3,2] row_mask:0xf bank_mask:0xf
    s_nop 1
    v_add_f32_dpp v56, v56, v56 quad_perm:[2,3,0,1] row_mask:0xf bank_mask:0xf
    s_nop 1
    v_add_f32_dpp v56, v56, v56 row_half_mirror row_mask:0xf bank_mask:0xf
    s_nop 1
    v_add_f32_dpp v56, v56, v56 row_mirror row_mask:0xf bank_mask:0xf
    s_nop 1
    v_mov_b32 v57, v56
    s_nop 1
    v_permlane16_swap_b32 v57, v56
    s_nop 1
    v_add_f32 v56, v56, v57
    v_mov_b32 v57, v56
    s_nop 1
    v_permlane32_swap_b32 v57, v56
    s_nop 1
    v_add_f32 v56, v56, v57
    v_mul_f32 v56, 0x3b000000, v56
    v_sub_f32 v48, v48, v56
    v_sub_f32 v49, v49, v56
    v_sub_f32 v50, v50, v56
    v_sub_f32 v51, v51, v56
    v_sub_f32 v52, v52, v56
    v_sub_f32 v53, v53, v56
    v_sub_f32 v54, v54, v56
    v_sub_f32 v55, v55, v56
    v_mul_f32 v58, v48, v48
    v_fmac_f32 v58, v49, v49
    v_fmac_f32 v58, v50, v50
    v_fmac_f32 v58, v51, v51
    v_fmac_f32 v58, v52, v52
    v_fmac_f32 v58, v53, v53
    v_fmac_f32 v58, v54, v54
    v_fmac_f32 v58, v55, v55
    s_nop 1
    v_add_f32_dpp v58, v58, v58 quad_perm:[1,0,3,2] row_mask:0xf bank_mask:0xf
    s_nop 1
    v_add_f32_dpp v58, v58, v58 quad_perm:[2,3,0,1] row_mask:0xf bank_mask:0xf
    s_nop 1
    v_add_f32_dpp v58, v58, v58 row_half_mirror row_mask:0xf bank_mask:0xf
    s_nop 1
    v_add_f32_dpp v58, v58, v58 row_mirror row_mask:0xf bank_mask:0xf
    s_nop 1
    v_mov_b32 v57, v58
    s_nop 1
    v_permlane16_swap_b32 v57, v58
    s_nop 1
    v_add_f32 v58, v58, v57
    v_mov_b32 v57, v58
    s_nop 1
    v_permlane32_swap_b32 v57, v58
    s_nop 1
    v_add_f32 v58, v58, v57
    v_mov_b32 v59, 0x3727c5ac
    v_fmac_f32 v59, 0x3b000000, v58
    v_rsq_f32 v60, v59
    s_nop 0
    v_mul_f32 v61, v56, v60
    v_sub_f32 v61, 0, v61
    buffer_store_dwordx2 v[60:61], v4, s[20:23], s25 offen offset:24
    s_waitcnt vmcnt(3)
    v_lshlrev_b32 v48, 16, v32
    v_and_b32 v49, 0xffff0000, v32
    v_lshlrev_b32 v50, 16, v33
    v_and_b32 v51, 0xffff0000, v33
    v_lshlrev_b32 v52, 16, v34
    v_and_b32 v53, 0xffff0000, v34
    v_lshlrev_b32 v54, 16, v35
    v_and_b32 v55, 0xffff0000, v35
    v_add_f32 v56, v48, v49
    v_add_f32 v57, v50, v51
    v_add_f32 v58, v52, v53
    v_add_f32 v59, v54, v55
    v_add_f32 v56, v56, v57
    v_add_f32 v58, v58, v59
    v_add_f32 v56, v56, v58
    s_nop 1
    v_add_f32_dpp v56, v56, v56 quad_perm:[1,0,3,2] row_mask:0xf bank_mask:0xf
    s_nop 1
    v_add_f32_dpp v56, v56, v56 quad_perm:[2,3,0,1] row_mask:0xf bank_mask:0xf
    s_nop 1
    v_add_f32_dpp v56, v56, v56 row_half_mirror row_mask:0xf bank_mask:0xf
    s_nop 1
    v_add_f32_dpp v56, v56, v56 row_mirror row_mask:0xf bank_mask:0xf
    s_nop 1
    v_mov_b32 v57, v56
    s_nop 1
    v_permlane16_swap_b32 v57, v56
    s_nop 1
    v_add_f32 v56, v56, v57
    v_mov_b32 v57, v56
    s_nop 1
    v_permlane32_swap_b32 v57, v56
    s_nop 1
    v_add_f32 v56, v56, v57
    v_mul_f32 v56, 0x3b000000, v56
    v_sub_f32 v48, v48, v56
    v_sub_f32 v49, v49, v56
    v_sub_f32 v50, v50, v56
    v_sub_f32 v51, v51, v56
    v_sub_f32 v52, v52, v56
    v_sub_f32 v53, v53, v56
    v_sub_f32 v54, v54, v56
    v_sub_f32 v55, v55, v56
    v_mul_f32 v58, v48, v48
    v_fmac_f32 v58, v49, v49
    v_fmac_f32 v58, v50, v50
    v_fmac_f32 v58, v51, v51
    v_fmac_f32 v58, v52, v52
    v_fmac_f32 v58, v53, v53
    v_fmac_f32 v58, v54, v54
    v_fmac_f32 v58, v55, v55
    s_nop 1
    v_add_f32_dpp v58, v58, v58 quad_perm:[1,0,3,2] row_mask:0xf bank_mask:0xf
    s_nop 1
    v_add_f32_dpp v58, v58, v58 quad_perm:[2,3,0,1] row_mask:0xf bank_mask:0xf
    s_nop 1
    v_add_f32_dpp v58, v58, v58 row_half_mirror row_mask:0xf bank_mask:0xf
    s_nop 1
    v_add_f32_dpp v58, v58, v58 row_mirror row_mask:0xf bank_mask:0xf
    s_nop 1
    v_mov_b32 v57, v58
    s_nop 1
    v_permlane16_swap_b32 v57, v58
    s_nop 1
    v_add_f32 v58, v58, v57
    v_mov_b32 v57, v58
    s_nop 1
    v_permlane32_swap_b32 v57, v58
    s_nop 1
    v_add_f32 v58, v58, v57
    v_mov_b32 v59, 0x3727c5ac
    v_fmac_f32 v59, 0x3b000000, v58
    v_rsq_f32 v60, v59
    s_nop 0
    v_mul_f32 v61, v56, v60
    v_sub_f32 v61, 0, v61
    buffer_store_dwordx2 v[60:61], v4, s[20:23], s25 offen offset:32
    s_waitcnt vmcnt(2)
    v_lshlrev_b32 v48, 16, v36
    v_and_b32 v49, 0xffff0000, v36
    v_lshlrev_b32 v50, 16, v37
    v_and_b32 v51, 0xffff0000, v37
    v_lshlrev_b32 v52, 16, v38
    v_and_b32 v53, 0xffff0000, v38
    v_lshlrev_b32 v54, 16, v39
    v_and_b32 v55, 0xffff0000, v39
    v_add_f32 v56, v48, v49
    v_add_f32 v57, v50, v51
    v_add_f32 v58, v52, v53
    v_add_f32 v59, v54, v55
    v_add_f32 v56, v56, v57
    v_add_f32 v58, v58, v59
    v_add_f32 v56, v56, v58
    s_nop 1
    v_add_f32_dpp v56, v56, v56 quad_perm:[1,0,3,2] row_mask:0xf bank_mask:0xf
    s_nop 1
    v_add_f32_dpp v56, v56, v56 quad_perm:[2,3,0,1] row_mask:0xf bank_mask:0xf
    s_nop 1
    v_add_f32_dpp v56, v56, v56 row_half_mirror row_mask:0xf bank_mask:0xf
    s_nop 1
    v_add_f32_dpp v56, v56, v56 row_mirror row_mask:0xf bank_mask:0xf
    s_nop 1
    v_mov_b32 v57, v56
    s_nop 1
    v_permlane16_swap_b32 v57, v56
    s_nop 1
    v_add_f32 v56, v56, v57
    v_mov_b32 v57, v56
    s_nop 1
    v_permlane32_swap_b32 v57, v56
    s_nop 1
    v_add_f32 v56, v56, v57
    v_mul_f32 v56, 0x3b000000, v56
    v_sub_f32 v48, v48, v56
    v_sub_f32 v49, v49, v56
    v_sub_f32 v50, v50, v56
    v_sub_f32 v51, v51, v56
    v_sub_f32 v52, v52, v56
    v_sub_f32 v53, v53, v56
    v_sub_f32 v54, v54, v56
    v_sub_f32 v55, v55, v56
    v_mul_f32 v58, v48, v48
    v_fmac_f32 v58, v49, v49
    v_fmac_f32 v58, v50, v50
    v_fmac_f32 v58, v51, v51
    v_fmac_f32 v58, v52, v52
    v_fmac_f32 v58, v53, v53
    v_fmac_f32 v58, v54, v54
    v_fmac_f32 v58, v55, v55
    s_nop 1
    v_add_f32_dpp v58, v58, v58 quad_perm:[1,0,3,2] row_mask:0xf bank_mask:0xf
    s_nop 1
    v_add_f32_dpp v58, v58, v58 quad_perm:[2,3,0,1] row_mask:0xf bank_mask:0xf
    s_nop 1
    v_add_f32_dpp v58, v58, v58 row_half_mirror row_mask:0xf bank_mask:0xf
    s_nop 1
    v_add_f32_dpp v58, v58, v58 row_mirror row_mask:0xf bank_mask:0xf
    s_nop 1
    v_mov_b32 v57, v58
    s_nop 1
    v_permlane16_swap_b32 v57, v58
    s_nop 1
    v_add_f32 v58, v58, v57
    v_mov_b32 v57, v58
    s_nop 1
    v_permlane32_swap_b32 v57, v58
    s_nop 1
    v_add_f32 v58, v58, v57
    v_mov_b32 v59, 0x3727c5ac
    v_fmac_f32 v59, 0x3b000000, v58
    v_rsq_f32 v60, v59
    s_nop 0
    v_mul_f32 v61, v56, v60
    v_sub_f32 v61, 0, v61
    buffer_store_dwordx2 v[60:61], v4, s[20:23], s25 offen offset:40
    s_waitcnt vmcnt(1)
    v_lshlrev_b32 v48, 16, v40
    v_and_b32 v49, 0xffff0000, v40
    v_lshlrev_b32 v50, 16, v41
    v_and_b32 v51, 0xffff0000, v41
    v_lshlrev_b32 v52, 16, v42
    v_and_b32 v53, 0xffff0000, v42
    v_lshlrev_b32 v54, 16, v43
    v_and_b32 v55, 0xffff0000, v43
    v_add_f32 v56, v48, v49
    v_add_f32 v57, v50, v51
    v_add_f32 v58, v52, v53
    v_add_f32 v59, v54, v55
    v_add_f32 v56, v56, v57
    v_add_f32 v58, v58, v59
    v_add_f32 v56, v56, v58
    s_nop 1
    v_add_f32_dpp v56, v56, v56 quad_perm:[1,0,3,2] row_mask:0xf bank_mask:0xf
    s_nop 1
    v_add_f32_dpp v56, v56, v56 quad_perm:[2,3,0,1] row_mask:0xf bank_mask:0xf
    s_nop 1
    v_add_f32_dpp v56, v56, v56 row_half_mirror row_mask:0xf bank_mask:0xf
    s_nop 1
    v_add_f32_dpp v56, v56, v56 row_mirror row_mask:0xf bank_mask:0xf
    s_nop 1
    v_mov_b32 v57, v56
    s_nop 1
    v_permlane16_swap_b32 v57, v56
    s_nop 1
    v_add_f32 v56, v56, v57
    v_mov_b32 v57, v56
    s_nop 1
    v_permlane32_swap_b32 v57, v56
    s_nop 1
    v_add_f32 v56, v56, v57
    v_mul_f32 v56, 0x3b000000, v56
    v_sub_f32 v48, v48, v56
    v_sub_f32 v49, v49, v56
    v_sub_f32 v50, v50, v56
    v_sub_f32 v51, v51, v56
    v_sub_f32 v52, v52, v56
    v_sub_f32 v53, v53, v56
    v_sub_f32 v54, v54, v56
    v_sub_f32 v55, v55, v56
    v_mul_f32 v58, v48, v48
    v_fmac_f32 v58, v49, v49
    v_fmac_f32 v58, v50, v50
    v_fmac_f32 v58, v51, v51
    v_fmac_f32 v58, v52, v52
    v_fmac_f32 v58, v53, v53
    v_fmac_f32 v58, v54, v54
    v_fmac_f32 v58, v55, v55
    s_nop 1
    v_add_f32_dpp v58, v58, v58 quad_perm:[1,0,3,2] row_mask:0xf bank_mask:0xf
    s_nop 1
    v_add_f32_dpp v58, v58, v58 quad_perm:[2,3,0,1] row_mask:0xf bank_mask:0xf
    s_nop 1
    v_add_f32_dpp v58, v58, v58 row_half_mirror row_mask:0xf bank_mask:0xf
    s_nop 1
    v_add_f32_dpp v58, v58, v58 row_mirror row_mask:0xf bank_mask:0xf
    s_nop 1
    v_mov_b32 v57, v58
    s_nop 1
    v_permlane16_swap_b32 v57, v58
    s_nop 1
    v_add_f32 v58, v58, v57
    v_mov_b32 v57, v58
    s_nop 1
    v_permlane32_swap_b32 v57, v58
    s_nop 1
    v_add_f32 v58, v58, v57
    v_mov_b32 v59, 0x3727c5ac
    v_fmac_f32 v59, 0x3b000000, v58
    v_rsq_f32 v60, v59
    s_nop 0
    v_mul_f32 v61, v56, v60
    v_sub_f32 v61, 0, v61
    buffer_store_dwordx2 v[60:61], v4, s[20:23], s25 offen offset:48
    s_waitcnt vmcnt(0)
    v_lshlrev_b32 v48, 16, v44
    v_and_b32 v49, 0xffff0000, v44
    v_lshlrev_b32 v50, 16, v45
    v_and_b32 v51, 0xffff0000, v45
    v_lshlrev_b32 v52, 16, v46
    v_and_b32 v53, 0xffff0000, v46
    v_lshlrev_b32 v54, 16, v47
    v_and_b32 v55, 0xffff0000, v47
    v_add_f32 v56, v48, v49
    v_add_f32 v57, v50, v51
    v_add_f32 v58, v52, v53
    v_add_f32 v59, v54, v55
    v_add_f32 v56, v56, v57
    v_add_f32 v58, v58, v59
    v_add_f32 v56, v56, v58
    s_nop 1
    v_add_f32_dpp v56, v56, v56 quad_perm:[1,0,3,2] row_mask:0xf bank_mask:0xf
    s_nop 1
    v_add_f32_dpp v56, v56, v56 quad_perm:[2,3,0,1] row_mask:0xf bank_mask:0xf
    s_nop 1
    v_add_f32_dpp v56, v56, v56 row_half_mirror row_mask:0xf bank_mask:0xf
    s_nop 1
    v_add_f32_dpp v56, v56, v56 row_mirror row_mask:0xf bank_mask:0xf
    s_nop 1
    v_mov_b32 v57, v56
    s_nop 1
    v_permlane16_swap_b32 v57, v56
    s_nop 1
    v_add_f32 v56, v56, v57
    v_mov_b32 v57, v56
    s_nop 1
    v_permlane32_swap_b32 v57, v56
    s_nop 1
    v_add_f32 v56, v56, v57
    v_mul_f32 v56, 0x3b000000, v56
    v_sub_f32 v48, v48, v56
    v_sub_f32 v49, v49, v56
    v_sub_f32 v50, v50, v56
    v_sub_f32 v51, v51, v56
    v_sub_f32 v52, v52, v56
    v_sub_f32 v53, v53, v56
    v_sub_f32 v54, v54, v56
    v_sub_f32 v55, v55, v56
    v_mul_f32 v58, v48, v48
    v_fmac_f32 v58, v49, v49
    v_fmac_f32 v58, v50, v50
    v_fmac_f32 v58, v51, v51
    v_fmac_f32 v58, v52, v52
    v_fmac_f32 v58, v53, v53
    v_fmac_f32 v58, v54, v54
    v_fmac_f32 v58, v55, v55
    s_nop 1
    v_add_f32_dpp v58, v58, v58 quad_perm:[1,0,3,2] row_mask:0xf bank_mask:0xf
    s_nop 1
    v_add_f32_dpp v58, v58, v58 quad_perm:[2,3,0,1] row_mask:0xf bank_mask:0xf
    s_nop 1
    v_add_f32_dpp v58, v58, v58 row_half_mirror row_mask:0xf bank_mask:0xf
    s_nop 1
    v_add_f32_dpp v58, v58, v58 row_mirror row_mask:0xf bank_mask:0xf
    s_nop 1
    v_mov_b32 v57, v58
    s_nop 1
    v_permlane16_swap_b32 v57, v58
    s_nop 1
    v_add_f32 v58, v58, v57
    v_mov_b32 v57, v58
    s_nop 1
    v_permlane32_swap_b32 v57, v58
    s_nop 1
    v_add_f32 v58, v58, v57
    v_mov_b32 v59, 0x3727c5ac
    v_fmac_f32 v59, 0x3b000000, v58
    v_rsq_f32 v60, v59
    s_nop 0
    v_mul_f32 v61, v56, v60
    v_sub_f32 v61, 0, v61
    buffer_store_dwordx2 v[60:61], v4, s[20:23], s25 offen offset:56
K0_END:
    s_endpgm

.globl k1_kernel
.p2align 8
.type k1_kernel,@function
k1_kernel:

    s_load_dwordx2 s[4:5], s[0:1], 0
    s_load_dwordx2 s[6:7], s[0:1], 8
    s_load_dwordx2 s[8:9], s[0:1], 88
    s_cmp_ge_u32 s2, 256
    s_cbranch_scc1 K1_END
    s_and_b32 s27, s2, 7
    s_lshr_b32 s28, s2, 3
    s_lshr_b32 s24, s27, 1
    s_lshl_b32 s24, s24, 3
    s_and_b32 s29, s28, 7
    s_add_u32 s24, s24, s29
    s_and_b32 s25, s27, 1
    s_lshl_b32 s25, s25, 2
    s_lshr_b32 s29, s28, 3
    s_add_u32 s25, s25, s29
    v_and_b32 v1, 63, v0
    v_lshrrev_b32 v2, 6, v0
    s_nop 0
    v_readfirstlane_b32 s26, v2
    s_waitcnt lgkmcnt(0)
    s_mov_b32 s12, s4
    s_mov_b32 s13, s5
    s_mov_b32 s14, 2097152
    s_mov_b32 s15, 0x00020000
    s_mov_b32 s16, s6
    s_mov_b32 s17, s7
    s_mov_b32 s18, 1572864
    s_mov_b32 s19, 0x00020000
    s_mov_b32 s20, s8
    s_mov_b32 s21, s9
    s_mov_b32 s22, 16777216
    s_mov_b32 s23, 0x00020000
    s_lshl_b32 s27, s24, 6
    s_mul_i32 s28, s26, 20
    s_add_i32 s27, s27, s28
    s_sub_i32 s27, s27, 16
    s_lshl_b32 s28, s27, 10
    v_lshlrev_b32 v3, 4, v1
    buffer_load_dwordx4 v[100:103], v3, s[12:15], s28 offen offset:0
    buffer_load_dwordx4 v[104:107], v3, s[12:15], s28 offen offset:1024
    buffer_load_dwordx4 v[108:111], v3, s[12:15], s28 offen offset:2048
    buffer_load_dwordx4 v[112:115], v3, s[12:15], s28 offen offset:3072
    s_add_u32 s28, s28, 4096
    buffer_load_dwordx4 v[116:119], v3, s[12:15], s28 offen offset:0
    buffer_load_dwordx4 v[120:123], v3, s[12:15], s28 offen offset:1024
    buffer_load_dwordx4 v[124:127], v3, s[12:15], s28 offen offset:2048
    buffer_load_dwordx4 v[128:131], v3, s[12:15], s28 offen offset:3072
    s_add_u32 s28, s28, 4096
    buffer_load_dwordx4 v[132:135], v3, s[12:15], s28 offen offset:0
    buffer_load_dwordx4 v[136:139], v3, s[12:15], s28 offen offset:1024
    buffer_load_dwordx4 v[140:143], v3, s[12:15], s28 offen offset:2048
    buffer_load_dwordx4 v[144:147], v3, s[12:15], s28 offen offset:3072
    s_add_u32 s28, s28, 4096
    buffer_load_dwordx4 v[148:151], v3, s[12:15], s28 offen offset:0
    buffer_load_dwordx4 v[152:155], v3, s[12:15], s28 offen offset:1024
    buffer_load_dwordx4 v[156:159], v3, s[12:15], s28 offen offset:2048
    buffer_load_dwordx4 v[160:163], v3, s[12:15], s28 offen offset:3072
    s_add_u32 s28, s28, 4096
    buffer_load_dwordx4 v[164:167], v3, s[12:15], s28 offen offset:0
    buffer_load_dwordx4 v[168:171], v3, s[12:15], s28 offen offset:1024
    buffer_load_dwordx4 v[172:175], v3, s[12:15], s28 offen offset:2048
    buffer_load_dwordx4 v[176:179], v3, s[12:15], s28 offen offset:3072
    s_lshl_b32 s29, s27, 3
    s_ashr_i32 s31, s29, 31
    s_add_u32 s30, s8, s29
    s_addc_u32 s31, s9, s31
    s_load_dwordx16 s[40:55], s[30:31], 16384
    s_load_dwordx16 s[56:71], s[30:31], 16448
    s_load_dwordx8 s[72:79], s[30:31], 16512
    v_lshlrev_b32 v4, 5, v1
    buffer_load_dwordx4 v[22:25], v4, s[20:23], 0 offen offset:0
    buffer_load_dwordx4 v[26:29], v4, s[20:23], 0 offen offset:16
    buffer_load_dwordx4 v[14:17], v4, s[20:23], 0 offen offset:2048
    buffer_load_dwordx4 v[18:21], v4, s[20:23], 0 offen offset:2064
    v_lshrrev_b32 v5, 3, v1
    v_mul_u32_u24 v5, 3072, v5
    v_and_b32 v6, 7, v1
    v_lshrrev_b32 v7, 4, v1
    v_and_b32 v7, 1, v7
    v_lshlrev_b32 v8, 1, v7
    v_xor_b32 v9, v6, v8
    v_lshl_add_u32 v11, v9, 4, v5
    v_or_b32 v8, 4, v8
    v_xor_b32 v9, v6, v8
    v_lshl_add_u32 v12, v9, 4, v5
    s_mul_i32 s32, s26, 49152
    s_lshl_b32 s33, s25, 7
    s_add_u32 s32, s32, s33
    s_lshl_b32 s33, s26, 11
    s_add_u32 s34, s33, 81920
    s_mov_b32 m0, s34
    s_add_u32 s35, s32, 0
    buffer_load_dwordx4 v11, s[16:19], s35 offen lds
    s_add_u32 s34, s33, 82944
    s_mov_b32 m0, s34
    s_add_u32 s35, s32, 24576
    buffer_load_dwordx4 v12, s[16:19], s35 offen lds
    s_add_u32 s34, s33, 90112
    s_mov_b32 m0, s34
    s_add_u32 s35, s32, 1024
    buffer_load_dwordx4 v11, s[16:19], s35 offen lds
    s_add_u32 s34, s33, 91136
    s_mov_b32 m0, s34
    s_add_u32 s35, s32, 25600
    buffer_load_dwordx4 v12, s[16:19], s35 offen lds
    s_add_u32 s34, s33, 98304
    s_mov_b32 m0, s34
    s_add_u32 s35, s32, 2048
    buffer_load_dwordx4 v11, s[16:19], s35 offen lds
    s_add_u32 s34, s33, 99328
    s_mov_b32 m0, s34
    s_add_u32 s35, s32, 26624
    buffer_load_dwordx4 v12, s[16:19], s35 offen lds
    s_add_u32 s34, s33, 106496
    s_mov_b32 m0, s34
    s_add_u32 s35, s32, 196608
    buffer_load_dwordx4 v11, s[16:19], s35 offen lds
    s_add_u32 s34, s33, 107520
    s_mov_b32 m0, s34
    s_add_u32 s35, s32, 221184
    buffer_load_dwordx4 v12, s[16:19], s35 offen lds
    s_add_u32 s34, s33, 114688
    s_mov_b32 m0, s34
    s_add_u32 s35, s32, 197632
    buffer_load_dwordx4 v11, s[16:19], s35 offen lds
    s_add_u32 s34, s33, 115712
    s_mov_b32 m0, s34
    s_add_u32 s35, s32, 222208
    buffer_load_dwordx4 v12, s[16:19], s35 offen lds
    s_add_u32 s34, s33, 122880
    s_mov_b32 m0, s34
    s_add_u32 s35, s32, 198656
    buffer_load_dwordx4 v11, s[16:19], s35 offen lds
    s_add_u32 s34, s33, 123904
    s_mov_b32 m0, s34
    s_add_u32 s35, s32, 223232
    buffer_load_dwordx4 v12, s[16:19], s35 offen lds
    s_add_u32 s34, s33, 131072
    s_mov_b32 m0, s34
    s_add_u32 s35, s32, 393216
    buffer_load_dwordx4 v11, s[16:19], s35 offen lds
    s_add_u32 s34, s33, 132096
    s_mov_b32 m0, s34
    s_add_u32 s35, s32, 417792
    buffer_load_dwordx4 v12, s[16:19], s35 offen lds
    s_add_u32 s34, s33, 139264
    s_mov_b32 m0, s34
    s_add_u32 s35, s32, 394240
    buffer_load_dwordx4 v11, s[16:19], s35 offen lds
    s_add_u32 s34, s33, 140288
    s_mov_b32 m0, s34
    s_add_u32 s35, s32, 418816
    buffer_load_dwordx4 v12, s[16:19], s35 offen lds
    s_add_u32 s34, s33, 147456
    s_mov_b32 m0, s34
    s_add_u32 s35, s32, 395264
    buffer_load_dwordx4 v11, s[16:19], s35 offen lds
    s_add_u32 s34, s33, 148480
    s_mov_b32 m0, s34
    s_add_u32 s35, s32, 419840
    buffer_load_dwordx4 v12, s[16:19], s35 offen lds
    v_and_b32 v5, 15, v1
    v_lshrrev_b32 v6, 4, v1
    v_add_u32 v7, 0, v6
    v_xor_b32 v7, v7, v5
    v_lshlrev_b32 v7, 4, v7
    v_lshl_add_u32 v30, v5, 10, v7
    v_add_u32 v34, 0x10000, v30
    v_add_u32 v7, 4, v6
    v_xor_b32 v7, v7, v5
    v_lshlrev_b32 v7, 4, v7
    v_lshl_add_u32 v31, v5, 10, v7
    v_add_u32 v35, 0x10000, v31
    v_add_u32 v7, 8, v6
    v_xor_b32 v7, v7, v5
    v_lshlrev_b32 v7, 4, v7
    v_lshl_add_u32 v32, v5, 10, v7
    v_add_u32 v36, 0x10000, v32
    v_add_u32 v7, 12, v6
    v_xor_b32 v7, v7, v5
    v_lshlrev_b32 v7, 4, v7
    v_lshl_add_u32 v33, v5, 10, v7
    v_add_u32 v37, 0x10000, v33
    v_lshrrev_b32 v7, 2, v5
    v_lshl_add_u32 v7, v6, 3, v7
    v_lshlrev_b32 v7, 7, v7
    v_lshrrev_b32 v8, 3, v1
    v_and_b32 v8, 3, v8
    v_xor_b32 v8, s26, v8
    v_lshl_add_u32 v7, v8, 5, v7
    v_and_b32 v8, 3, v1
    v_lshl_add_u32 v7, v8, 3, v7
    v_add_u32 v38, 81920, v7
    v_add_u32 v39, 49152, v38
    s_waitcnt vmcnt(18)
    v_add_f32 v14, 1.0, v14
    v_add_f32 v15, 1.0, v15
    v_add_f32 v16, 1.0, v16
    v_add_f32 v17, 1.0, v17
    v_add_f32 v18, 1.0, v18
    v_add_f32 v19, 1.0, v19
    v_add_f32 v20, 1.0, v20
    v_add_f32 v21, 1.0, v21
    s_waitcnt lgkmcnt(0)
    s_mul_i32 s28, s26, 20
    s_waitcnt vmcnt(41)
    v_lshlrev_b32 v44, 16, v100
    v_and_b32 v45, 0xffff0000, v100
    v_lshlrev_b32 v46, 16, v101
    v_and_b32 v47, 0xffff0000, v101
    v_lshlrev_b32 v48, 16, v102
    v_and_b32 v49, 0xffff0000, v102
    v_lshlrev_b32 v50, 16, v103
    v_and_b32 v51, 0xffff0000, v103
    v_mov_b32 v52, s41
    v_fma_f32 v44, v44, s40, v52
    v_fma_f32 v45, v45, s40, v52
    v_fma_f32 v46, v46, s40, v52
    v_fma_f32 v47, v47, s40, v52
    v_fma_f32 v48, v48, s40, v52
    v_fma_f32 v49, v49, s40, v52
    v_fma_f32 v50, v50, s40, v52
    v_fma_f32 v51, v51, s40, v52
    v_fma_f32 v44, v44, v14, v22
    v_fma_f32 v45, v45, v15, v23
    v_fma_f32 v46, v46, v16, v24
    v_fma_f32 v47, v47, v17, v25
    v_fma_f32 v48, v48, v18, v26
    v_fma_f32 v49, v49, v19, v27
    v_fma_f32 v50, v50, v20, v28
    v_fma_f32 v51, v51, v21, v29
    v_cvt_pk_bf16_f32 v56, v44, v45
    v_cvt_pk_bf16_f32 v57, v46, v47
    v_cvt_pk_bf16_f32 v58, v48, v49
    v_cvt_pk_bf16_f32 v59, v50, v51
    s_add_u32 s29, s28, 0
    s_and_b32 s30, s29, 15
    s_lshl_b32 s29, s29, 10
    v_xor_b32 v53, s30, v1
    v_lshlrev_b32 v53, 4, v53
    v_add_u32 v53, s29, v53
    ds_write_b128 v53, v[56:59]
    s_waitcnt vmcnt(40)
    v_lshlrev_b32 v44, 16, v104
    v_and_b32 v45, 0xffff0000, v104
    v_lshlrev_b32 v46, 16, v105
    v_and_b32 v47, 0xffff0000, v105
    v_lshlrev_b32 v48, 16, v106
    v_and_b32 v49, 0xffff0000, v106
    v_lshlrev_b32 v50, 16, v107
    v_and_b32 v51, 0xffff0000, v107
    v_mov_b32 v52, s43
    v_fma_f32 v44, v44, s42, v52
    v_fma_f32 v45, v45, s42, v52
    v_fma_f32 v46, v46, s42, v52
    v_fma_f32 v47, v47, s42, v52
    v_fma_f32 v48, v48, s42, v52
    v_fma_f32 v49, v49, s42, v52
    v_fma_f32 v50, v50, s42, v52
    v_fma_f32 v51, v51, s42, v52
    v_fma_f32 v44, v44, v14, v22
    v_fma_f32 v45, v45, v15, v23
    v_fma_f32 v46, v46, v16, v24
    v_fma_f32 v47, v47, v17, v25
    v_fma_f32 v48, v48, v18, v26
    v_fma_f32 v49, v49, v19, v27
    v_fma_f32 v50, v50, v20, v28
    v_fma_f32 v51, v51, v21, v29
    v_cvt_pk_bf16_f32 v56, v44, v45
    v_cvt_pk_bf16_f32 v57, v46, v47
    v_cvt_pk_bf16_f32 v58, v48, v49
    v_cvt_pk_bf16_f32 v59, v50, v51
    s_add_u32 s29, s28, 1
    s_and_b32 s30, s29, 15
    s_lshl_b32 s29, s29, 10
    v_xor_b32 v53, s30, v1
    v_lshlrev_b32 v53, 4, v53
    v_add_u32 v53, s29, v53
    ds_write_b128 v53, v[56:59]
    s_waitcnt vmcnt(39)
    v_lshlrev_b32 v44, 16, v108
    v_and_b32 v45, 0xffff0000, v108
    v_lshlrev_b32 v46, 16, v109
    v_and_b32 v47, 0xffff0000, v109
    v_lshlrev_b32 v48, 16, v110
    v_and_b32 v49, 0xffff0000, v110
    v_lshlrev_b32 v50, 16, v111
    v_and_b32 v51, 0xffff0000, v111
    v_mov_b32 v52, s45
    v_fma_f32 v44, v44, s44, v52
    v_fma_f32 v45, v45, s44, v52
    v_fma_f32 v46, v46, s44, v52
    v_fma_f32 v47, v47, s44, v52
    v_fma_f32 v48, v48, s44, v52
    v_fma_f32 v49, v49, s44, v52
    v_fma_f32 v50, v50, s44, v52
    v_fma_f32 v51, v51, s44, v52
    v_fma_f32 v44, v44, v14, v22
    v_fma_f32 v45, v45, v15, v23
    v_fma_f32 v46, v46, v16, v24
    v_fma_f32 v47, v47, v17, v25
    v_fma_f32 v48, v48, v18, v26
    v_fma_f32 v49, v49, v19, v27
    v_fma_f32 v50, v50, v20, v28
    v_fma_f32 v51, v51, v21, v29
    v_cvt_pk_bf16_f32 v56, v44, v45
    v_cvt_pk_bf16_f32 v57, v46, v47
    v_cvt_pk_bf16_f32 v58, v48, v49
    v_cvt_pk_bf16_f32 v59, v50, v51
    s_add_u32 s29, s28, 2
    s_and_b32 s30, s29, 15
    s_lshl_b32 s29, s29, 10
    v_xor_b32 v53, s30, v1
    v_lshlrev_b32 v53, 4, v53
    v_add_u32 v53, s29, v53
    ds_write_b128 v53, v[56:59]
    s_waitcnt vmcnt(38)
    v_lshlrev_b32 v44, 16, v112
    v_and_b32 v45, 0xffff0000, v112
    v_lshlrev_b32 v46, 16, v113
    v_and_b32 v47, 0xffff0000, v113
    v_lshlrev_b32 v48, 16, v114
    v_and_b32 v49, 0xffff0000, v114
    v_lshlrev_b32 v50, 16, v115
    v_and_b32 v51, 0xffff0000, v115
    v_mov_b32 v52, s47
    v_fma_f32 v44, v44, s46, v52
    v_fma_f32 v45, v45, s46, v52
    v_fma_f32 v46, v46, s46, v52
    v_fma_f32 v47, v47, s46, v52
    v_fma_f32 v48, v48, s46, v52
    v_fma_f32 v49, v49, s46, v52
    v_fma_f32 v50, v50, s46, v52
    v_fma_f32 v51, v51, s46, v52
    v_fma_f32 v44, v44, v14, v22
    v_fma_f32 v45, v45, v15, v23
    v_fma_f32 v46, v46, v16, v24
    v_fma_f32 v47, v47, v17, v25
    v_fma_f32 v48, v48, v18, v26
    v_fma_f32 v49, v49, v19, v27
    v_fma_f32 v50, v50, v20, v28
    v_fma_f32 v51, v51, v21, v29
    v_cvt_pk_bf16_f32 v56, v44, v45
    v_cvt_pk_bf16_f32 v57, v46, v47
    v_cvt_pk_bf16_f32 v58, v48, v49
    v_cvt_pk_bf16_f32 v59, v50, v51
    s_add_u32 s29, s28, 3
    s_and_b32 s30, s29, 15
    s_lshl_b32 s29, s29, 10
    v_xor_b32 v53, s30, v1
    v_lshlrev_b32 v53, 4, v53
    v_add_u32 v53, s29, v53
    ds_write_b128 v53, v[56:59]
    s_waitcnt vmcnt(37)
    v_lshlrev_b32 v44, 16, v116
    v_and_b32 v45, 0xffff0000, v116
    v_lshlrev_b32 v46, 16, v117
    v_and_b32 v47, 0xffff0000, v117
    v_lshlrev_b32 v48, 16, v118
    v_and_b32 v49, 0xffff0000, v118
    v_lshlrev_b32 v50, 16, v119
    v_and_b32 v51, 0xffff0000, v119
    v_mov_b32 v52, s49
    v_fma_f32 v44, v44, s48, v52
    v_fma_f32 v45, v45, s48, v52
    v_fma_f32 v46, v46, s48, v52
    v_fma_f32 v47, v47, s48, v52
    v_fma_f32 v48, v48, s48, v52
    v_fma_f32 v49, v49, s48, v52
    v_fma_f32 v50, v50, s48, v52
    v_fma_f32 v51, v51, s48, v52
    v_fma_f32 v44, v44, v14, v22
    v_fma_f32 v45, v45, v15, v23
    v_fma_f32 v46, v46, v16, v24
    v_fma_f32 v47, v47, v17, v25
    v_fma_f32 v48, v48, v18, v26
    v_fma_f32 v49, v49, v19, v27
    v_fma_f32 v50, v50, v20, v28
    v_fma_f32 v51, v51, v21, v29
    v_cvt_pk_bf16_f32 v56, v44, v45
    v_cvt_pk_bf16_f32 v57, v46, v47
    v_cvt_pk_bf16_f32 v58, v48, v49
    v_cvt_pk_bf16_f32 v59, v50, v51
    s_add_u32 s29, s28, 4
    s_and_b32 s30, s29, 15
    s_lshl_b32 s29, s29, 10
    v_xor_b32 v53, s30, v1
    v_lshlrev_b32 v53, 4, v53
    v_add_u32 v53, s29, v53
    ds_write_b128 v53, v[56:59]
    s_waitcnt vmcnt(36)
    v_lshlrev_b32 v44, 16, v120
    v_and_b32 v45, 0xffff0000, v120
    v_lshlrev_b32 v46, 16, v121
    v_and_b32 v47, 0xffff0000, v121
    v_lshlrev_b32 v48, 16, v122
    v_and_b32 v49, 0xffff0000, v122
    v_lshlrev_b32 v50, 16, v123
    v_and_b32 v51, 0xffff0000, v123
    v_mov_b32 v52, s51
    v_fma_f32 v44, v44, s50, v52
    v_fma_f32 v45, v45, s50, v52
    v_fma_f32 v46, v46, s50, v52
    v_fma_f32 v47, v47, s50, v52
    v_fma_f32 v48, v48, s50, v52
    v_fma_f32 v49, v49, s50, v52
    v_fma_f32 v50, v50, s50, v52
    v_fma_f32 v51, v51, s50, v52
    v_fma_f32 v44, v44, v14, v22
    v_fma_f32 v45, v45, v15, v23
    v_fma_f32 v46, v46, v16, v24
    v_fma_f32 v47, v47, v17, v25
    v_fma_f32 v48, v48, v18, v26
    v_fma_f32 v49, v49, v19, v27
    v_fma_f32 v50, v50, v20, v28
    v_fma_f32 v51, v51, v21, v29
    v_cvt_pk_bf16_f32 v56, v44, v45
    v_cvt_pk_bf16_f32 v57, v46, v47
    v_cvt_pk_bf16_f32 v58, v48, v49
    v_cvt_pk_bf16_f32 v59, v50, v51
    s_add_u32 s29, s28, 5
    s_and_b32 s30, s29, 15
    s_lshl_b32 s29, s29, 10
    v_xor_b32 v53, s30, v1
    v_lshlrev_b32 v53, 4, v53
    v_add_u32 v53, s29, v53
    ds_write_b128 v53, v[56:59]
    s_waitcnt vmcnt(35)
    v_lshlrev_b32 v44, 16, v124
    v_and_b32 v45, 0xffff0000, v124
    v_lshlrev_b32 v46, 16, v125
    v_and_b32 v47, 0xffff0000, v125
    v_lshlrev_b32 v48, 16, v126
    v_and_b32 v49, 0xffff0000, v126
    v_lshlrev_b32 v50, 16, v127
    v_and_b32 v51, 0xffff0000, v127
    v_mov_b32 v52, s53
    v_fma_f32 v44, v44, s52, v52
    v_fma_f32 v45, v45, s52, v52
    v_fma_f32 v46, v46, s52, v52
    v_fma_f32 v47, v47, s52, v52
    v_fma_f32 v48, v48, s52, v52
    v_fma_f32 v49, v49, s52, v52
    v_fma_f32 v50, v50, s52, v52
    v_fma_f32 v51, v51, s52, v52
    v_fma_f32 v44, v44, v14, v22
    v_fma_f32 v45, v45, v15, v23
    v_fma_f32 v46, v46, v16, v24
    v_fma_f32 v47, v47, v17, v25
    v_fma_f32 v48, v48, v18, v26
    v_fma_f32 v49, v49, v19, v27
    v_fma_f32 v50, v50, v20, v28
    v_fma_f32 v51, v51, v21, v29
    v_cvt_pk_bf16_f32 v56, v44, v45
    v_cvt_pk_bf16_f32 v57, v46, v47
    v_cvt_pk_bf16_f32 v58, v48, v49
    v_cvt_pk_bf16_f32 v59, v50, v51
    s_add_u32 s29, s28, 6
    s_and_b32 s30, s29, 15
    s_lshl_b32 s29, s29, 10
    v_xor_b32 v53, s30, v1
    v_lshlrev_b32 v53, 4, v53
    v_add_u32 v53, s29, v53
    ds_write_b128 v53, v[56:59]
    s_waitcnt vmcnt(34)
    v_lshlrev_b32 v44, 16, v128
    v_and_b32 v45, 0xffff0000, v128
    v_lshlrev_b32 v46, 16, v129
    v_and_b32 v47, 0xffff0000, v129
    v_lshlrev_b32 v48, 16, v130
    v_and_b32 v49, 0xffff0000, v130
    v_lshlrev_b32 v50, 16, v131
    v_and_b32 v51, 0xffff0000, v131
    v_mov_b32 v52, s55
    v_fma_f32 v44, v44, s54, v52
    v_fma_f32 v45, v45, s54, v52
    v_fma_f32 v46, v46, s54, v52
    v_fma_f32 v47, v47, s54, v52
    v_fma_f32 v48, v48, s54, v52
    v_fma_f32 v49, v49, s54, v52
    v_fma_f32 v50, v50, s54, v52
    v_fma_f32 v51, v51, s54, v52
    v_fma_f32 v44, v44, v14, v22
    v_fma_f32 v45, v45, v15, v23
    v_fma_f32 v46, v46, v16, v24
    v_fma_f32 v47, v47, v17, v25
    v_fma_f32 v48, v48, v18, v26
    v_fma_f32 v49, v49, v19, v27
    v_fma_f32 v50, v50, v20, v28
    v_fma_f32 v51, v51, v21, v29
    v_cvt_pk_bf16_f32 v56, v44, v45
    v_cvt_pk_bf16_f32 v57, v46, v47
    v_cvt_pk_bf16_f32 v58, v48, v49
    v_cvt_pk_bf16_f32 v59, v50, v51
    s_add_u32 s29, s28, 7
    s_and_b32 s30, s29, 15
    s_lshl_b32 s29, s29, 10
    v_xor_b32 v53, s30, v1
    v_lshlrev_b32 v53, 4, v53
    v_add_u32 v53, s29, v53
    ds_write_b128 v53, v[56:59]
    s_waitcnt vmcnt(33)
    v_lshlrev_b32 v44, 16, v132
    v_and_b32 v45, 0xffff0000, v132
    v_lshlrev_b32 v46, 16, v133
    v_and_b32 v47, 0xffff0000, v133
    v_lshlrev_b32 v48, 16, v134
    v_and_b32 v49, 0xffff0000, v134
    v_lshlrev_b32 v50, 16, v135
    v_and_b32 v51, 0xffff0000, v135
    v_mov_b32 v52, s57
    v_fma_f32 v44, v44, s56, v52
    v_fma_f32 v45, v45, s56, v52
    v_fma_f32 v46, v46, s56, v52
    v_fma_f32 v47, v47, s56, v52
    v_fma_f32 v48, v48, s56, v52
    v_fma_f32 v49, v49, s56, v52
    v_fma_f32 v50, v50, s56, v52
    v_fma_f32 v51, v51, s56, v52
    v_fma_f32 v44, v44, v14, v22
    v_fma_f32 v45, v45, v15, v23
    v_fma_f32 v46, v46, v16, v24
    v_fma_f32 v47, v47, v17, v25
    v_fma_f32 v48, v48, v18, v26
    v_fma_f32 v49, v49, v19, v27
    v_fma_f32 v50, v50, v20, v28
    v_fma_f32 v51, v51, v21, v29
    v_cvt_pk_bf16_f32 v56, v44, v45
    v_cvt_pk_bf16_f32 v57, v46, v47
    v_cvt_pk_bf16_f32 v58, v48, v49
    v_cvt_pk_bf16_f32 v59, v50, v51
    s_add_u32 s29, s28, 8
    s_and_b32 s30, s29, 15
    s_lshl_b32 s29, s29, 10
    v_xor_b32 v53, s30, v1
    v_lshlrev_b32 v53, 4, v53
    v_add_u32 v53, s29, v53
    ds_write_b128 v53, v[56:59]
    s_waitcnt vmcnt(32)
    v_lshlrev_b32 v44, 16, v136
    v_and_b32 v45, 0xffff0000, v136
    v_lshlrev_b32 v46, 16, v137
    v_and_b32 v47, 0xffff0000, v137
    v_lshlrev_b32 v48, 16, v138
    v_and_b32 v49, 0xffff0000, v138
    v_lshlrev_b32 v50, 16, v139
    v_and_b32 v51, 0xffff0000, v139
    v_mov_b32 v52, s59
    v_fma_f32 v44, v44, s58, v52
    v_fma_f32 v45, v45, s58, v52
    v_fma_f32 v46, v46, s58, v52
    v_fma_f32 v47, v47, s58, v52
    v_fma_f32 v48, v48, s58, v52
    v_fma_f32 v49, v49, s58, v52
    v_fma_f32 v50, v50, s58, v52
    v_fma_f32 v51, v51, s58, v52
    v_fma_f32 v44, v44, v14, v22
    v_fma_f32 v45, v45, v15, v23
    v_fma_f32 v46, v46, v16, v24
    v_fma_f32 v47, v47, v17, v25
    v_fma_f32 v48, v48, v18, v26
    v_fma_f32 v49, v49, v19, v27
    v_fma_f32 v50, v50, v20, v28
    v_fma_f32 v51, v51, v21, v29
    v_cvt_pk_bf16_f32 v56, v44, v45
    v_cvt_pk_bf16_f32 v57, v46, v47
    v_cvt_pk_bf16_f32 v58, v48, v49
    v_cvt_pk_bf16_f32 v59, v50, v51
    s_add_u32 s29, s28, 9
    s_and_b32 s30, s29, 15
    s_lshl_b32 s29, s29, 10
    v_xor_b32 v53, s30, v1
    v_lshlrev_b32 v53, 4, v53
    v_add_u32 v53, s29, v53
    ds_write_b128 v53, v[56:59]
    s_waitcnt vmcnt(31)
    v_lshlrev_b32 v44, 16, v140
    v_and_b32 v45, 0xffff0000, v140
    v_lshlrev_b32 v46, 16, v141
    v_and_b32 v47, 0xffff0000, v141
    v_lshlrev_b32 v48, 16, v142
    v_and_b32 v49, 0xffff0000, v142
    v_lshlrev_b32 v50, 16, v143
    v_and_b32 v51, 0xffff0000, v143
    v_mov_b32 v52, s61
    v_fma_f32 v44, v44, s60, v52
    v_fma_f32 v45, v45, s60, v52
    v_fma_f32 v46, v46, s60, v52
    v_fma_f32 v47, v47, s60, v52
    v_fma_f32 v48, v48, s60, v52
    v_fma_f32 v49, v49, s60, v52
    v_fma_f32 v50, v50, s60, v52
    v_fma_f32 v51, v51, s60, v52
    v_fma_f32 v44, v44, v14, v22
    v_fma_f32 v45, v45, v15, v23
    v_fma_f32 v46, v46, v16, v24
    v_fma_f32 v47, v47, v17, v25
    v_fma_f32 v48, v48, v18, v26
    v_fma_f32 v49, v49, v19, v27
    v_fma_f32 v50, v50, v20, v28
    v_fma_f32 v51, v51, v21, v29
    v_cvt_pk_bf16_f32 v56, v44, v45
    v_cvt_pk_bf16_f32 v57, v46, v47
    v_cvt_pk_bf16_f32 v58, v48, v49
    v_cvt_pk_bf16_f32 v59, v50, v51
    s_add_u32 s29, s28, 10
    s_and_b32 s30, s29, 15
    s_lshl_b32 s29, s29, 10
    v_xor_b32 v53, s30, v1
    v_lshlrev_b32 v53, 4, v53
    v_add_u32 v53, s29, v53
    ds_write_b128 v53, v[56:59]
    s_waitcnt vmcnt(30)
    v_lshlrev_b32 v44, 16, v144
    v_and_b32 v45, 0xffff0000, v144
    v_lshlrev_b32 v46, 16, v145
    v_and_b32 v47, 0xffff0000, v145
    v_lshlrev_b32 v48, 16, v146
    v_and_b32 v49, 0xffff0000, v146
    v_lshlrev_b32 v50, 16, v147
    v_and_b32 v51, 0xffff0000, v147
    v_mov_b32 v52, s63
    v_fma_f32 v44, v44, s62, v52
    v_fma_f32 v45, v45, s62, v52
    v_fma_f32 v46, v46, s62, v52
    v_fma_f32 v47, v47, s62, v52
    v_fma_f32 v48, v48, s62, v52
    v_fma_f32 v49, v49, s62, v52
    v_fma_f32 v50, v50, s62, v52
    v_fma_f32 v51, v51, s62, v52
    v_fma_f32 v44, v44, v14, v22
    v_fma_f32 v45, v45, v15, v23
    v_fma_f32 v46, v46, v16, v24
    v_fma_f32 v47, v47, v17, v25
    v_fma_f32 v48, v48, v18, v26
    v_fma_f32 v49, v49, v19, v27
    v_fma_f32 v50, v50, v20, v28
    v_fma_f32 v51, v51, v21, v29
    v_cvt_pk_bf16_f32 v56, v44, v45
    v_cvt_pk_bf16_f32 v57, v46, v47
    v_cvt_pk_bf16_f32 v58, v48, v49
    v_cvt_pk_bf16_f32 v59, v50, v51
    s_add_u32 s29, s28, 11
    s_and_b32 s30, s29, 15
    s_lshl_b32 s29, s29, 10
    v_xor_b32 v53, s30, v1
    v_lshlrev_b32 v53, 4, v53
    v_add_u32 v53, s29, v53
    ds_write_b128 v53, v[56:59]
    s_waitcnt vmcnt(29)
    v_lshlrev_b32 v44, 16, v148
    v_and_b32 v45, 0xffff0000, v148
    v_lshlrev_b32 v46, 16, v149
    v_and_b32 v47, 0xffff0000, v149
    v_lshlrev_b32 v48, 16, v150
    v_and_b32 v49, 0xffff0000, v150
    v_lshlrev_b32 v50, 16, v151
    v_and_b32 v51, 0xffff0000, v151
    v_mov_b32 v52, s65
    v_fma_f32 v44, v44, s64, v52
    v_fma_f32 v45, v45, s64, v52
    v_fma_f32 v46, v46, s64, v52
    v_fma_f32 v47, v47, s64, v52
    v_fma_f32 v48, v48, s64, v52
    v_fma_f32 v49, v49, s64, v52
    v_fma_f32 v50, v50, s64, v52
    v_fma_f32 v51, v51, s64, v52
    v_fma_f32 v44, v44, v14, v22
    v_fma_f32 v45, v45, v15, v23
    v_fma_f32 v46, v46, v16, v24
    v_fma_f32 v47, v47, v17, v25
    v_fma_f32 v48, v48, v18, v26
    v_fma_f32 v49, v49, v19, v27
    v_fma_f32 v50, v50, v20, v28
    v_fma_f32 v51, v51, v21, v29
    v_cvt_pk_bf16_f32 v56, v44, v45
    v_cvt_pk_bf16_f32 v57, v46, v47
    v_cvt_pk_bf16_f32 v58, v48, v49
    v_cvt_pk_bf16_f32 v59, v50, v51
    s_add_u32 s29, s28, 12
    s_and_b32 s30, s29, 15
    s_lshl_b32 s29, s29, 10
    v_xor_b32 v53, s30, v1
    v_lshlrev_b32 v53, 4, v53
    v_add_u32 v53, s29, v53
    ds_write_b128 v53, v[56:59]
    s_waitcnt vmcnt(28)
    v_lshlrev_b32 v44, 16, v152
    v_and_b32 v45, 0xffff0000, v152
    v_lshlrev_b32 v46, 16, v153
    v_and_b32 v47, 0xffff0000, v153
    v_lshlrev_b32 v48, 16, v154
    v_and_b32 v49, 0xffff0000, v154
    v_lshlrev_b32 v50, 16, v155
    v_and_b32 v51, 0xffff0000, v155
    v_mov_b32 v52, s67
    v_fma_f32 v44, v44, s66, v52
    v_fma_f32 v45, v45, s66, v52
    v_fma_f32 v46, v46, s66, v52
    v_fma_f32 v47, v47, s66, v52
    v_fma_f32 v48, v48, s66, v52
    v_fma_f32 v49, v49, s66, v52
    v_fma_f32 v50, v50, s66, v52
    v_fma_f32 v51, v51, s66, v52
    v_fma_f32 v44, v44, v14, v22
    v_fma_f32 v45, v45, v15, v23
    v_fma_f32 v46, v46, v16, v24
    v_fma_f32 v47, v47, v17, v25
    v_fma_f32 v48, v48, v18, v26
    v_fma_f32 v49, v49, v19, v27
    v_fma_f32 v50, v50, v20, v28
    v_fma_f32 v51, v51, v21, v29
    v_cvt_pk_bf16_f32 v56, v44, v45
    v_cvt_pk_bf16_f32 v57, v46, v47
    v_cvt_pk_bf16_f32 v58, v48, v49
    v_cvt_pk_bf16_f32 v59, v50, v51
    s_add_u32 s29, s28, 13
    s_and_b32 s30, s29, 15
    s_lshl_b32 s29, s29, 10
    v_xor_b32 v53, s30, v1
    v_lshlrev_b32 v53, 4, v53
    v_add_u32 v53, s29, v53
    ds_write_b128 v53, v[56:59]
    s_waitcnt vmcnt(27)
    v_lshlrev_b32 v44, 16, v156
    v_and_b32 v45, 0xffff0000, v156
    v_lshlrev_b32 v46, 16, v157
    v_and_b32 v47, 0xffff0000, v157
    v_lshlrev_b32 v48, 16, v158
    v_and_b32 v49, 0xffff0000, v158
    v_lshlrev_b32 v50, 16, v159
    v_and_b32 v51, 0xffff0000, v159
    v_mov_b32 v52, s69
    v_fma_f32 v44, v44, s68, v52
    v_fma_f32 v45, v45, s68, v52
    v_fma_f32 v46, v46, s68, v52
    v_fma_f32 v47, v47, s68, v52
    v_fma_f32 v48, v48, s68, v52
    v_fma_f32 v49, v49, s68, v52
    v_fma_f32 v50, v50, s68, v52
    v_fma_f32 v51, v51, s68, v52
    v_fma_f32 v44, v44, v14, v22
    v_fma_f32 v45, v45, v15, v23
    v_fma_f32 v46, v46, v16, v24
    v_fma_f32 v47, v47, v17, v25
    v_fma_f32 v48, v48, v18, v26
    v_fma_f32 v49, v49, v19, v27
    v_fma_f32 v50, v50, v20, v28
    v_fma_f32 v51, v51, v21, v29
    v_cvt_pk_bf16_f32 v56, v44, v45
    v_cvt_pk_bf16_f32 v57, v46, v47
    v_cvt_pk_bf16_f32 v58, v48, v49
    v_cvt_pk_bf16_f32 v59, v50, v51
    s_add_u32 s29, s28, 14
    s_and_b32 s30, s29, 15
    s_lshl_b32 s29, s29, 10
    v_xor_b32 v53, s30, v1
    v_lshlrev_b32 v53, 4, v53
    v_add_u32 v53, s29, v53
    ds_write_b128 v53, v[56:59]
    s_waitcnt vmcnt(26)
    v_lshlrev_b32 v44, 16, v160
    v_and_b32 v45, 0xffff0000, v160
    v_lshlrev_b32 v46, 16, v161
    v_and_b32 v47, 0xffff0000, v161
    v_lshlrev_b32 v48, 16, v162
    v_and_b32 v49, 0xffff0000, v162
    v_lshlrev_b32 v50, 16, v163
    v_and_b32 v51, 0xffff0000, v163
    v_mov_b32 v52, s71
    v_fma_f32 v44, v44, s70, v52
    v_fma_f32 v45, v45, s70, v52
    v_fma_f32 v46, v46, s70, v52
    v_fma_f32 v47, v47, s70, v52
    v_fma_f32 v48, v48, s70, v52
    v_fma_f32 v49, v49, s70, v52
    v_fma_f32 v50, v50, s70, v52
    v_fma_f32 v51, v51, s70, v52
    v_fma_f32 v44, v44, v14, v22
    v_fma_f32 v45, v45, v15, v23
    v_fma_f32 v46, v46, v16, v24
    v_fma_f32 v47, v47, v17, v25
    v_fma_f32 v48, v48, v18, v26
    v_fma_f32 v49, v49, v19, v27
    v_fma_f32 v50, v50, v20, v28
    v_fma_f32 v51, v51, v21, v29
    v_cvt_pk_bf16_f32 v56, v44, v45
    v_cvt_pk_bf16_f32 v57, v46, v47
    v_cvt_pk_bf16_f32 v58, v48, v49
    v_cvt_pk_bf16_f32 v59, v50, v51
    s_add_u32 s29, s28, 15
    s_and_b32 s30, s29, 15
    s_lshl_b32 s29, s29, 10
    v_xor_b32 v53, s30, v1
    v_lshlrev_b32 v53, 4, v53
    v_add_u32 v53, s29, v53
    ds_write_b128 v53, v[56:59]
    s_waitcnt vmcnt(25)
    v_lshlrev_b32 v44, 16, v164
    v_and_b32 v45, 0xffff0000, v164
    v_lshlrev_b32 v46, 16, v165
    v_and_b32 v47, 0xffff0000, v165
    v_lshlrev_b32 v48, 16, v166
    v_and_b32 v49, 0xffff0000, v166
    v_lshlrev_b32 v50, 16, v167
    v_and_b32 v51, 0xffff0000, v167
    v_mov_b32 v52, s73
    v_fma_f32 v44, v44, s72, v52
    v_fma_f32 v45, v45, s72, v52
    v_fma_f32 v46, v46, s72, v52
    v_fma_f32 v47, v47, s72, v52
    v_fma_f32 v48, v48, s72, v52
    v_fma_f32 v49, v49, s72, v52
    v_fma_f32 v50, v50, s72, v52
    v_fma_f32 v51, v51, s72, v52
    v_fma_f32 v44, v44, v14, v22
    v_fma_f32 v45, v45, v15, v23
    v_fma_f32 v46, v46, v16, v24
    v_fma_f32 v47, v47, v17, v25
    v_fma_f32 v48, v48, v18, v26
    v_fma_f32 v49, v49, v19, v27
    v_fma_f32 v50, v50, v20, v28
    v_fma_f32 v51, v51, v21, v29
    v_cvt_pk_bf16_f32 v56, v44, v45
    v_cvt_pk_bf16_f32 v57, v46, v47
    v_cvt_pk_bf16_f32 v58, v48, v49
    v_cvt_pk_bf16_f32 v59, v50, v51
    s_add_u32 s29, s28, 16
    s_and_b32 s30, s29, 15
    s_lshl_b32 s29, s29, 10
    v_xor_b32 v53, s30, v1
    v_lshlrev_b32 v53, 4, v53
    v_add_u32 v53, s29, v53
    ds_write_b128 v53, v[56:59]
    s_waitcnt vmcnt(24)
    v_lshlrev_b32 v44, 16, v168
    v_and_b32 v45, 0xffff0000, v168
    v_lshlrev_b32 v46, 16, v169
    v_and_b32 v47, 0xffff0000, v169
    v_lshlrev_b32 v48, 16, v170
    v_and_b32 v49, 0xffff0000, v170
    v_lshlrev_b32 v50, 16, v171
    v_and_b32 v51, 0xffff0000, v171
    v_mov_b32 v52, s75
    v_fma_f32 v44, v44, s74, v52
    v_fma_f32 v45, v45, s74, v52
    v_fma_f32 v46, v46, s74, v52
    v_fma_f32 v47, v47, s74, v52
    v_fma_f32 v48, v48, s74, v52
    v_fma_f32 v49, v49, s74, v52
    v_fma_f32 v50, v50, s74, v52
    v_fma_f32 v51, v51, s74, v52
    v_fma_f32 v44, v44, v14, v22
    v_fma_f32 v45, v45, v15, v23
    v_fma_f32 v46, v46, v16, v24
    v_fma_f32 v47, v47, v17, v25
    v_fma_f32 v48, v48, v18, v26
    v_fma_f32 v49, v49, v19, v27
    v_fma_f32 v50, v50, v20, v28
    v_fma_f32 v51, v51, v21, v29
    v_cvt_pk_bf16_f32 v56, v44, v45
    v_cvt_pk_bf16_f32 v57, v46, v47
    v_cvt_pk_bf16_f32 v58, v48, v49
    v_cvt_pk_bf16_f32 v59, v50, v51
    s_add_u32 s29, s28, 17
    s_and_b32 s30, s29, 15
    s_lshl_b32 s29, s29, 10
    v_xor_b32 v53, s30, v1
    v_lshlrev_b32 v53, 4, v53
    v_add_u32 v53, s29, v53
    ds_write_b128 v53, v[56:59]
    s_waitcnt vmcnt(23)
    v_lshlrev_b32 v44, 16, v172
    v_and_b32 v45, 0xffff0000, v172
    v_lshlrev_b32 v46, 16, v173
    v_and_b32 v47, 0xffff0000, v173
    v_lshlrev_b32 v48, 16, v174
    v_and_b32 v49, 0xffff0000, v174
    v_lshlrev_b32 v50, 16, v175
    v_and_b32 v51, 0xffff0000, v175
    v_mov_b32 v52, s77
    v_fma_f32 v44, v44, s76, v52
    v_fma_f32 v45, v45, s76, v52
    v_fma_f32 v46, v46, s76, v52
    v_fma_f32 v47, v47, s76, v52
    v_fma_f32 v48, v48, s76, v52
    v_fma_f32 v49, v49, s76, v52
    v_fma_f32 v50, v50, s76, v52
    v_fma_f32 v51, v51, s76, v52
    v_fma_f32 v44, v44, v14, v22
    v_fma_f32 v45, v45, v15, v23
    v_fma_f32 v46, v46, v16, v24
    v_fma_f32 v47, v47, v17, v25
    v_fma_f32 v48, v48, v18, v26
    v_fma_f32 v49, v49, v19, v27
    v_fma_f32 v50, v50, v20, v28
    v_fma_f32 v51, v51, v21, v29
    v_cvt_pk_bf16_f32 v56, v44, v45
    v_cvt_pk_bf16_f32 v57, v46, v47
    v_cvt_pk_bf16_f32 v58, v48, v49
    v_cvt_pk_bf16_f32 v59, v50, v51
    s_add_u32 s29, s28, 18
    s_and_b32 s30, s29, 15
    s_lshl_b32 s29, s29, 10
    v_xor_b32 v53, s30, v1
    v_lshlrev_b32 v53, 4, v53
    v_add_u32 v53, s29, v53
    ds_write_b128 v53, v[56:59]
    s_waitcnt vmcnt(22)
    v_lshlrev_b32 v44, 16, v176
    v_and_b32 v45, 0xffff0000, v176
    v_lshlrev_b32 v46, 16, v177
    v_and_b32 v47, 0xffff0000, v177
    v_lshlrev_b32 v48, 16, v178
    v_and_b32 v49, 0xffff0000, v178
    v_lshlrev_b32 v50, 16, v179
    v_and_b32 v51, 0xffff0000, v179
    v_mov_b32 v52, s79
    v_fma_f32 v44, v44, s78, v52
    v_fma_f32 v45, v45, s78, v52
    v_fma_f32 v46, v46, s78, v52
    v_fma_f32 v47, v47, s78, v52
    v_fma_f32 v48, v48, s78, v52
    v_fma_f32 v49, v49, s78, v52
    v_fma_f32 v50, v50, s78, v52
    v_fma_f32 v51, v51, s78, v52
    v_fma_f32 v44, v44, v14, v22
    v_fma_f32 v45, v45, v15, v23
    v_fma_f32 v46, v46, v16, v24
    v_fma_f32 v47, v47, v17, v25
    v_fma_f32 v48, v48, v18, v26
    v_fma_f32 v49, v49, v19, v27
    v_fma_f32 v50, v50, v20, v28
    v_fma_f32 v51, v51, v21, v29
    v_cvt_pk_bf16_f32 v56, v44, v45
    v_cvt_pk_bf16_f32 v57, v46, v47
    v_cvt_pk_bf16_f32 v58, v48, v49
    v_cvt_pk_bf16_f32 v59, v50, v51
    s_add_u32 s29, s28, 19
    s_and_b32 s30, s29, 15
    s_lshl_b32 s29, s29, 10
    v_xor_b32 v53, s30, v1
    v_lshlrev_b32 v53, 4, v53
    v_add_u32 v53, s29, v53
    ds_write_b128 v53, v[56:59]
    s_waitcnt lgkmcnt(0)
    s_waitcnt vmcnt(12)
    s_barrier
    v_mov_b32 v180, 0
    v_mov_b32 v181, 0
    v_mov_b32 v182, 0
    v_mov_b32 v183, 0
    v_mov_b32 v184, 0
    v_mov_b32 v185, 0
    v_mov_b32 v186, 0
    v_mov_b32 v187, 0
    v_mov_b32 v188, 0
    v_mov_b32 v189, 0
    v_mov_b32 v190, 0
    v_mov_b32 v191, 0
    v_mov_b32 v192, 0
    v_mov_b32 v193, 0
    v_mov_b32 v194, 0
    v_mov_b32 v195, 0
    v_mov_b32 v196, 0
    v_mov_b32 v197, 0
    v_mov_b32 v198, 0
    v_mov_b32 v199, 0
    v_mov_b32 v200, 0
    v_mov_b32 v201, 0
    v_mov_b32 v202, 0
    v_mov_b32 v203, 0
    v_mov_b32 v204, 0
    v_mov_b32 v205, 0
    v_mov_b32 v206, 0
    v_mov_b32 v207, 0
    v_mov_b32 v208, 0
    v_mov_b32 v209, 0
    v_mov_b32 v210, 0
    v_mov_b32 v211, 0
    v_mov_b32 v212, 0
    v_mov_b32 v213, 0
    v_mov_b32 v214, 0
    v_mov_b32 v215, 0
    v_mov_b32 v216, 0
    v_mov_b32 v217, 0
    v_mov_b32 v218, 0
    v_mov_b32 v219, 0
    v_mov_b32 v220, 0
    v_mov_b32 v221, 0
    v_mov_b32 v222, 0
    v_mov_b32 v223, 0
    v_mov_b32 v224, 0
    v_mov_b32 v225, 0
    v_mov_b32 v226, 0
    v_mov_b32 v227, 0
    v_mov_b32 v228, 0
    v_mov_b32 v229, 0
    v_mov_b32 v230, 0
    v_mov_b32 v231, 0
    v_mov_b32 v232, 0
    v_mov_b32 v233, 0
    v_mov_b32 v234, 0
    v_mov_b32 v235, 0
    v_mov_b32 v236, 0
    v_mov_b32 v237, 0
    v_mov_b32 v238, 0
    v_mov_b32 v239, 0
    ds_read_b64_tr_b16 v[140:141], v38 offset:0
    ds_read_b64_tr_b16 v[142:143], v38 offset:512
    ds_read_b64_tr_b16 v[144:145], v38 offset:8192
    ds_read_b64_tr_b16 v[146:147], v38 offset:8704
    ds_read_b64_tr_b16 v[148:149], v38 offset:16384
    ds_read_b64_tr_b16 v[150:151], v38 offset:16896
    ds_read_b128 v[100:103], v30 offset:0
    ds_read_b128 v[104:107], v30 offset:16384
    ds_read_b128 v[108:111], v30 offset:32768
    ds_read_b128 v[112:115], v30 offset:49152
    ds_read_b128 v[116:119], v34 offset:0
    s_waitcnt lgkmcnt(0)
    v_mfma_f32_16x16x32_bf16 v[180:183], v[140:143], v[100:103], v[180:183]
    ds_read_b64_tr_b16 v[152:153], v38 offset:4096
    v_mfma_f32_16x16x32_bf16 v[200:203], v[144:147], v[100:103], v[200:203]
    ds_read_b64_tr_b16 v[154:155], v38 offset:4608
    v_mfma_f32_16x16x32_bf16 v[220:223], v[148:151], v[100:103], v[220:223]
    ds_read_b64_tr_b16 v[156:157], v38 offset:12288
    v_mfma_f32_16x16x32_bf16 v[184:187], v[140:143], v[104:107], v[184:187]
    ds_read_b64_tr_b16 v[158:159], v38 offset:12800
    v_mfma_f32_16x16x32_bf16 v[204:207], v[144:147], v[104:107], v[204:207]
    ds_read_b64_tr_b16 v[160:161], v38 offset:20480
    v_mfma_f32_16x16x32_bf16 v[224:227], v[148:151], v[104:107], v[224:227]
    ds_read_b64_tr_b16 v[162:163], v38 offset:20992
    v_mfma_f32_16x16x32_bf16 v[188:191], v[140:143], v[108:111], v[188:191]
    ds_read_b128 v[120:123], v31 offset:0
    v_mfma_f32_16x16x32_bf16 v[208:211], v[144:147], v[108:111], v[208:211]
    ds_read_b128 v[124:127], v31 offset:16384
    v_mfma_f32_16x16x32_bf16 v[228:231], v[148:151], v[108:111], v[228:231]
    ds_read_b128 v[128:131], v31 offset:32768
    v_mfma_f32_16x16x32_bf16 v[192:195], v[140:143], v[112:115], v[192:195]
    ds_read_b128 v[132:135], v31 offset:49152
    v_mfma_f32_16x16x32_bf16 v[212:215], v[144:147], v[112:115], v[212:215]
    ds_read_b128 v[136:139], v35 offset:0
    v_mfma_f32_16x16x32_bf16 v[232:235], v[148:151], v[112:115], v[232:235]
    v_mfma_f32_16x16x32_bf16 v[196:199], v[140:143], v[116:119], v[196:199]
    v_mfma_f32_16x16x32_bf16 v[216:219], v[144:147], v[116:119], v[216:219]
    v_mfma_f32_16x16x32_bf16 v[236:239], v[148:151], v[116:119], v[236:239]
    s_waitcnt lgkmcnt(0)
    s_waitcnt vmcnt(6)
    s_barrier
    s_add_u32 s34, s33, 81920
    s_mov_b32 m0, s34
    s_add_u32 s35, s32, 589824
    buffer_load_dwordx4 v11, s[16:19], s35 offen lds
    s_add_u32 s34, s33, 82944
    s_mov_b32 m0, s34
    s_add_u32 s35, s32, 614400
    buffer_load_dwordx4 v12, s[16:19], s35 offen lds
    s_add_u32 s34, s33, 90112
    s_mov_b32 m0, s34
    s_add_u32 s35, s32, 590848
    buffer_load_dwordx4 v11, s[16:19], s35 offen lds
    s_add_u32 s34, s33, 91136
    s_mov_b32 m0, s34
    s_add_u32 s35, s32, 615424
    buffer_load_dwordx4 v12, s[16:19], s35 offen lds
    s_add_u32 s34, s33, 98304
    s_mov_b32 m0, s34
    s_add_u32 s35, s32, 591872
    buffer_load_dwordx4 v11, s[16:19], s35 offen lds
    s_add_u32 s34, s33, 99328
    s_mov_b32 m0, s34
    s_add_u32 s35, s32, 616448
    buffer_load_dwordx4 v12, s[16:19], s35 offen lds
    v_mfma_f32_16x16x32_bf16 v[180:183], v[152:155], v[120:123], v[180:183]
    ds_read_b64_tr_b16 v[140:141], v38 offset:24576
    v_mfma_f32_16x16x32_bf16 v[200:203], v[156:159], v[120:123], v[200:203]
    ds_read_b64_tr_b16 v[142:143], v38 offset:25088
    v_mfma_f32_16x16x32_bf16 v[220:223], v[160:163], v[120:123], v[220:223]
    ds_read_b64_tr_b16 v[144:145], v38 offset:32768
    v_mfma_f32_16x16x32_bf16 v[184:187], v[152:155], v[124:127], v[184:187]
    ds_read_b64_tr_b16 v[146:147], v38 offset:33280
    v_mfma_f32_16x16x32_bf16 v[204:207], v[156:159], v[124:127], v[204:207]
    ds_read_b64_tr_b16 v[148:149], v38 offset:40960
    v_mfma_f32_16x16x32_bf16 v[224:227], v[160:163], v[124:127], v[224:227]
    ds_read_b64_tr_b16 v[150:151], v38 offset:41472
    v_mfma_f32_16x16x32_bf16 v[188:191], v[152:155], v[128:131], v[188:191]
    ds_read_b128 v[100:103], v32 offset:0
    v_mfma_f32_16x16x32_bf16 v[208:211], v[156:159], v[128:131], v[208:211]
    ds_read_b128 v[104:107], v32 offset:16384
    v_mfma_f32_16x16x32_bf16 v[228:231], v[160:163], v[128:131], v[228:231]
    ds_read_b128 v[108:111], v32 offset:32768
    v_mfma_f32_16x16x32_bf16 v[192:195], v[152:155], v[132:135], v[192:195]
    ds_read_b128 v[112:115], v32 offset:49152
    v_mfma_f32_16x16x32_bf16 v[212:215], v[156:159], v[132:135], v[212:215]
    ds_read_b128 v[116:119], v36 offset:0
    v_mfma_f32_16x16x32_bf16 v[232:235], v[160:163], v[132:135], v[232:235]
    v_mfma_f32_16x16x32_bf16 v[196:199], v[152:155], v[136:139], v[196:199]
    v_mfma_f32_16x16x32_bf16 v[216:219], v[156:159], v[136:139], v[216:219]
    v_mfma_f32_16x16x32_bf16 v[236:239], v[160:163], v[136:139], v[236:239]
    s_waitcnt lgkmcnt(0)
    v_mfma_f32_16x16x32_bf16 v[180:183], v[140:143], v[100:103], v[180:183]
    ds_read_b64_tr_b16 v[152:153], v38 offset:28672
    v_mfma_f32_16x16x32_bf16 v[200:203], v[144:147], v[100:103], v[200:203]
    ds_read_b64_tr_b16 v[154:155], v38 offset:29184
    v_mfma_f32_16x16x32_bf16 v[220:223], v[148:151], v[100:103], v[220:223]
    ds_read_b64_tr_b16 v[156:157], v38 offset:36864
    v_mfma_f32_16x16x32_bf16 v[184:187], v[140:143], v[104:107], v[184:187]
    ds_read_b64_tr_b16 v[158:159], v38 offset:37376
    v_mfma_f32_16x16x32_bf16 v[204:207], v[144:147], v[104:107], v[204:207]
    ds_read_b64_tr_b16 v[160:161], v38 offset:45056
    v_mfma_f32_16x16x32_bf16 v[224:227], v[148:151], v[104:107], v[224:227]
    ds_read_b64_tr_b16 v[162:163], v38 offset:45568
    v_mfma_f32_16x16x32_bf16 v[188:191], v[140:143], v[108:111], v[188:191]
    ds_read_b128 v[120:123], v33 offset:0
    v_mfma_f32_16x16x32_bf16 v[208:211], v[144:147], v[108:111], v[208:211]
    ds_read_b128 v[124:127], v33 offset:16384
    v_mfma_f32_16x16x32_bf16 v[228:231], v[148:151], v[108:111], v[228:231]
    ds_read_b128 v[128:131], v33 offset:32768
    v_mfma_f32_16x16x32_bf16 v[192:195], v[140:143], v[112:115], v[192:195]
    ds_read_b128 v[132:135], v33 offset:49152
    v_mfma_f32_16x16x32_bf16 v[212:215], v[144:147], v[112:115], v[212:215]
    ds_read_b128 v[136:139], v37 offset:0
    v_mfma_f32_16x16x32_bf16 v[232:235], v[148:151], v[112:115], v[232:235]
    v_mfma_f32_16x16x32_bf16 v[196:199], v[140:143], v[116:119], v[196:199]
    v_mfma_f32_16x16x32_bf16 v[216:219], v[144:147], v[116:119], v[216:219]
    v_mfma_f32_16x16x32_bf16 v[236:239], v[148:151], v[116:119], v[236:239]
    s_waitcnt lgkmcnt(0)
    s_waitcnt vmcnt(6)
    s_barrier
    s_add_u32 s34, s33, 106496
    s_mov_b32 m0, s34
    s_add_u32 s35, s32, 786432
    buffer_load_dwordx4 v11, s[16:19], s35 offen lds
    s_add_u32 s34, s33, 107520
    s_mov_b32 m0, s34
    s_add_u32 s35, s32, 811008
    buffer_load_dwordx4 v12, s[16:19], s35 offen lds
    s_add_u32 s34, s33, 114688
    s_mov_b32 m0, s34
    s_add_u32 s35, s32, 787456
    buffer_load_dwordx4 v11, s[16:19], s35 offen lds
    s_add_u32 s34, s33, 115712
    s_mov_b32 m0, s34
    s_add_u32 s35, s32, 812032
    buffer_load_dwordx4 v12, s[16:19], s35 offen lds
    s_add_u32 s34, s33, 122880
    s_mov_b32 m0, s34
    s_add_u32 s35, s32, 788480
    buffer_load_dwordx4 v11, s[16:19], s35 offen lds
    s_add_u32 s34, s33, 123904
    s_mov_b32 m0, s34
    s_add_u32 s35, s32, 813056
    buffer_load_dwordx4 v12, s[16:19], s35 offen lds
    v_mfma_f32_16x16x32_bf16 v[180:183], v[152:155], v[120:123], v[180:183]
    ds_read_b64_tr_b16 v[140:141], v39 offset:0
    v_mfma_f32_16x16x32_bf16 v[200:203], v[156:159], v[120:123], v[200:203]
    ds_read_b64_tr_b16 v[142:143], v39 offset:512
    v_mfma_f32_16x16x32_bf16 v[220:223], v[160:163], v[120:123], v[220:223]
    ds_read_b64_tr_b16 v[144:145], v39 offset:8192
    v_mfma_f32_16x16x32_bf16 v[184:187], v[152:155], v[124:127], v[184:187]
    ds_read_b64_tr_b16 v[146:147], v39 offset:8704
    v_mfma_f32_16x16x32_bf16 v[204:207], v[156:159], v[124:127], v[204:207]
    ds_read_b64_tr_b16 v[148:149], v39 offset:16384
    v_mfma_f32_16x16x32_bf16 v[224:227], v[160:163], v[124:127], v[224:227]
    ds_read_b64_tr_b16 v[150:151], v39 offset:16896
    v_mfma_f32_16x16x32_bf16 v[188:191], v[152:155], v[128:131], v[188:191]
    ds_read_b128 v[100:103], v30 offset:256
    v_mfma_f32_16x16x32_bf16 v[208:211], v[156:159], v[128:131], v[208:211]
    ds_read_b128 v[104:107], v30 offset:16640
    v_mfma_f32_16x16x32_bf16 v[228:231], v[160:163], v[128:131], v[228:231]
    ds_read_b128 v[108:111], v30 offset:33024
    v_mfma_f32_16x16x32_bf16 v[192:195], v[152:155], v[132:135], v[192:195]
    ds_read_b128 v[112:115], v30 offset:49408
    v_mfma_f32_16x16x32_bf16 v[212:215], v[156:159], v[132:135], v[212:215]
    ds_read_b128 v[116:119], v34 offset:256
    v_mfma_f32_16x16x32_bf16 v[232:235], v[160:163], v[132:135], v[232:235]
    v_mfma_f32_16x16x32_bf16 v[196:199], v[152:155], v[136:139], v[196:199]
    v_mfma_f32_16x16x32_bf16 v[216:219], v[156:159], v[136:139], v[216:219]
    v_mfma_f32_16x16x32_bf16 v[236:239], v[160:163], v[136:139], v[236:239]
    s_waitcnt lgkmcnt(0)
    v_mfma_f32_16x16x32_bf16 v[180:183], v[140:143], v[100:103], v[180:183]
    ds_read_b64_tr_b16 v[152:153], v39 offset:4096
    v_mfma_f32_16x16x32_bf16 v[200:203], v[144:147], v[100:103], v[200:203]
    ds_read_b64_tr_b16 v[154:155], v39 offset:4608
    v_mfma_f32_16x16x32_bf16 v[220:223], v[148:151], v[100:103], v[220:223]
    ds_read_b64_tr_b16 v[156:157], v39 offset:12288
    v_mfma_f32_16x16x32_bf16 v[184:187], v[140:143], v[104:107], v[184:187]
    ds_read_b64_tr_b16 v[158:159], v39 offset:12800
    v_mfma_f32_16x16x32_bf16 v[204:207], v[144:147], v[104:107], v[204:207]
    ds_read_b64_tr_b16 v[160:161], v39 offset:20480
    v_mfma_f32_16x16x32_bf16 v[224:227], v[148:151], v[104:107], v[224:227]
    ds_read_b64_tr_b16 v[162:163], v39 offset:20992
    v_mfma_f32_16x16x32_bf16 v[188:191], v[140:143], v[108:111], v[188:191]
    ds_read_b128 v[120:123], v31 offset:256
    v_mfma_f32_16x16x32_bf16 v[208:211], v[144:147], v[108:111], v[208:211]
    ds_read_b128 v[124:127], v31 offset:16640
    v_mfma_f32_16x16x32_bf16 v[228:231], v[148:151], v[108:111], v[228:231]
    ds_read_b128 v[128:131], v31 offset:33024
    v_mfma_f32_16x16x32_bf16 v[192:195], v[140:143], v[112:115], v[192:195]
    ds_read_b128 v[132:135], v31 offset:49408
    v_mfma_f32_16x16x32_bf16 v[212:215], v[144:147], v[112:115], v[212:215]
    ds_read_b128 v[136:139], v35 offset:256
    v_mfma_f32_16x16x32_bf16 v[232:235], v[148:151], v[112:115], v[232:235]
    v_mfma_f32_16x16x32_bf16 v[196:199], v[140:143], v[116:119], v[196:199]
    v_mfma_f32_16x16x32_bf16 v[216:219], v[144:147], v[116:119], v[216:219]
    v_mfma_f32_16x16x32_bf16 v[236:239], v[148:151], v[116:119], v[236:239]
    s_waitcnt lgkmcnt(0)
    s_waitcnt vmcnt(6)
    s_barrier
    s_add_u32 s34, s33, 131072
    s_mov_b32 m0, s34
    s_add_u32 s35, s32, 983040
    buffer_load_dwordx4 v11, s[16:19], s35 offen lds
    s_add_u32 s34, s33, 132096
    s_mov_b32 m0, s34
    s_add_u32 s35, s32, 1007616
    buffer_load_dwordx4 v12, s[16:19], s35 offen lds
    s_add_u32 s34, s33, 139264
    s_mov_b32 m0, s34
    s_add_u32 s35, s32, 984064
    buffer_load_dwordx4 v11, s[16:19], s35 offen lds
    s_add_u32 s34, s33, 140288
    s_mov_b32 m0, s34
    s_add_u32 s35, s32, 1008640
    buffer_load_dwordx4 v12, s[16:19], s35 offen lds
    s_add_u32 s34, s33, 147456
    s_mov_b32 m0, s34
    s_add_u32 s35, s32, 985088
    buffer_load_dwordx4 v11, s[16:19], s35 offen lds
    s_add_u32 s34, s33, 148480
    s_mov_b32 m0, s34
    s_add_u32 s35, s32, 1009664
    buffer_load_dwordx4 v12, s[16:19], s35 offen lds
    v_mfma_f32_16x16x32_bf16 v[180:183], v[152:155], v[120:123], v[180:183]
    ds_read_b64_tr_b16 v[140:141], v38 offset:0
    v_mfma_f32_16x16x32_bf16 v[200:203], v[156:159], v[120:123], v[200:203]
    ds_read_b64_tr_b16 v[142:143], v38 offset:512
    v_mfma_f32_16x16x32_bf16 v[220:223], v[160:163], v[120:123], v[220:223]
    ds_read_b64_tr_b16 v[144:145], v38 offset:8192
    v_mfma_f32_16x16x32_bf16 v[184:187], v[152:155], v[124:127], v[184:187]
    ds_read_b64_tr_b16 v[146:147], v38 offset:8704
    v_mfma_f32_16x16x32_bf16 v[204:207], v[156:159], v[124:127], v[204:207]
    ds_read_b64_tr_b16 v[148:149], v38 offset:16384
    v_mfma_f32_16x16x32_bf16 v[224:227], v[160:163], v[124:127], v[224:227]
    ds_read_b64_tr_b16 v[150:151], v38 offset:16896
    v_mfma_f32_16x16x32_bf16 v[188:191], v[152:155], v[128:131], v[188:191]
    ds_read_b128 v[100:103], v32 offset:256
    v_mfma_f32_16x16x32_bf16 v[208:211], v[156:159], v[128:131], v[208:211]
    ds_read_b128 v[104:107], v32 offset:16640
    v_mfma_f32_16x16x32_bf16 v[228:231], v[160:163], v[128:131], v[228:231]
    ds_read_b128 v[108:111], v32 offset:33024
    v_mfma_f32_16x16x32_bf16 v[192:195], v[152:155], v[132:135], v[192:195]
    ds_read_b128 v[112:115], v32 offset:49408
    v_mfma_f32_16x16x32_bf16 v[212:215], v[156:159], v[132:135], v[212:215]
    ds_read_b128 v[116:119], v36 offset:256
    v_mfma_f32_16x16x32_bf16 v[232:235], v[160:163], v[132:135], v[232:235]
    v_mfma_f32_16x16x32_bf16 v[196:199], v[152:155], v[136:139], v[196:199]
    v_mfma_f32_16x16x32_bf16 v[216:219], v[156:159], v[136:139], v[216:219]
    v_mfma_f32_16x16x32_bf16 v[236:239], v[160:163], v[136:139], v[236:239]
    s_waitcnt lgkmcnt(0)
    v_mfma_f32_16x16x32_bf16 v[180:183], v[140:143], v[100:103], v[180:183]
    ds_read_b64_tr_b16 v[152:153], v38 offset:4096
    v_mfma_f32_16x16x32_bf16 v[200:203], v[144:147], v[100:103], v[200:203]
    ds_read_b64_tr_b16 v[154:155], v38 offset:4608
    v_mfma_f32_16x16x32_bf16 v[220:223], v[148:151], v[100:103], v[220:223]
    ds_read_b64_tr_b16 v[156:157], v38 offset:12288
    v_mfma_f32_16x16x32_bf16 v[184:187], v[140:143], v[104:107], v[184:187]
    ds_read_b64_tr_b16 v[158:159], v38 offset:12800
    v_mfma_f32_16x16x32_bf16 v[204:207], v[144:147], v[104:107], v[204:207]
    ds_read_b64_tr_b16 v[160:161], v38 offset:20480
    v_mfma_f32_16x16x32_bf16 v[224:227], v[148:151], v[104:107], v[224:227]
    ds_read_b64_tr_b16 v[162:163], v38 offset:20992
    v_mfma_f32_16x16x32_bf16 v[188:191], v[140:143], v[108:111], v[188:191]
    ds_read_b128 v[120:123], v33 offset:256
    v_mfma_f32_16x16x32_bf16 v[208:211], v[144:147], v[108:111], v[208:211]
    ds_read_b128 v[124:127], v33 offset:16640
    v_mfma_f32_16x16x32_bf16 v[228:231], v[148:151], v[108:111], v[228:231]
    ds_read_b128 v[128:131], v33 offset:33024
    v_mfma_f32_16x16x32_bf16 v[192:195], v[140:143], v[112:115], v[192:195]
    ds_read_b128 v[132:135], v33 offset:49408
    v_mfma_f32_16x16x32_bf16 v[212:215], v[144:147], v[112:115], v[212:215]
    ds_read_b128 v[136:139], v37 offset:256
    v_mfma_f32_16x16x32_bf16 v[232:235], v[148:151], v[112:115], v[232:235]
    v_mfma_f32_16x16x32_bf16 v[196:199], v[140:143], v[116:119], v[196:199]
    v_mfma_f32_16x16x32_bf16 v[216:219], v[144:147], v[116:119], v[216:219]
    v_mfma_f32_16x16x32_bf16 v[236:239], v[148:151], v[116:119], v[236:239]
    s_waitcnt lgkmcnt(0)
    s_waitcnt vmcnt(6)
    s_barrier
    s_add_u32 s34, s33, 81920
    s_mov_b32 m0, s34
    s_add_u32 s35, s32, 1179648
    buffer_load_dwordx4 v11, s[16:19], s35 offen lds
    s_add_u32 s34, s33, 82944
    s_mov_b32 m0, s34
    s_add_u32 s35, s32, 1204224
    buffer_load_dwordx4 v12, s[16:19], s35 offen lds
    s_add_u32 s34, s33, 90112
    s_mov_b32 m0, s34
    s_add_u32 s35, s32, 1180672
    buffer_load_dwordx4 v11, s[16:19], s35 offen lds
    s_add_u32 s34, s33, 91136
    s_mov_b32 m0, s34
    s_add_u32 s35, s32, 1205248
    buffer_load_dwordx4 v12, s[16:19], s35 offen lds
    s_add_u32 s34, s33, 98304
    s_mov_b32 m0, s34
    s_add_u32 s35, s32, 1181696
    buffer_load_dwordx4 v11, s[16:19], s35 offen lds
    s_add_u32 s34, s33, 99328
    s_mov_b32 m0, s34
    s_add_u32 s35, s32, 1206272
    buffer_load_dwordx4 v12, s[16:19], s35 offen lds
    v_mfma_f32_16x16x32_bf16 v[180:183], v[152:155], v[120:123], v[180:183]
    ds_read_b64_tr_b16 v[140:141], v38 offset:24576
    v_mfma_f32_16x16x32_bf16 v[200:203], v[156:159], v[120:123], v[200:203]
    ds_read_b64_tr_b16 v[142:143], v38 offset:25088
    v_mfma_f32_16x16x32_bf16 v[220:223], v[160:163], v[120:123], v[220:223]
    ds_read_b64_tr_b16 v[144:145], v38 offset:32768
    v_mfma_f32_16x16x32_bf16 v[184:187], v[152:155], v[124:127], v[184:187]
    ds_read_b64_tr_b16 v[146:147], v38 offset:33280
    v_mfma_f32_16x16x32_bf16 v[204:207], v[156:159], v[124:127], v[204:207]
    ds_read_b64_tr_b16 v[148:149], v38 offset:40960
    v_mfma_f32_16x16x32_bf16 v[224:227], v[160:163], v[124:127], v[224:227]
    ds_read_b64_tr_b16 v[150:151], v38 offset:41472
    v_mfma_f32_16x16x32_bf16 v[188:191], v[152:155], v[128:131], v[188:191]
    ds_read_b128 v[100:103], v30 offset:512
    v_mfma_f32_16x16x32_bf16 v[208:211], v[156:159], v[128:131], v[208:211]
    ds_read_b128 v[104:107], v30 offset:16896
    v_mfma_f32_16x16x32_bf16 v[228:231], v[160:163], v[128:131], v[228:231]
    ds_read_b128 v[108:111], v30 offset:33280
    v_mfma_f32_16x16x32_bf16 v[192:195], v[152:155], v[132:135], v[192:195]
    ds_read_b128 v[112:115], v30 offset:49664
    v_mfma_f32_16x16x32_bf16 v[212:215], v[156:159], v[132:135], v[212:215]
    ds_read_b128 v[116:119], v34 offset:512
    v_mfma_f32_16x16x32_bf16 v[232:235], v[160:163], v[132:135], v[232:235]
    v_mfma_f32_16x16x32_bf16 v[196:199], v[152:155], v[136:139], v[196:199]
    v_mfma_f32_16x16x32_bf16 v[216:219], v[156:159], v[136:139], v[216:219]
    v_mfma_f32_16x16x32_bf16 v[236:239], v[160:163], v[136:139], v[236:239]
    s_waitcnt lgkmcnt(0)
    v_mfma_f32_16x16x32_bf16 v[180:183], v[140:143], v[100:103], v[180:183]
    ds_read_b64_tr_b16 v[152:153], v38 offset:28672
    v_mfma_f32_16x16x32_bf16 v[200:203], v[144:147], v[100:103], v[200:203]
    ds_read_b64_tr_b16 v[154:155], v38 offset:29184
    v_mfma_f32_16x16x32_bf16 v[220:223], v[148:151], v[100:103], v[220:223]
    ds_read_b64_tr_b16 v[156:157], v38 offset:36864
    v_mfma_f32_16x16x32_bf16 v[184:187], v[140:143], v[104:107], v[184:187]
    ds_read_b64_tr_b16 v[158:159], v38 offset:37376
    v_mfma_f32_16x16x32_bf16 v[204:207], v[144:147], v[104:107], v[204:207]
    ds_read_b64_tr_b16 v[160:161], v38 offset:45056
    v_mfma_f32_16x16x32_bf16 v[224:227], v[148:151], v[104:107], v[224:227]
    ds_read_b64_tr_b16 v[162:163], v38 offset:45568
    v_mfma_f32_16x16x32_bf16 v[188:191], v[140:143], v[108:111], v[188:191]
    ds_read_b128 v[120:123], v31 offset:512
    v_mfma_f32_16x16x32_bf16 v[208:211], v[144:147], v[108:111], v[208:211]
    ds_read_b128 v[124:127], v31 offset:16896
    v_mfma_f32_16x16x32_bf16 v[228:231], v[148:151], v[108:111], v[228:231]
    ds_read_b128 v[128:131], v31 offset:33280
    v_mfma_f32_16x16x32_bf16 v[192:195], v[140:143], v[112:115], v[192:195]
    ds_read_b128 v[132:135], v31 offset:49664
    v_mfma_f32_16x16x32_bf16 v[212:215], v[144:147], v[112:115], v[212:215]
    ds_read_b128 v[136:139], v35 offset:512
    v_mfma_f32_16x16x32_bf16 v[232:235], v[148:151], v[112:115], v[232:235]
    v_mfma_f32_16x16x32_bf16 v[196:199], v[140:143], v[116:119], v[196:199]
    v_mfma_f32_16x16x32_bf16 v[216:219], v[144:147], v[116:119], v[216:219]
    v_mfma_f32_16x16x32_bf16 v[236:239], v[148:151], v[116:119], v[236:239]
    s_waitcnt lgkmcnt(0)
    s_waitcnt vmcnt(6)
    s_barrier
    s_add_u32 s34, s33, 106496
    s_mov_b32 m0, s34
    s_add_u32 s35, s32, 1376256
    buffer_load_dwordx4 v11, s[16:19], s35 offen lds
    s_add_u32 s34, s33, 107520
    s_mov_b32 m0, s34
    s_add_u32 s35, s32, 1400832
    buffer_load_dwordx4 v12, s[16:19], s35 offen lds
    s_add_u32 s34, s33, 114688
    s_mov_b32 m0, s34
    s_add_u32 s35, s32, 1377280
    buffer_load_dwordx4 v11, s[16:19], s35 offen lds
    s_add_u32 s34, s33, 115712
    s_mov_b32 m0, s34
    s_add_u32 s35, s32, 1401856
    buffer_load_dwordx4 v12, s[16:19], s35 offen lds
    s_add_u32 s34, s33, 122880
    s_mov_b32 m0, s34
    s_add_u32 s35, s32, 1378304
    buffer_load_dwordx4 v11, s[16:19], s35 offen lds
    s_add_u32 s34, s33, 123904
    s_mov_b32 m0, s34
    s_add_u32 s35, s32, 1402880
    buffer_load_dwordx4 v12, s[16:19], s35 offen lds
    v_mfma_f32_16x16x32_bf16 v[180:183], v[152:155], v[120:123], v[180:183]
    ds_read_b64_tr_b16 v[140:141], v39 offset:0
    v_mfma_f32_16x16x32_bf16 v[200:203], v[156:159], v[120:123], v[200:203]
    ds_read_b64_tr_b16 v[142:143], v39 offset:512
    v_mfma_f32_16x16x32_bf16 v[220:223], v[160:163], v[120:123], v[220:223]
    ds_read_b64_tr_b16 v[144:145], v39 offset:8192
    v_mfma_f32_16x16x32_bf16 v[184:187], v[152:155], v[124:127], v[184:187]
    ds_read_b64_tr_b16 v[146:147], v39 offset:8704
    v_mfma_f32_16x16x32_bf16 v[204:207], v[156:159], v[124:127], v[204:207]
    ds_read_b64_tr_b16 v[148:149], v39 offset:16384
    v_mfma_f32_16x16x32_bf16 v[224:227], v[160:163], v[124:127], v[224:227]
    ds_read_b64_tr_b16 v[150:151], v39 offset:16896
    v_mfma_f32_16x16x32_bf16 v[188:191], v[152:155], v[128:131], v[188:191]
    ds_read_b128 v[100:103], v32 offset:512
    v_mfma_f32_16x16x32_bf16 v[208:211], v[156:159], v[128:131], v[208:211]
    ds_read_b128 v[104:107], v32 offset:16896
    v_mfma_f32_16x16x32_bf16 v[228:231], v[160:163], v[128:131], v[228:231]
    ds_read_b128 v[108:111], v32 offset:33280
    v_mfma_f32_16x16x32_bf16 v[192:195], v[152:155], v[132:135], v[192:195]
    ds_read_b128 v[112:115], v32 offset:49664
    v_mfma_f32_16x16x32_bf16 v[212:215], v[156:159], v[132:135], v[212:215]
    ds_read_b128 v[116:119], v36 offset:512
    v_mfma_f32_16x16x32_bf16 v[232:235], v[160:163], v[132:135], v[232:235]
    v_mfma_f32_16x16x32_bf16 v[196:199], v[152:155], v[136:139], v[196:199]
    v_mfma_f32_16x16x32_bf16 v[216:219], v[156:159], v[136:139], v[216:219]
    v_mfma_f32_16x16x32_bf16 v[236:239], v[160:163], v[136:139], v[236:239]
    s_waitcnt lgkmcnt(0)
    v_mfma_f32_16x16x32_bf16 v[180:183], v[140:143], v[100:103], v[180:183]
    ds_read_b64_tr_b16 v[152:153], v39 offset:4096
    v_mfma_f32_16x16x32_bf16 v[200:203], v[144:147], v[100:103], v[200:203]
    ds_read_b64_tr_b16 v[154:155], v39 offset:4608
    v_mfma_f32_16x16x32_bf16 v[220:223], v[148:151], v[100:103], v[220:223]
    ds_read_b64_tr_b16 v[156:157], v39 offset:12288
    v_mfma_f32_16x16x32_bf16 v[184:187], v[140:143], v[104:107], v[184:187]
    ds_read_b64_tr_b16 v[158:159], v39 offset:12800
    v_mfma_f32_16x16x32_bf16 v[204:207], v[144:147], v[104:107], v[204:207]
    ds_read_b64_tr_b16 v[160:161], v39 offset:20480
    v_mfma_f32_16x16x32_bf16 v[224:227], v[148:151], v[104:107], v[224:227]
    ds_read_b64_tr_b16 v[162:163], v39 offset:20992
    v_mfma_f32_16x16x32_bf16 v[188:191], v[140:143], v[108:111], v[188:191]
    ds_read_b128 v[120:123], v33 offset:512
    v_mfma_f32_16x16x32_bf16 v[208:211], v[144:147], v[108:111], v[208:211]
    ds_read_b128 v[124:127], v33 offset:16896
    v_mfma_f32_16x16x32_bf16 v[228:231], v[148:151], v[108:111], v[228:231]
    ds_read_b128 v[128:131], v33 offset:33280
    v_mfma_f32_16x16x32_bf16 v[192:195], v[140:143], v[112:115], v[192:195]
    ds_read_b128 v[132:135], v33 offset:49664
    v_mfma_f32_16x16x32_bf16 v[212:215], v[144:147], v[112:115], v[212:215]
    ds_read_b128 v[136:139], v37 offset:512
    v_mfma_f32_16x16x32_bf16 v[232:235], v[148:151], v[112:115], v[232:235]
    v_mfma_f32_16x16x32_bf16 v[196:199], v[140:143], v[116:119], v[196:199]
    v_mfma_f32_16x16x32_bf16 v[216:219], v[144:147], v[116:119], v[216:219]
    v_mfma_f32_16x16x32_bf16 v[236:239], v[148:151], v[116:119], v[236:239]
    s_waitcnt lgkmcnt(0)
    s_waitcnt vmcnt(6)
    s_barrier
    v_mfma_f32_16x16x32_bf16 v[180:183], v[152:155], v[120:123], v[180:183]
    ds_read_b64_tr_b16 v[140:141], v38 offset:0
    v_mfma_f32_16x16x32_bf16 v[200:203], v[156:159], v[120:123], v[200:203]
    ds_read_b64_tr_b16 v[142:143], v38 offset:512
    v_mfma_f32_16x16x32_bf16 v[220:223], v[160:163], v[120:123], v[220:223]
    ds_read_b64_tr_b16 v[144:145], v38 offset:8192
    v_mfma_f32_16x16x32_bf16 v[184:187], v[152:155], v[124:127], v[184:187]
    ds_read_b64_tr_b16 v[146:147], v38 offset:8704
    v_mfma_f32_16x16x32_bf16 v[204:207], v[156:159], v[124:127], v[204:207]
    ds_read_b64_tr_b16 v[148:149], v38 offset:16384
    v_mfma_f32_16x16x32_bf16 v[224:227], v[160:163], v[124:127], v[224:227]
    ds_read_b64_tr_b16 v[150:151], v38 offset:16896
    v_mfma_f32_16x16x32_bf16 v[188:191], v[152:155], v[128:131], v[188:191]
    ds_read_b128 v[100:103], v30 offset:768
    v_mfma_f32_16x16x32_bf16 v[208:211], v[156:159], v[128:131], v[208:211]
    ds_read_b128 v[104:107], v30 offset:17152
    v_mfma_f32_16x16x32_bf16 v[228:231], v[160:163], v[128:131], v[228:231]
    ds_read_b128 v[108:111], v30 offset:33536
    v_mfma_f32_16x16x32_bf16 v[192:195], v[152:155], v[132:135], v[192:195]
    ds_read_b128 v[112:115], v30 offset:49920
    v_mfma_f32_16x16x32_bf16 v[212:215], v[156:159], v[132:135], v[212:215]
    ds_read_b128 v[116:119], v34 offset:768
    v_mfma_f32_16x16x32_bf16 v[232:235], v[160:163], v[132:135], v[232:235]
    v_mfma_f32_16x16x32_bf16 v[196:199], v[152:155], v[136:139], v[196:199]
    v_mfma_f32_16x16x32_bf16 v[216:219], v[156:159], v[136:139], v[216:219]
    v_mfma_f32_16x16x32_bf16 v[236:239], v[160:163], v[136:139], v[236:239]
    s_waitcnt lgkmcnt(0)
    v_mfma_f32_16x16x32_bf16 v[180:183], v[140:143], v[100:103], v[180:183]
    ds_read_b64_tr_b16 v[152:153], v38 offset:4096
    v_mfma_f32_16x16x32_bf16 v[200:203], v[144:147], v[100:103], v[200:203]
    ds_read_b64_tr_b16 v[154:155], v38 offset:4608
    v_mfma_f32_16x16x32_bf16 v[220:223], v[148:151], v[100:103], v[220:223]
    ds_read_b64_tr_b16 v[156:157], v38 offset:12288
    v_mfma_f32_16x16x32_bf16 v[184:187], v[140:143], v[104:107], v[184:187]
    ds_read_b64_tr_b16 v[158:159], v38 offset:12800
    v_mfma_f32_16x16x32_bf16 v[204:207], v[144:147], v[104:107], v[204:207]
    ds_read_b64_tr_b16 v[160:161], v38 offset:20480
    v_mfma_f32_16x16x32_bf16 v[224:227], v[148:151], v[104:107], v[224:227]
    ds_read_b64_tr_b16 v[162:163], v38 offset:20992
    v_mfma_f32_16x16x32_bf16 v[188:191], v[140:143], v[108:111], v[188:191]
    ds_read_b128 v[120:123], v31 offset:768
    v_mfma_f32_16x16x32_bf16 v[208:211], v[144:147], v[108:111], v[208:211]
    ds_read_b128 v[124:127], v31 offset:17152
    v_mfma_f32_16x16x32_bf16 v[228:231], v[148:151], v[108:111], v[228:231]
    ds_read_b128 v[128:131], v31 offset:33536
    v_mfma_f32_16x16x32_bf16 v[192:195], v[140:143], v[112:115], v[192:195]
    ds_read_b128 v[132:135], v31 offset:49920
    v_mfma_f32_16x16x32_bf16 v[212:215], v[144:147], v[112:115], v[212:215]
    ds_read_b128 v[136:139], v35 offset:768
    v_mfma_f32_16x16x32_bf16 v[232:235], v[148:151], v[112:115], v[232:235]
    v_mfma_f32_16x16x32_bf16 v[196:199], v[140:143], v[116:119], v[196:199]
    v_mfma_f32_16x16x32_bf16 v[216:219], v[144:147], v[116:119], v[216:219]
    v_mfma_f32_16x16x32_bf16 v[236:239], v[148:151], v[116:119], v[236:239]
    s_waitcnt lgkmcnt(0)
    s_waitcnt vmcnt(0)
    s_barrier
    v_mfma_f32_16x16x32_bf16 v[180:183], v[152:155], v[120:123], v[180:183]
    ds_read_b64_tr_b16 v[140:141], v38 offset:24576
    v_mfma_f32_16x16x32_bf16 v[200:203], v[156:159], v[120:123], v[200:203]
    ds_read_b64_tr_b16 v[142:143], v38 offset:25088
    v_mfma_f32_16x16x32_bf16 v[220:223], v[160:163], v[120:123], v[220:223]
    ds_read_b64_tr_b16 v[144:145], v38 offset:32768
    v_mfma_f32_16x16x32_bf16 v[184:187], v[152:155], v[124:127], v[184:187]
    ds_read_b64_tr_b16 v[146:147], v38 offset:33280
    v_mfma_f32_16x16x32_bf16 v[204:207], v[156:159], v[124:127], v[204:207]
    ds_read_b64_tr_b16 v[148:149], v38 offset:40960
    v_mfma_f32_16x16x32_bf16 v[224:227], v[160:163], v[124:127], v[224:227]
    ds_read_b64_tr_b16 v[150:151], v38 offset:41472
    v_mfma_f32_16x16x32_bf16 v[188:191], v[152:155], v[128:131], v[188:191]
    ds_read_b128 v[100:103], v32 offset:768
    v_mfma_f32_16x16x32_bf16 v[208:211], v[156:159], v[128:131], v[208:211]
    ds_read_b128 v[104:107], v32 offset:17152
    v_mfma_f32_16x16x32_bf16 v[228:231], v[160:163], v[128:131], v[228:231]
    ds_read_b128 v[108:111], v32 offset:33536
    v_mfma_f32_16x16x32_bf16 v[192:195], v[152:155], v[132:135], v[192:195]
    ds_read_b128 v[112:115], v32 offset:49920
    v_mfma_f32_16x16x32_bf16 v[212:215], v[156:159], v[132:135], v[212:215]
    ds_read_b128 v[116:119], v36 offset:768
    v_mfma_f32_16x16x32_bf16 v[232:235], v[160:163], v[132:135], v[232:235]
    v_mfma_f32_16x16x32_bf16 v[196:199], v[152:155], v[136:139], v[196:199]
    v_mfma_f32_16x16x32_bf16 v[216:219], v[156:159], v[136:139], v[216:219]
    v_mfma_f32_16x16x32_bf16 v[236:239], v[160:163], v[136:139], v[236:239]
    s_waitcnt lgkmcnt(0)
    v_mfma_f32_16x16x32_bf16 v[180:183], v[140:143], v[100:103], v[180:183]
    ds_read_b64_tr_b16 v[152:153], v38 offset:28672
    v_mfma_f32_16x16x32_bf16 v[200:203], v[144:147], v[100:103], v[200:203]
    ds_read_b64_tr_b16 v[154:155], v38 offset:29184
    v_mfma_f32_16x16x32_bf16 v[220:223], v[148:151], v[100:103], v[220:223]
    ds_read_b64_tr_b16 v[156:157], v38 offset:36864
    v_mfma_f32_16x16x32_bf16 v[184:187], v[140:143], v[104:107], v[184:187]
    ds_read_b64_tr_b16 v[158:159], v38 offset:37376
    v_mfma_f32_16x16x32_bf16 v[204:207], v[144:147], v[104:107], v[204:207]
    ds_read_b64_tr_b16 v[160:161], v38 offset:45056
    v_mfma_f32_16x16x32_bf16 v[224:227], v[148:151], v[104:107], v[224:227]
    ds_read_b64_tr_b16 v[162:163], v38 offset:45568
    v_mfma_f32_16x16x32_bf16 v[188:191], v[140:143], v[108:111], v[188:191]
    ds_read_b128 v[120:123], v33 offset:768
    v_mfma_f32_16x16x32_bf16 v[208:211], v[144:147], v[108:111], v[208:211]
    ds_read_b128 v[124:127], v33 offset:17152
    v_mfma_f32_16x16x32_bf16 v[228:231], v[148:151], v[108:111], v[228:231]
    ds_read_b128 v[128:131], v33 offset:33536
    v_mfma_f32_16x16x32_bf16 v[192:195], v[140:143], v[112:115], v[192:195]
    ds_read_b128 v[132:135], v33 offset:49920
    v_mfma_f32_16x16x32_bf16 v[212:215], v[144:147], v[112:115], v[212:215]
    ds_read_b128 v[136:139], v37 offset:768
    v_mfma_f32_16x16x32_bf16 v[232:235], v[148:151], v[112:115], v[232:235]
    v_mfma_f32_16x16x32_bf16 v[196:199], v[140:143], v[116:119], v[196:199]
    v_mfma_f32_16x16x32_bf16 v[216:219], v[144:147], v[116:119], v[216:219]
    v_mfma_f32_16x16x32_bf16 v[236:239], v[148:151], v[116:119], v[236:239]
    s_waitcnt lgkmcnt(0)
    v_mfma_f32_16x16x32_bf16 v[180:183], v[152:155], v[120:123], v[180:183]
    v_mfma_f32_16x16x32_bf16 v[200:203], v[156:159], v[120:123], v[200:203]
    v_mfma_f32_16x16x32_bf16 v[220:223], v[160:163], v[120:123], v[220:223]
    v_mfma_f32_16x16x32_bf16 v[184:187], v[152:155], v[124:127], v[184:187]
    v_mfma_f32_16x16x32_bf16 v[204:207], v[156:159], v[124:127], v[204:207]
    v_mfma_f32_16x16x32_bf16 v[224:227], v[160:163], v[124:127], v[224:227]
    v_mfma_f32_16x16x32_bf16 v[188:191], v[152:155], v[128:131], v[188:191]
    v_mfma_f32_16x16x32_bf16 v[208:211], v[156:159], v[128:131], v[208:211]
    v_mfma_f32_16x16x32_bf16 v[228:231], v[160:163], v[128:131], v[228:231]
    v_mfma_f32_16x16x32_bf16 v[192:195], v[152:155], v[132:135], v[192:195]
    v_mfma_f32_16x16x32_bf16 v[212:215], v[156:159], v[132:135], v[212:215]
    v_mfma_f32_16x16x32_bf16 v[232:235], v[160:163], v[132:135], v[232:235]
    v_mfma_f32_16x16x32_bf16 v[196:199], v[152:155], v[136:139], v[196:199]
    v_mfma_f32_16x16x32_bf16 v[216:219], v[156:159], v[136:139], v[216:219]
    v_mfma_f32_16x16x32_bf16 v[236:239], v[160:163], v[136:139], v[236:239]
    s_nop 7
    s_nop 7
    s_barrier
    s_mul_i32 s28, s26, 16640
    v_mul_u32_u24 v40, 208, v5
    v_lshl_add_u32 v40, v6, 4, v40
    v_add_u32 v40, s28, v40
    ds_write_b128 v40, v[180:183] offset:0
    ds_write_b128 v40, v[184:187] offset:3328
    ds_write_b128 v40, v[188:191] offset:6656
    ds_write_b128 v40, v[192:195] offset:9984
    ds_write_b128 v40, v[196:199] offset:13312
    ds_write_b128 v40, v[200:203] offset:64
    ds_write_b128 v40, v[204:207] offset:3392
    ds_write_b128 v40, v[208:211] offset:6720
    ds_write_b128 v40, v[212:215] offset:10048
    ds_write_b128 v40, v[216:219] offset:13376
    ds_write_b128 v40, v[220:223] offset:128
    ds_write_b128 v40, v[224:227] offset:3456
    ds_write_b128 v40, v[228:231] offset:6784
    ds_write_b128 v40, v[232:235] offset:10112
    ds_write_b128 v40, v[236:239] offset:13440
    v_mul_u32_u24 v41, 208, v1
    v_add_u32 v41, s28, v41
    s_waitcnt lgkmcnt(0)
    ds_read_b128 v[44:47], v41 offset:3328
    ds_read_b128 v[48:51], v41 offset:3344
    ds_read_b128 v[52:55], v41 offset:3360
    ds_read_b128 v[56:59], v41 offset:3376
    ds_read_b128 v[100:103], v41 offset:3392
    ds_read_b128 v[104:107], v41 offset:3408
    ds_read_b128 v[108:111], v41 offset:3424
    ds_read_b128 v[112:115], v41 offset:3440
    ds_read_b128 v[116:119], v41 offset:2976
    ds_read_b128 v[120:123], v41 offset:2992
    ds_read_b128 v[124:127], v41 offset:3008
    ds_read_b128 v[128:131], v41 offset:3024
    ds_read_b128 v[132:135], v41 offset:2560
    ds_read_b128 v[136:139], v41 offset:2576
    ds_read_b128 v[140:143], v41 offset:2592
    ds_read_b128 v[144:147], v41 offset:2608
    ds_read_b128 v[148:151], v41 offset:2144
    ds_read_b128 v[152:155], v41 offset:2160
    ds_read_b128 v[156:159], v41 offset:2176
    ds_read_b128 v[160:163], v41 offset:2192
    s_waitcnt lgkmcnt(0)
    v_mul_f32 v60, v44, v100
    v_fmac_f32 v60, v45, v101
    v_fmac_f32 v60, v46, v102
    v_fmac_f32 v60, v47, v103
    v_fmac_f32 v60, v48, v104
    v_fmac_f32 v60, v49, v105
    v_fmac_f32 v60, v50, v106
    v_fmac_f32 v60, v51, v107
    v_fmac_f32 v60, v52, v108
    v_fmac_f32 v60, v53, v109
    v_fmac_f32 v60, v54, v110
    v_fmac_f32 v60, v55, v111
    v_fmac_f32 v60, v56, v112
    v_fmac_f32 v60, v57, v113
    v_fmac_f32 v60, v58, v114
    v_fmac_f32 v60, v59, v115
    v_mul_f32 v61, v44, v116
    v_fmac_f32 v61, v45, v117
    v_fmac_f32 v61, v46, v118
    v_fmac_f32 v61, v47, v119
    v_fmac_f32 v61, v48, v120
    v_fmac_f32 v61, v49, v121
    v_fmac_f32 v61, v50, v122
    v_fmac_f32 v61, v51, v123
    v_fmac_f32 v61, v52, v124
    v_fmac_f32 v61, v53, v125
    v_fmac_f32 v61, v54, v126
    v_fmac_f32 v61, v55, v127
    v_fmac_f32 v61, v56, v128
    v_fmac_f32 v61, v57, v129
    v_fmac_f32 v61, v58, v130
    v_fmac_f32 v61, v59, v131
    v_mul_f32 v62, v44, v132
    v_fmac_f32 v62, v45, v133
    v_fmac_f32 v62, v46, v134
    v_fmac_f32 v62, v47, v135
    v_fmac_f32 v62, v48, v136
    v_fmac_f32 v62, v49, v137
    v_fmac_f32 v62, v50, v138
    v_fmac_f32 v62, v51, v139
    v_fmac_f32 v62, v52, v140
    v_fmac_f32 v62, v53, v141
    v_fmac_f32 v62, v54, v142
    v_fmac_f32 v62, v55, v143
    v_fmac_f32 v62, v56, v144
    v_fmac_f32 v62, v57, v145
    v_fmac_f32 v62, v58, v146
    v_fmac_f32 v62, v59, v147
    v_mul_f32 v63, v44, v148
    v_fmac_f32 v63, v45, v149
    v_fmac_f32 v63, v46, v150
    v_fmac_f32 v63, v47, v151
    v_fmac_f32 v63, v48, v152
    v_fmac_f32 v63, v49, v153
    v_fmac_f32 v63, v50, v154
    v_fmac_f32 v63, v51, v155
    v_fmac_f32 v63, v52, v156
    v_fmac_f32 v63, v53, v157
    v_fmac_f32 v63, v54, v158
    v_fmac_f32 v63, v55, v159
    v_fmac_f32 v63, v56, v160
    v_fmac_f32 v63, v57, v161
    v_fmac_f32 v63, v58, v162
    v_fmac_f32 v63, v59, v163
    ds_read_b128 v[100:103], v41 offset:1728
    ds_read_b128 v[104:107], v41 offset:1744
    ds_read_b128 v[108:111], v41 offset:1760
    ds_read_b128 v[112:115], v41 offset:1776
    ds_read_b128 v[116:119], v41 offset:1312
    ds_read_b128 v[120:123], v41 offset:1328
    ds_read_b128 v[124:127], v41 offset:1344
    ds_read_b128 v[128:131], v41 offset:1360
    ds_read_b128 v[132:135], v41 offset:896
    ds_read_b128 v[136:139], v41 offset:912
    ds_read_b128 v[140:143], v41 offset:928
    ds_read_b128 v[144:147], v41 offset:944
    ds_read_b128 v[148:151], v41 offset:480
    ds_read_b128 v[152:155], v41 offset:496
    ds_read_b128 v[156:159], v41 offset:512
    ds_read_b128 v[160:163], v41 offset:528
    s_waitcnt lgkmcnt(0)
    v_mul_f32 v64, v44, v100
    v_fmac_f32 v64, v45, v101
    v_fmac_f32 v64, v46, v102
    v_fmac_f32 v64, v47, v103
    v_fmac_f32 v64, v48, v104
    v_fmac_f32 v64, v49, v105
    v_fmac_f32 v64, v50, v106
    v_fmac_f32 v64, v51, v107
    v_fmac_f32 v64, v52, v108
    v_fmac_f32 v64, v53, v109
    v_fmac_f32 v64, v54, v110
    v_fmac_f32 v64, v55, v111
    v_fmac_f32 v64, v56, v112
    v_fmac_f32 v64, v57, v113
    v_fmac_f32 v64, v58, v114
    v_fmac_f32 v64, v59, v115
    v_mul_f32 v65, v44, v116
    v_fmac_f32 v65, v45, v117
    v_fmac_f32 v65, v46, v118
    v_fmac_f32 v65, v47, v119
    v_fmac_f32 v65, v48, v120
    v_fmac_f32 v65, v49, v121
    v_fmac_f32 v65, v50, v122
    v_fmac_f32 v65, v51, v123
    v_fmac_f32 v65, v52, v124
    v_fmac_f32 v65, v53, v125
    v_fmac_f32 v65, v54, v126
    v_fmac_f32 v65, v55, v127
    v_fmac_f32 v65, v56, v128
    v_fmac_f32 v65, v57, v129
    v_fmac_f32 v65, v58, v130
    v_fmac_f32 v65, v59, v131
    v_mul_f32 v66, v44, v132
    v_fmac_f32 v66, v45, v133
    v_fmac_f32 v66, v46, v134
    v_fmac_f32 v66, v47, v135
    v_fmac_f32 v66, v48, v136
    v_fmac_f32 v66, v49, v137
    v_fmac_f32 v66, v50, v138
    v_fmac_f32 v66, v51, v139
    v_fmac_f32 v66, v52, v140
    v_fmac_f32 v66, v53, v141
    v_fmac_f32 v66, v54, v142
    v_fmac_f32 v66, v55, v143
    v_fmac_f32 v66, v56, v144
    v_fmac_f32 v66, v57, v145
    v_fmac_f32 v66, v58, v146
    v_fmac_f32 v66, v59, v147
    v_mul_f32 v67, v44, v148
    v_fmac_f32 v67, v45, v149
    v_fmac_f32 v67, v46, v150
    v_fmac_f32 v67, v47, v151
    v_fmac_f32 v67, v48, v152
    v_fmac_f32 v67, v49, v153
    v_fmac_f32 v67, v50, v154
    v_fmac_f32 v67, v51, v155
    v_fmac_f32 v67, v52, v156
    v_fmac_f32 v67, v53, v157
    v_fmac_f32 v67, v54, v158
    v_fmac_f32 v67, v55, v159
    v_fmac_f32 v67, v56, v160
    v_fmac_f32 v67, v57, v161
    v_fmac_f32 v67, v58, v162
    v_fmac_f32 v67, v59, v163
    ds_read_b128 v[100:103], v41 offset:3456
    ds_read_b128 v[104:107], v41 offset:3472
    ds_read_b128 v[108:111], v41 offset:3488
    ds_read_b128 v[112:115], v41 offset:3504
    ds_read_b128 v[116:119], v41 offset:3040
    ds_read_b128 v[120:123], v41 offset:3056
    ds_read_b128 v[124:127], v41 offset:3072
    ds_read_b128 v[128:131], v41 offset:3088
    ds_read_b128 v[132:135], v41 offset:2624
    ds_read_b128 v[136:139], v41 offset:2640
    ds_read_b128 v[140:143], v41 offset:2656
    ds_read_b128 v[144:147], v41 offset:2672
    ds_read_b128 v[148:151], v41 offset:2208
    ds_read_b128 v[152:155], v41 offset:2224
    ds_read_b128 v[156:159], v41 offset:2240
    ds_read_b128 v[160:163], v41 offset:2256
    s_lshl_b32 s29, s24, 6
    v_add_u32 v70, s29, v1
    v_mov_b32 v71, 0xce6e6b28
    v_mul_f32 v60, 0.25, v60
    v_mul_f32 v61, 0.25, v61
    v_mul_f32 v62, 0.25, v62
    v_mul_f32 v63, 0.25, v63
    v_mul_f32 v64, 0.25, v64
    v_mul_f32 v65, 0.25, v65
    v_mul_f32 v66, 0.25, v66
    v_mul_f32 v67, 0.25, v67
    v_cmp_le_u32 vcc, 2, v70
    s_nop 1
    v_cndmask_b32 v61, v71, v61, vcc
    v_cmp_le_u32 vcc, 4, v70
    s_nop 1
    v_cndmask_b32 v62, v71, v62, vcc
    v_cmp_le_u32 vcc, 6, v70
    s_nop 1
    v_cndmask_b32 v63, v71, v63, vcc
    v_cmp_le_u32 vcc, 8, v70
    s_nop 1
    v_cndmask_b32 v64, v71, v64, vcc
    v_cmp_le_u32 vcc, 10, v70
    s_nop 1
    v_cndmask_b32 v65, v71, v65, vcc
    v_cmp_le_u32 vcc, 12, v70
    s_nop 1
    v_cndmask_b32 v66, v71, v66, vcc
    v_cmp_le_u32 vcc, 14, v70
    s_nop 1
    v_cndmask_b32 v67, v71, v67, vcc
    v_max3_f32 v72, v60, v61, v62
    v_max3_f32 v72, v72, v63, v64
    v_max3_f32 v72, v72, v65, v66
    v_max_f32 v72, v72, v67
    v_sub_f32 v60, v60, v72
    v_sub_f32 v61, v61, v72
    v_sub_f32 v62, v62, v72
    v_sub_f32 v63, v63, v72
    v_sub_f32 v64, v64, v72
    v_sub_f32 v65, v65, v72
    v_sub_f32 v66, v66, v72
    v_sub_f32 v67, v67, v72
    v_mul_f32 v60, 0x3fb8aa3b, v60
    v_mul_f32 v61, 0x3fb8aa3b, v61
    v_mul_f32 v62, 0x3fb8aa3b, v62
    v_mul_f32 v63, 0x3fb8aa3b, v63
    v_mul_f32 v64, 0x3fb8aa3b, v64
    v_mul_f32 v65, 0x3fb8aa3b, v65
    v_mul_f32 v66, 0x3fb8aa3b, v66
    v_mul_f32 v67, 0x3fb8aa3b, v67
    v_exp_f32 v60, v60
    v_exp_f32 v61, v61
    v_exp_f32 v62, v62
    v_exp_f32 v63, v63
    v_exp_f32 v64, v64
    v_exp_f32 v65, v65
    v_exp_f32 v66, v66
    v_exp_f32 v67, v67
    s_nop 0
    v_add_f32 v72, v60, v61
    v_add_f32 v73, v62, v63
    v_add_f32 v74, v64, v65
    v_add_f32 v75, v66, v67
    v_add_f32 v72, v72, v73
    v_add_f32 v74, v74, v75
    v_add_f32 v72, v72, v74
    v_rcp_f32 v72, v72
    s_waitcnt lgkmcnt(0)
    v_mul_f32 v76, v60, v100
    v_mul_f32 v77, v60, v101
    v_mul_f32 v78, v60, v102
    v_mul_f32 v79, v60, v103
    v_mul_f32 v80, v60, v104
    v_mul_f32 v81, v60, v105
    v_mul_f32 v82, v60, v106
    v_mul_f32 v83, v60, v107
    v_mul_f32 v84, v60, v108
    v_mul_f32 v85, v60, v109
    v_mul_f32 v86, v60, v110
    v_mul_f32 v87, v60, v111
    v_mul_f32 v88, v60, v112
    v_mul_f32 v89, v60, v113
    v_mul_f32 v90, v60, v114
    v_mul_f32 v91, v60, v115
    v_fmac_f32 v76, v61, v116
    v_fmac_f32 v77, v61, v117
    v_fmac_f32 v78, v61, v118
    v_fmac_f32 v79, v61, v119
    v_fmac_f32 v80, v61, v120
    v_fmac_f32 v81, v61, v121
    v_fmac_f32 v82, v61, v122
    v_fmac_f32 v83, v61, v123
    v_fmac_f32 v84, v61, v124
    v_fmac_f32 v85, v61, v125
    v_fmac_f32 v86, v61, v126
    v_fmac_f32 v87, v61, v127
    v_fmac_f32 v88, v61, v128
    v_fmac_f32 v89, v61, v129
    v_fmac_f32 v90, v61, v130
    v_fmac_f32 v91, v61, v131
    v_fmac_f32 v76, v62, v132
    v_fmac_f32 v77, v62, v133
    v_fmac_f32 v78, v62, v134
    v_fmac_f32 v79, v62, v135
    v_fmac_f32 v80, v62, v136
    v_fmac_f32 v81, v62, v137
    v_fmac_f32 v82, v62, v138
    v_fmac_f32 v83, v62, v139
    v_fmac_f32 v84, v62, v140
    v_fmac_f32 v85, v62, v141
    v_fmac_f32 v86, v62, v142
    v_fmac_f32 v87, v62, v143
    v_fmac_f32 v88, v62, v144
    v_fmac_f32 v89, v62, v145
    v_fmac_f32 v90, v62, v146
    v_fmac_f32 v91, v62, v147
    v_fmac_f32 v76, v63, v148
    v_fmac_f32 v77, v63, v149
    v_fmac_f32 v78, v63, v150
    v_fmac_f32 v79, v63, v151
    v_fmac_f32 v80, v63, v152
    v_fmac_f32 v81, v63, v153
    v_fmac_f32 v82, v63, v154
    v_fmac_f32 v83, v63, v155
    v_fmac_f32 v84, v63, v156
    v_fmac_f32 v85, v63, v157
    v_fmac_f32 v86, v63, v158
    v_fmac_f32 v87, v63, v159
    v_fmac_f32 v88, v63, v160
    v_fmac_f32 v89, v63, v161
    v_fmac_f32 v90, v63, v162
    v_fmac_f32 v91, v63, v163
    ds_read_b128 v[100:103], v41 offset:1792
    ds_read_b128 v[104:107], v41 offset:1808
    ds_read_b128 v[108:111], v41 offset:1824
    ds_read_b128 v[112:115], v41 offset:1840
    ds_read_b128 v[116:119], v41 offset:1376
    ds_read_b128 v[120:123], v41 offset:1392
    ds_read_b128 v[124:127], v41 offset:1408
    ds_read_b128 v[128:131], v41 offset:1424
    ds_read_b128 v[132:135], v41 offset:960
    ds_read_b128 v[136:139], v41 offset:976
    ds_read_b128 v[140:143], v41 offset:992
    ds_read_b128 v[144:147], v41 offset:1008
    ds_read_b128 v[148:151], v41 offset:544
    ds_read_b128 v[152:155], v41 offset:560
    ds_read_b128 v[156:159], v41 offset:576
    ds_read_b128 v[160:163], v41 offset:592
    s_waitcnt lgkmcnt(0)
    v_fmac_f32 v76, v64, v100
    v_fmac_f32 v77, v64, v101
    v_fmac_f32 v78, v64, v102
    v_fmac_f32 v79, v64, v103
    v_fmac_f32 v80, v64, v104
    v_fmac_f32 v81, v64, v105
    v_fmac_f32 v82, v64, v106
    v_fmac_f32 v83, v64, v107
    v_fmac_f32 v84, v64, v108
    v_fmac_f32 v85, v64, v109
    v_fmac_f32 v86, v64, v110
    v_fmac_f32 v87, v64, v111
    v_fmac_f32 v88, v64, v112
    v_fmac_f32 v89, v64, v113
    v_fmac_f32 v90, v64, v114
    v_fmac_f32 v91, v64, v115
    v_fmac_f32 v76, v65, v116
    v_fmac_f32 v77, v65, v117
    v_fmac_f32 v78, v65, v118
    v_fmac_f32 v79, v65, v119
    v_fmac_f32 v80, v65, v120
    v_fmac_f32 v81, v65, v121
    v_fmac_f32 v82, v65, v122
    v_fmac_f32 v83, v65, v123
    v_fmac_f32 v84, v65, v124
    v_fmac_f32 v85, v65, v125
    v_fmac_f32 v86, v65, v126
    v_fmac_f32 v87, v65, v127
    v_fmac_f32 v88, v65, v128
    v_fmac_f32 v89, v65, v129
    v_fmac_f32 v90, v65, v130
    v_fmac_f32 v91, v65, v131
    v_fmac_f32 v76, v66, v132
    v_fmac_f32 v77, v66, v133
    v_fmac_f32 v78, v66, v134
    v_fmac_f32 v79, v66, v135
    v_fmac_f32 v80, v66, v136
    v_fmac_f32 v81, v66, v137
    v_fmac_f32 v82, v66, v138
    v_fmac_f32 v83, v66, v139
    v_fmac_f32 v84, v66, v140
    v_fmac_f32 v85, v66, v141
    v_fmac_f32 v86, v66, v142
    v_fmac_f32 v87, v66, v143
    v_fmac_f32 v88, v66, v144
    v_fmac_f32 v89, v66, v145
    v_fmac_f32 v90, v66, v146
    v_fmac_f32 v91, v66, v147
    v_fmac_f32 v76, v67, v148
    v_fmac_f32 v77, v67, v149
    v_fmac_f32 v78, v67, v150
    v_fmac_f32 v79, v67, v151
    v_fmac_f32 v80, v67, v152
    v_fmac_f32 v81, v67, v153
    v_fmac_f32 v82, v67, v154
    v_fmac_f32 v83, v67, v155
    v_fmac_f32 v84, v67, v156
    v_fmac_f32 v85, v67, v157
    v_fmac_f32 v86, v67, v158
    v_fmac_f32 v87, v67, v159
    v_fmac_f32 v88, v67, v160
    v_fmac_f32 v89, v67, v161
    v_fmac_f32 v90, v67, v162
    v_fmac_f32 v91, v67, v163
    v_mul_f32 v76, v76, v72
    v_mul_f32 v77, v77, v72
    v_mul_f32 v78, v78, v72
    v_mul_f32 v79, v79, v72
    v_mul_f32 v80, v80, v72
    v_mul_f32 v81, v81, v72
    v_mul_f32 v82, v82, v72
    v_mul_f32 v83, v83, v72
    v_mul_f32 v84, v84, v72
    v_mul_f32 v85, v85, v72
    v_mul_f32 v86, v86, v72
    v_mul_f32 v87, v87, v72
    v_mul_f32 v88, v88, v72
    v_mul_f32 v89, v89, v72
    v_mul_f32 v90, v90, v72
    v_mul_f32 v91, v91, v72
    v_cvt_pk_bf16_f32 v92, v76, v77
    v_cvt_pk_bf16_f32 v93, v78, v79
    v_cvt_pk_bf16_f32 v94, v80, v81
    v_cvt_pk_bf16_f32 v95, v82, v83
    v_cvt_pk_bf16_f32 v96, v84, v85
    v_cvt_pk_bf16_f32 v97, v86, v87
    v_cvt_pk_bf16_f32 v98, v88, v89
    v_cvt_pk_bf16_f32 v99, v90, v91
    s_lshl_b32 s29, s25, 2
    s_add_u32 s29, s29, s26
    s_lshl_b32 s29, s29, 5
    s_add_u32 s29, s29, 1048576
    v_lshlrev_b32 v70, 10, v70
    buffer_store_dwordx4 v[92:95], v70, s[20:23], s29 offen
    buffer_store_dwordx4 v[96:99], v70, s[20:23], s29 offen offset:16
    s_endpgm
K1_GEMV:
    s_load_dwordx2 s[8:9], s[0:1], 88
    s_sub_u32 s24, s2, 256
    s_cmp_ge_u32 s24, 14
    s_cselect_b32 s25, 1, 0
    s_mul_i32 s27, s25, 14
    s_sub_u32 s24, s24, s27
    s_load_dwordx2 s[4:5], s[0:1], 32
    s_load_dwordx2 s[6:7], s[0:1], 40
    v_and_b32 v1, 63, v0
    v_lshrrev_b32 v2, 6, v0
    s_nop 0
    v_readfirstlane_b32 s26, v2
    s_waitcnt lgkmcnt(0)
    s_cmp_eq_u32 s25, 1
    s_cselect_b32 s4, s6, s4
    s_cselect_b32 s5, s7, s5
    s_mov_b32 s12, s4
    s_mov_b32 s13, s5
    s_mov_b32 s14, 1835008
    s_mov_b32 s15, 0x00020000
    s_mov_b32 s20, s8
    s_mov_b32 s21, s9
    s_mov_b32 s22, 16777216
    s_mov_b32 s23, 0x00020000
    v_lshlrev_b32 v3, 2, v1
    s_mul_i32 s28, s26, 458752
    s_lshl_b32 s29, s24, 8
    s_add_u32 s28, s28, s29
    s_lshl_b32 s29, s26, 9
    s_add_u32 s30, s8, s29
    s_addc_u32 s31, s9, 0
    v_mov_b32 v40, 0
    v_mov_b32 v41, 0
    v_mov_b32 v42, 0
    v_mov_b32 v43, 0
    v_mov_b32 v44, 0
    v_mov_b32 v45, 0
    s_add_u32 s32, s28, 0
    buffer_load_dword v100, v3, s[12:15], s32 offen
    s_add_u32 s32, s28, 3584
    buffer_load_dword v101, v3, s[12:15], s32 offen
    s_add_u32 s32, s28, 7168
    buffer_load_dword v102, v3, s[12:15], s32 offen
    s_add_u32 s32, s28, 10752
    buffer_load_dword v103, v3, s[12:15], s32 offen
    s_add_u32 s32, s28, 14336
    buffer_load_dword v104, v3, s[12:15], s32 offen
    s_add_u32 s32, s28, 17920
    buffer_load_dword v105, v3, s[12:15], s32 offen
    s_add_u32 s32, s28, 21504
    buffer_load_dword v106, v3, s[12:15], s32 offen
    s_add_u32 s32, s28, 25088
    buffer_load_dword v107, v3, s[12:15], s32 offen
    s_add_u32 s32, s28, 28672
    buffer_load_dword v108, v3, s[12:15], s32 offen
    s_add_u32 s32, s28, 32256
    buffer_load_dword v109, v3, s[12:15], s32 offen
    s_add_u32 s32, s28, 35840
    buffer_load_dword v110, v3, s[12:15], s32 offen
    s_add_u32 s32, s28, 39424
    buffer_load_dword v111, v3, s[12:15], s32 offen
    s_add_u32 s32, s28, 43008
    buffer_load_dword v112, v3, s[12:15], s32 offen
    s_add_u32 s32, s28, 46592
    buffer_load_dword v113, v3, s[12:15], s32 offen
    s_add_u32 s32, s28, 50176
    buffer_load_dword v114, v3, s[12:15], s32 offen
    s_add_u32 s32, s28, 53760
    buffer_load_dword v115, v3, s[12:15], s32 offen
    s_add_u32 s32, s28, 57344
    buffer_load_dword v116, v3, s[12:15], s32 offen
    s_add_u32 s32, s28, 60928
    buffer_load_dword v117, v3, s[12:15], s32 offen
    s_add_u32 s32, s28, 64512
    buffer_load_dword v118, v3, s[12:15], s32 offen
    s_add_u32 s32, s28, 68096
    buffer_load_dword v119, v3, s[12:15], s32 offen
    s_add_u32 s32, s28, 71680
    buffer_load_dword v120, v3, s[12:15], s32 offen
    s_add_u32 s32, s28, 75264
    buffer_load_dword v121, v3, s[12:15], s32 offen
    s_add_u32 s32, s28, 78848
    buffer_load_dword v122, v3, s[12:15], s32 offen
    s_add_u32 s32, s28, 82432
    buffer_load_dword v123, v3, s[12:15], s32 offen
    s_add_u32 s32, s28, 86016
    buffer_load_dword v124, v3, s[12:15], s32 offen
    s_add_u32 s32, s28, 89600
    buffer_load_dword v125, v3, s[12:15], s32 offen
    s_add_u32 s32, s28, 93184
    buffer_load_dword v126, v3, s[12:15], s32 offen
    s_add_u32 s32, s28, 96768
    buffer_load_dword v127, v3, s[12:15], s32 offen
    s_add_u32 s32, s28, 100352
    buffer_load_dword v128, v3, s[12:15], s32 offen
    s_add_u32 s32, s28, 103936
    buffer_load_dword v129, v3, s[12:15], s32 offen
    s_add_u32 s32, s28, 107520
    buffer_load_dword v130, v3, s[12:15], s32 offen
    s_add_u32 s32, s28, 111104
    buffer_load_dword v131, v3, s[12:15], s32 offen
    s_add_u32 s32, s28, 114688
    buffer_load_dword v132, v3, s[12:15], s32 offen
    s_add_u32 s32, s28, 118272
    buffer_load_dword v133, v3, s[12:15], s32 offen
    s_add_u32 s32, s28, 121856
    buffer_load_dword v134, v3, s[12:15], s32 offen
    s_add_u32 s32, s28, 125440
    buffer_load_dword v135, v3, s[12:15], s32 offen
    s_add_u32 s32, s28, 129024
    buffer_load_dword v136, v3, s[12:15], s32 offen
    s_add_u32 s32, s28, 132608
    buffer_load_dword v137, v3, s[12:15], s32 offen
    s_add_u32 s32, s28, 136192
    buffer_load_dword v138, v3, s[12:15], s32 offen
    s_add_u32 s32, s28, 139776
    buffer_load_dword v139, v3, s[12:15], s32 offen
    s_add_u32 s32, s28, 143360
    buffer_load_dword v140, v3, s[12:15], s32 offen
    s_add_u32 s32, s28, 146944
    buffer_load_dword v141, v3, s[12:15], s32 offen
    s_add_u32 s32, s28, 150528
    buffer_load_dword v142, v3, s[12:15], s32 offen
    s_add_u32 s32, s28, 154112
    buffer_load_dword v143, v3, s[12:15], s32 offen
    s_add_u32 s32, s28, 157696
    buffer_load_dword v144, v3, s[12:15], s32 offen
    s_add_u32 s32, s28, 161280
    buffer_load_dword v145, v3, s[12:15], s32 offen
    s_add_u32 s32, s28, 164864
    buffer_load_dword v146, v3, s[12:15], s32 offen
    s_add_u32 s32, s28, 168448
    buffer_load_dword v147, v3, s[12:15], s32 offen
    s_add_u32 s32, s28, 172032
    buffer_load_dword v148, v3, s[12:15], s32 offen
    s_add_u32 s32, s28, 175616
    buffer_load_dword v149, v3, s[12:15], s32 offen
    s_add_u32 s32, s28, 179200
    buffer_load_dword v150, v3, s[12:15], s32 offen
    s_add_u32 s32, s28, 182784
    buffer_load_dword v151, v3, s[12:15], s32 offen
    s_add_u32 s32, s28, 186368
    buffer_load_dword v152, v3, s[12:15], s32 offen
    s_add_u32 s32, s28, 189952
    buffer_load_dword v153, v3, s[12:15], s32 offen
    s_add_u32 s32, s28, 193536
    buffer_load_dword v154, v3, s[12:15], s32 offen
    s_add_u32 s32, s28, 197120
    buffer_load_dword v155, v3, s[12:15], s32 offen
    s_add_u32 s32, s28, 200704
    buffer_load_dword v156, v3, s[12:15], s32 offen
    s_add_u32 s32, s28, 204288
    buffer_load_dword v157, v3, s[12:15], s32 offen
    s_add_u32 s32, s28, 207872
    buffer_load_dword v158, v3, s[12:15], s32 offen
    s_add_u32 s32, s28, 211456
    buffer_load_dword v159, v3, s[12:15], s32 offen
    s_add_u32 s32, s28, 215040
    buffer_load_dword v160, v3, s[12:15], s32 offen
    s_add_u32 s32, s28, 218624
    buffer_load_dword v161, v3, s[12:15], s32 offen
    s_add_u32 s32, s28, 222208
    buffer_load_dword v162, v3, s[12:15], s32 offen
    s_add_u32 s32, s28, 225792
    buffer_load_dword v163, v3, s[12:15], s32 offen
    s_add_u32 s32, s28, 229376
    buffer_load_dword v164, v3, s[12:15], s32 offen
    s_add_u32 s32, s28, 232960
    buffer_load_dword v165, v3, s[12:15], s32 offen
    s_add_u32 s32, s28, 236544
    buffer_load_dword v166, v3, s[12:15], s32 offen
    s_add_u32 s32, s28, 240128
    buffer_load_dword v167, v3, s[12:15], s32 offen
    s_add_u32 s32, s28, 243712
    buffer_load_dword v168, v3, s[12:15], s32 offen
    s_add_u32 s32, s28, 247296
    buffer_load_dword v169, v3, s[12:15], s32 offen
    s_add_u32 s32, s28, 250880
    buffer_load_dword v170, v3, s[12:15], s32 offen
    s_add_u32 s32, s28, 254464
    buffer_load_dword v171, v3, s[12:15], s32 offen
    s_add_u32 s32, s28, 258048
    buffer_load_dword v172, v3, s[12:15], s32 offen
    s_add_u32 s32, s28, 261632
    buffer_load_dword v173, v3, s[12:15], s32 offen
    s_add_u32 s32, s28, 265216
    buffer_load_dword v174, v3, s[12:15], s32 offen
    s_add_u32 s32, s28, 268800
    buffer_load_dword v175, v3, s[12:15], s32 offen
    s_add_u32 s32, s28, 272384
    buffer_load_dword v176, v3, s[12:15], s32 offen
    s_add_u32 s32, s28, 275968
    buffer_load_dword v177, v3, s[12:15], s32 offen
    s_add_u32 s32, s28, 279552
    buffer_load_dword v178, v3, s[12:15], s32 offen
    s_add_u32 s32, s28, 283136
    buffer_load_dword v179, v3, s[12:15], s32 offen
    s_add_u32 s32, s28, 286720
    buffer_load_dword v180, v3, s[12:15], s32 offen
    s_add_u32 s32, s28, 290304
    buffer_load_dword v181, v3, s[12:15], s32 offen
    s_add_u32 s32, s28, 293888
    buffer_load_dword v182, v3, s[12:15], s32 offen
    s_add_u32 s32, s28, 297472
    buffer_load_dword v183, v3, s[12:15], s32 offen
    s_add_u32 s32, s28, 301056
    buffer_load_dword v184, v3, s[12:15], s32 offen
    s_add_u32 s32, s28, 304640
    buffer_load_dword v185, v3, s[12:15], s32 offen
    s_add_u32 s32, s28, 308224
    buffer_load_dword v186, v3, s[12:15], s32 offen
    s_add_u32 s32, s28, 311808
    buffer_load_dword v187, v3, s[12:15], s32 offen
    s_add_u32 s32, s28, 315392
    buffer_load_dword v188, v3, s[12:15], s32 offen
    s_add_u32 s32, s28, 318976
    buffer_load_dword v189, v3, s[12:15], s32 offen
    s_add_u32 s32, s28, 322560
    buffer_load_dword v190, v3, s[12:15], s32 offen
    s_add_u32 s32, s28, 326144
    buffer_load_dword v191, v3, s[12:15], s32 offen
    s_add_u32 s32, s28, 329728
    buffer_load_dword v192, v3, s[12:15], s32 offen
    s_add_u32 s32, s28, 333312
    buffer_load_dword v193, v3, s[12:15], s32 offen
    s_add_u32 s32, s28, 336896
    buffer_load_dword v194, v3, s[12:15], s32 offen
    s_add_u32 s32, s28, 340480
    buffer_load_dword v195, v3, s[12:15], s32 offen
    s_add_u32 s32, s28, 344064
    buffer_load_dword v196, v3, s[12:15], s32 offen
    s_add_u32 s32, s28, 347648
    buffer_load_dword v197, v3, s[12:15], s32 offen
    s_add_u32 s32, s28, 351232
    buffer_load_dword v198, v3, s[12:15], s32 offen
    s_add_u32 s32, s28, 354816
    buffer_load_dword v199, v3, s[12:15], s32 offen
    s_add_u32 s32, s28, 358400
    buffer_load_dword v200, v3, s[12:15], s32 offen
    s_add_u32 s32, s28, 361984
    buffer_load_dword v201, v3, s[12:15], s32 offen
    s_add_u32 s32, s28, 365568
    buffer_load_dword v202, v3, s[12:15], s32 offen
    s_add_u32 s32, s28, 369152
    buffer_load_dword v203, v3, s[12:15], s32 offen
    s_add_u32 s32, s28, 372736
    buffer_load_dword v204, v3, s[12:15], s32 offen
    s_add_u32 s32, s28, 376320
    buffer_load_dword v205, v3, s[12:15], s32 offen
    s_add_u32 s32, s28, 379904
    buffer_load_dword v206, v3, s[12:15], s32 offen
    s_add_u32 s32, s28, 383488
    buffer_load_dword v207, v3, s[12:15], s32 offen
    s_add_u32 s32, s28, 387072
    buffer_load_dword v208, v3, s[12:15], s32 offen
    s_add_u32 s32, s28, 390656
    buffer_load_dword v209, v3, s[12:15], s32 offen
    s_add_u32 s32, s28, 394240
    buffer_load_dword v210, v3, s[12:15], s32 offen
    s_add_u32 s32, s28, 397824
    buffer_load_dword v211, v3, s[12:15], s32 offen
    s_add_u32 s32, s28, 401408
    buffer_load_dword v212, v3, s[12:15], s32 offen
    s_add_u32 s32, s28, 404992
    buffer_load_dword v213, v3, s[12:15], s32 offen
    s_add_u32 s32, s28, 408576
    buffer_load_dword v214, v3, s[12:15], s32 offen
    s_add_u32 s32, s28, 412160
    buffer_load_dword v215, v3, s[12:15], s32 offen
    s_add_u32 s32, s28, 415744
    buffer_load_dword v216, v3, s[12:15], s32 offen
    s_add_u32 s32, s28, 419328
    buffer_load_dword v217, v3, s[12:15], s32 offen
    s_add_u32 s32, s28, 422912
    buffer_load_dword v218, v3, s[12:15], s32 offen
    s_add_u32 s32, s28, 426496
    buffer_load_dword v219, v3, s[12:15], s32 offen
    s_add_u32 s32, s28, 430080
    buffer_load_dword v220, v3, s[12:15], s32 offen
    s_add_u32 s32, s28, 433664
    buffer_load_dword v221, v3, s[12:15], s32 offen
    s_add_u32 s32, s28, 437248
    buffer_load_dword v222, v3, s[12:15], s32 offen
    s_add_u32 s32, s28, 440832
    buffer_load_dword v223, v3, s[12:15], s32 offen
    s_add_u32 s32, s28, 444416
    buffer_load_dword v224, v3, s[12:15], s32 offen
    s_add_u32 s32, s28, 448000
    buffer_load_dword v225, v3, s[12:15], s32 offen
    s_add_u32 s32, s28, 451584
    buffer_load_dword v226, v3, s[12:15], s32 offen
    s_add_u32 s32, s28, 455168
    buffer_load_dword v227, v3, s[12:15], s32 offen
    s_load_dwordx16 s[40:55], s[30:31], 8192
    s_load_dwordx16 s[56:71], s[30:31], 6144
    s_waitcnt lgkmcnt(0)
    s_waitcnt vmcnt(63)
    v_lshlrev_b32 v70, 16, v100
    v_and_b32 v71, 0xffff0000, v100
    v_add_f32 v40, v40, v70
    v_add_f32 v41, v41, v71
    v_fmac_f32 v42, s40, v70
    v_fmac_f32 v43, s40, v71
    v_fmac_f32 v44, s56, v70
    v_fmac_f32 v45, s56, v71
    s_waitcnt vmcnt(63)
    v_lshlrev_b32 v70, 16, v101
    v_and_b32 v71, 0xffff0000, v101
    v_add_f32 v40, v40, v70
    v_add_f32 v41, v41, v71
    v_fmac_f32 v42, s41, v70
    v_fmac_f32 v43, s41, v71
    v_fmac_f32 v44, s57, v70
    v_fmac_f32 v45, s57, v71
    s_waitcnt vmcnt(63)
    v_lshlrev_b32 v70, 16, v102
    v_and_b32 v71, 0xffff0000, v102
    v_add_f32 v40, v40, v70
    v_add_f32 v41, v41, v71
    v_fmac_f32 v42, s42, v70
    v_fmac_f32 v43, s42, v71
    v_fmac_f32 v44, s58, v70
    v_fmac_f32 v45, s58, v71
    s_waitcnt vmcnt(63)
    v_lshlrev_b32 v70, 16, v103
    v_and_b32 v71, 0xffff0000, v103
    v_add_f32 v40, v40, v70
    v_add_f32 v41, v41, v71
    v_fmac_f32 v42, s43, v70
    v_fmac_f32 v43, s43, v71
    v_fmac_f32 v44, s59, v70
    v_fmac_f32 v45, s59, v71
    s_waitcnt vmcnt(63)
    v_lshlrev_b32 v70, 16, v104
    v_and_b32 v71, 0xffff0000, v104
    v_add_f32 v40, v40, v70
    v_add_f32 v41, v41, v71
    v_fmac_f32 v42, s44, v70
    v_fmac_f32 v43, s44, v71
    v_fmac_f32 v44, s60, v70
    v_fmac_f32 v45, s60, v71
    s_waitcnt vmcnt(63)
    v_lshlrev_b32 v70, 16, v105
    v_and_b32 v71, 0xffff0000, v105
    v_add_f32 v40, v40, v70
    v_add_f32 v41, v41, v71
    v_fmac_f32 v42, s45, v70
    v_fmac_f32 v43, s45, v71
    v_fmac_f32 v44, s61, v70
    v_fmac_f32 v45, s61, v71
    s_waitcnt vmcnt(63)
    v_lshlrev_b32 v70, 16, v106
    v_and_b32 v71, 0xffff0000, v106
    v_add_f32 v40, v40, v70
    v_add_f32 v41, v41, v71
    v_fmac_f32 v42, s46, v70
    v_fmac_f32 v43, s46, v71
    v_fmac_f32 v44, s62, v70
    v_fmac_f32 v45, s62, v71
    s_waitcnt vmcnt(63)
    v_lshlrev_b32 v70, 16, v107
    v_and_b32 v71, 0xffff0000, v107
    v_add_f32 v40, v40, v70
    v_add_f32 v41, v41, v71
    v_fmac_f32 v42, s47, v70
    v_fmac_f32 v43, s47, v71
    v_fmac_f32 v44, s63, v70
    v_fmac_f32 v45, s63, v71
    s_waitcnt vmcnt(63)
    v_lshlrev_b32 v70, 16, v108
    v_and_b32 v71, 0xffff0000, v108
    v_add_f32 v40, v40, v70
    v_add_f32 v41, v41, v71
    v_fmac_f32 v42, s48, v70
    v_fmac_f32 v43, s48, v71
    v_fmac_f32 v44, s64, v70
    v_fmac_f32 v45, s64, v71
    s_waitcnt vmcnt(63)
    v_lshlrev_b32 v70, 16, v109
    v_and_b32 v71, 0xffff0000, v109
    v_add_f32 v40, v40, v70
    v_add_f32 v41, v41, v71
    v_fmac_f32 v42, s49, v70
    v_fmac_f32 v43, s49, v71
    v_fmac_f32 v44, s65, v70
    v_fmac_f32 v45, s65, v71
    s_waitcnt vmcnt(63)
    v_lshlrev_b32 v70, 16, v110
    v_and_b32 v71, 0xffff0000, v110
    v_add_f32 v40, v40, v70
    v_add_f32 v41, v41, v71
    v_fmac_f32 v42, s50, v70
    v_fmac_f32 v43, s50, v71
    v_fmac_f32 v44, s66, v70
    v_fmac_f32 v45, s66, v71
    s_waitcnt vmcnt(63)
    v_lshlrev_b32 v70, 16, v111
    v_and_b32 v71, 0xffff0000, v111
    v_add_f32 v40, v40, v70
    v_add_f32 v41, v41, v71
    v_fmac_f32 v42, s51, v70
    v_fmac_f32 v43, s51, v71
    v_fmac_f32 v44, s67, v70
    v_fmac_f32 v45, s67, v71
    s_waitcnt vmcnt(63)
    v_lshlrev_b32 v70, 16, v112
    v_and_b32 v71, 0xffff0000, v112
    v_add_f32 v40, v40, v70
    v_add_f32 v41, v41, v71
    v_fmac_f32 v42, s52, v70
    v_fmac_f32 v43, s52, v71
    v_fmac_f32 v44, s68, v70
    v_fmac_f32 v45, s68, v71
    s_waitcnt vmcnt(63)
    v_lshlrev_b32 v70, 16, v113
    v_and_b32 v71, 0xffff0000, v113
    v_add_f32 v40, v40, v70
    v_add_f32 v41, v41, v71
    v_fmac_f32 v42, s53, v70
    v_fmac_f32 v43, s53, v71
    v_fmac_f32 v44, s69, v70
    v_fmac_f32 v45, s69, v71
    s_waitcnt vmcnt(63)
    v_lshlrev_b32 v70, 16, v114
    v_and_b32 v71, 0xffff0000, v114
    v_add_f32 v40, v40, v70
    v_add_f32 v41, v41, v71
    v_fmac_f32 v42, s54, v70
    v_fmac_f32 v43, s54, v71
    v_fmac_f32 v44, s70, v70
    v_fmac_f32 v45, s70, v71
    s_waitcnt vmcnt(63)
    v_lshlrev_b32 v70, 16, v115
    v_and_b32 v71, 0xffff0000, v115
    v_add_f32 v40, v40, v70
    v_add_f32 v41, v41, v71
    v_fmac_f32 v42, s55, v70
    v_fmac_f32 v43, s55, v71
    v_fmac_f32 v44, s71, v70
    v_fmac_f32 v45, s71, v71
    s_load_dwordx16 s[40:55], s[30:31], 8256
    s_load_dwordx16 s[56:71], s[30:31], 6208
    s_waitcnt lgkmcnt(0)
    s_waitcnt vmcnt(63)
    v_lshlrev_b32 v70, 16, v116
    v_and_b32 v71, 0xffff0000, v116
    v_add_f32 v40, v40, v70
    v_add_f32 v41, v41, v71
    v_fmac_f32 v42, s40, v70
    v_fmac_f32 v43, s40, v71
    v_fmac_f32 v44, s56, v70
    v_fmac_f32 v45, s56, v71
    s_waitcnt vmcnt(63)
    v_lshlrev_b32 v70, 16, v117
    v_and_b32 v71, 0xffff0000, v117
    v_add_f32 v40, v40, v70
    v_add_f32 v41, v41, v71
    v_fmac_f32 v42, s41, v70
    v_fmac_f32 v43, s41, v71
    v_fmac_f32 v44, s57, v70
    v_fmac_f32 v45, s57, v71
    s_waitcnt vmcnt(63)
    v_lshlrev_b32 v70, 16, v118
    v_and_b32 v71, 0xffff0000, v118
    v_add_f32 v40, v40, v70
    v_add_f32 v41, v41, v71
    v_fmac_f32 v42, s42, v70
    v_fmac_f32 v43, s42, v71
    v_fmac_f32 v44, s58, v70
    v_fmac_f32 v45, s58, v71
    s_waitcnt vmcnt(63)
    v_lshlrev_b32 v70, 16, v119
    v_and_b32 v71, 0xffff0000, v119
    v_add_f32 v40, v40, v70
    v_add_f32 v41, v41, v71
    v_fmac_f32 v42, s43, v70
    v_fmac_f32 v43, s43, v71
    v_fmac_f32 v44, s59, v70
    v_fmac_f32 v45, s59, v71
    s_waitcnt vmcnt(63)
    v_lshlrev_b32 v70, 16, v120
    v_and_b32 v71, 0xffff0000, v120
    v_add_f32 v40, v40, v70
    v_add_f32 v41, v41, v71
    v_fmac_f32 v42, s44, v70
    v_fmac_f32 v43, s44, v71
    v_fmac_f32 v44, s60, v70
    v_fmac_f32 v45, s60, v71
    s_waitcnt vmcnt(63)
    v_lshlrev_b32 v70, 16, v121
    v_and_b32 v71, 0xffff0000, v121
    v_add_f32 v40, v40, v70
    v_add_f32 v41, v41, v71
    v_fmac_f32 v42, s45, v70
    v_fmac_f32 v43, s45, v71
    v_fmac_f32 v44, s61, v70
    v_fmac_f32 v45, s61, v71
    s_waitcnt vmcnt(63)
    v_lshlrev_b32 v70, 16, v122
    v_and_b32 v71, 0xffff0000, v122
    v_add_f32 v40, v40, v70
    v_add_f32 v41, v41, v71
    v_fmac_f32 v42, s46, v70
    v_fmac_f32 v43, s46, v71
    v_fmac_f32 v44, s62, v70
    v_fmac_f32 v45, s62, v71
    s_waitcnt vmcnt(63)
    v_lshlrev_b32 v70, 16, v123
    v_and_b32 v71, 0xffff0000, v123
    v_add_f32 v40, v40, v70
    v_add_f32 v41, v41, v71
    v_fmac_f32 v42, s47, v70
    v_fmac_f32 v43, s47, v71
    v_fmac_f32 v44, s63, v70
    v_fmac_f32 v45, s63, v71
    s_waitcnt vmcnt(63)
    v_lshlrev_b32 v70, 16, v124
    v_and_b32 v71, 0xffff0000, v124
    v_add_f32 v40, v40, v70
    v_add_f32 v41, v41, v71
    v_fmac_f32 v42, s48, v70
    v_fmac_f32 v43, s48, v71
    v_fmac_f32 v44, s64, v70
    v_fmac_f32 v45, s64, v71
    s_waitcnt vmcnt(63)
    v_lshlrev_b32 v70, 16, v125
    v_and_b32 v71, 0xffff0000, v125
    v_add_f32 v40, v40, v70
    v_add_f32 v41, v41, v71
    v_fmac_f32 v42, s49, v70
    v_fmac_f32 v43, s49, v71
    v_fmac_f32 v44, s65, v70
    v_fmac_f32 v45, s65, v71
    s_waitcnt vmcnt(63)
    v_lshlrev_b32 v70, 16, v126
    v_and_b32 v71, 0xffff0000, v126
    v_add_f32 v40, v40, v70
    v_add_f32 v41, v41, v71
    v_fmac_f32 v42, s50, v70
    v_fmac_f32 v43, s50, v71
    v_fmac_f32 v44, s66, v70
    v_fmac_f32 v45, s66, v71
    s_waitcnt vmcnt(63)
    v_lshlrev_b32 v70, 16, v127
    v_and_b32 v71, 0xffff0000, v127
    v_add_f32 v40, v40, v70
    v_add_f32 v41, v41, v71
    v_fmac_f32 v42, s51, v70
    v_fmac_f32 v43, s51, v71
    v_fmac_f32 v44, s67, v70
    v_fmac_f32 v45, s67, v71
    s_waitcnt vmcnt(63)
    v_lshlrev_b32 v70, 16, v128
    v_and_b32 v71, 0xffff0000, v128
    v_add_f32 v40, v40, v70
    v_add_f32 v41, v41, v71
    v_fmac_f32 v42, s52, v70
    v_fmac_f32 v43, s52, v71
    v_fmac_f32 v44, s68, v70
    v_fmac_f32 v45, s68, v71
    s_waitcnt vmcnt(63)
    v_lshlrev_b32 v70, 16, v129
    v_and_b32 v71, 0xffff0000, v129
    v_add_f32 v40, v40, v70
    v_add_f32 v41, v41, v71
    v_fmac_f32 v42, s53, v70
    v_fmac_f32 v43, s53, v71
    v_fmac_f32 v44, s69, v70
    v_fmac_f32 v45, s69, v71
    s_waitcnt vmcnt(63)
    v_lshlrev_b32 v70, 16, v130
    v_and_b32 v71, 0xffff0000, v130
    v_add_f32 v40, v40, v70
    v_add_f32 v41, v41, v71
    v_fmac_f32 v42, s54, v70
    v_fmac_f32 v43, s54, v71
    v_fmac_f32 v44, s70, v70
    v_fmac_f32 v45, s70, v71
    s_waitcnt vmcnt(63)
    v_lshlrev_b32 v70, 16, v131
    v_and_b32 v71, 0xffff0000, v131
    v_add_f32 v40, v40, v70
    v_add_f32 v41, v41, v71
    v_fmac_f32 v42, s55, v70
    v_fmac_f32 v43, s55, v71
    v_fmac_f32 v44, s71, v70
    v_fmac_f32 v45, s71, v71
    s_load_dwordx16 s[40:55], s[30:31], 8320
    s_load_dwordx16 s[56:71], s[30:31], 6272
    s_waitcnt lgkmcnt(0)
    s_waitcnt vmcnt(63)
    v_lshlrev_b32 v70, 16, v132
    v_and_b32 v71, 0xffff0000, v132
    v_add_f32 v40, v40, v70
    v_add_f32 v41, v41, v71
    v_fmac_f32 v42, s40, v70
    v_fmac_f32 v43, s40, v71
    v_fmac_f32 v44, s56, v70
    v_fmac_f32 v45, s56, v71
    s_waitcnt vmcnt(63)
    v_lshlrev_b32 v70, 16, v133
    v_and_b32 v71, 0xffff0000, v133
    v_add_f32 v40, v40, v70
    v_add_f32 v41, v41, v71
    v_fmac_f32 v42, s41, v70
    v_fmac_f32 v43, s41, v71
    v_fmac_f32 v44, s57, v70
    v_fmac_f32 v45, s57, v71
    s_waitcnt vmcnt(63)
    v_lshlrev_b32 v70, 16, v134
    v_and_b32 v71, 0xffff0000, v134
    v_add_f32 v40, v40, v70
    v_add_f32 v41, v41, v71
    v_fmac_f32 v42, s42, v70
    v_fmac_f32 v43, s42, v71
    v_fmac_f32 v44, s58, v70
    v_fmac_f32 v45, s58, v71
    s_waitcnt vmcnt(63)
    v_lshlrev_b32 v70, 16, v135
    v_and_b32 v71, 0xffff0000, v135
    v_add_f32 v40, v40, v70
    v_add_f32 v41, v41, v71
    v_fmac_f32 v42, s43, v70
    v_fmac_f32 v43, s43, v71
    v_fmac_f32 v44, s59, v70
    v_fmac_f32 v45, s59, v71
    s_waitcnt vmcnt(63)
    v_lshlrev_b32 v70, 16, v136
    v_and_b32 v71, 0xffff0000, v136
    v_add_f32 v40, v40, v70
    v_add_f32 v41, v41, v71
    v_fmac_f32 v42, s44, v70
    v_fmac_f32 v43, s44, v71
    v_fmac_f32 v44, s60, v70
    v_fmac_f32 v45, s60, v71
    s_waitcnt vmcnt(63)
    v_lshlrev_b32 v70, 16, v137
    v_and_b32 v71, 0xffff0000, v137
    v_add_f32 v40, v40, v70
    v_add_f32 v41, v41, v71
    v_fmac_f32 v42, s45, v70
    v_fmac_f32 v43, s45, v71
    v_fmac_f32 v44, s61, v70
    v_fmac_f32 v45, s61, v71
    s_waitcnt vmcnt(63)
    v_lshlrev_b32 v70, 16, v138
    v_and_b32 v71, 0xffff0000, v138
    v_add_f32 v40, v40, v70
    v_add_f32 v41, v41, v71
    v_fmac_f32 v42, s46, v70
    v_fmac_f32 v43, s46, v71
    v_fmac_f32 v44, s62, v70
    v_fmac_f32 v45, s62, v71
    s_waitcnt vmcnt(63)
    v_lshlrev_b32 v70, 16, v139
    v_and_b32 v71, 0xffff0000, v139
    v_add_f32 v40, v40, v70
    v_add_f32 v41, v41, v71
    v_fmac_f32 v42, s47, v70
    v_fmac_f32 v43, s47, v71
    v_fmac_f32 v44, s63, v70
    v_fmac_f32 v45, s63, v71
    s_waitcnt vmcnt(63)
    v_lshlrev_b32 v70, 16, v140
    v_and_b32 v71, 0xffff0000, v140
    v_add_f32 v40, v40, v70
    v_add_f32 v41, v41, v71
    v_fmac_f32 v42, s48, v70
    v_fmac_f32 v43, s48, v71
    v_fmac_f32 v44, s64, v70
    v_fmac_f32 v45, s64, v71
    s_waitcnt vmcnt(63)
    v_lshlrev_b32 v70, 16, v141
    v_and_b32 v71, 0xffff0000, v141
    v_add_f32 v40, v40, v70
    v_add_f32 v41, v41, v71
    v_fmac_f32 v42, s49, v70
    v_fmac_f32 v43, s49, v71
    v_fmac_f32 v44, s65, v70
    v_fmac_f32 v45, s65, v71
    s_waitcnt vmcnt(63)
    v_lshlrev_b32 v70, 16, v142
    v_and_b32 v71, 0xffff0000, v142
    v_add_f32 v40, v40, v70
    v_add_f32 v41, v41, v71
    v_fmac_f32 v42, s50, v70
    v_fmac_f32 v43, s50, v71
    v_fmac_f32 v44, s66, v70
    v_fmac_f32 v45, s66, v71
    s_waitcnt vmcnt(63)
    v_lshlrev_b32 v70, 16, v143
    v_and_b32 v71, 0xffff0000, v143
    v_add_f32 v40, v40, v70
    v_add_f32 v41, v41, v71
    v_fmac_f32 v42, s51, v70
    v_fmac_f32 v43, s51, v71
    v_fmac_f32 v44, s67, v70
    v_fmac_f32 v45, s67, v71
    s_waitcnt vmcnt(63)
    v_lshlrev_b32 v70, 16, v144
    v_and_b32 v71, 0xffff0000, v144
    v_add_f32 v40, v40, v70
    v_add_f32 v41, v41, v71
    v_fmac_f32 v42, s52, v70
    v_fmac_f32 v43, s52, v71
    v_fmac_f32 v44, s68, v70
    v_fmac_f32 v45, s68, v71
    s_waitcnt vmcnt(63)
    v_lshlrev_b32 v70, 16, v145
    v_and_b32 v71, 0xffff0000, v145
    v_add_f32 v40, v40, v70
    v_add_f32 v41, v41, v71
    v_fmac_f32 v42, s53, v70
    v_fmac_f32 v43, s53, v71
    v_fmac_f32 v44, s69, v70
    v_fmac_f32 v45, s69, v71
    s_waitcnt vmcnt(63)
    v_lshlrev_b32 v70, 16, v146
    v_and_b32 v71, 0xffff0000, v146
    v_add_f32 v40, v40, v70
    v_add_f32 v41, v41, v71
    v_fmac_f32 v42, s54, v70
    v_fmac_f32 v43, s54, v71
    v_fmac_f32 v44, s70, v70
    v_fmac_f32 v45, s70, v71
    s_waitcnt vmcnt(63)
    v_lshlrev_b32 v70, 16, v147
    v_and_b32 v71, 0xffff0000, v147
    v_add_f32 v40, v40, v70
    v_add_f32 v41, v41, v71
    v_fmac_f32 v42, s55, v70
    v_fmac_f32 v43, s55, v71
    v_fmac_f32 v44, s71, v70
    v_fmac_f32 v45, s71, v71
    s_load_dwordx16 s[40:55], s[30:31], 8384
    s_load_dwordx16 s[56:71], s[30:31], 6336
    s_waitcnt lgkmcnt(0)
    s_waitcnt vmcnt(63)
    v_lshlrev_b32 v70, 16, v148
    v_and_b32 v71, 0xffff0000, v148
    v_add_f32 v40, v40, v70
    v_add_f32 v41, v41, v71
    v_fmac_f32 v42, s40, v70
    v_fmac_f32 v43, s40, v71
    v_fmac_f32 v44, s56, v70
    v_fmac_f32 v45, s56, v71
    s_waitcnt vmcnt(63)
    v_lshlrev_b32 v70, 16, v149
    v_and_b32 v71, 0xffff0000, v149
    v_add_f32 v40, v40, v70
    v_add_f32 v41, v41, v71
    v_fmac_f32 v42, s41, v70
    v_fmac_f32 v43, s41, v71
    v_fmac_f32 v44, s57, v70
    v_fmac_f32 v45, s57, v71
    s_waitcnt vmcnt(63)
    v_lshlrev_b32 v70, 16, v150
    v_and_b32 v71, 0xffff0000, v150
    v_add_f32 v40, v40, v70
    v_add_f32 v41, v41, v71
    v_fmac_f32 v42, s42, v70
    v_fmac_f32 v43, s42, v71
    v_fmac_f32 v44, s58, v70
    v_fmac_f32 v45, s58, v71
    s_waitcnt vmcnt(63)
    v_lshlrev_b32 v70, 16, v151
    v_and_b32 v71, 0xffff0000, v151
    v_add_f32 v40, v40, v70
    v_add_f32 v41, v41, v71
    v_fmac_f32 v42, s43, v70
    v_fmac_f32 v43, s43, v71
    v_fmac_f32 v44, s59, v70
    v_fmac_f32 v45, s59, v71
    s_waitcnt vmcnt(63)
    v_lshlrev_b32 v70, 16, v152
    v_and_b32 v71, 0xffff0000, v152
    v_add_f32 v40, v40, v70
    v_add_f32 v41, v41, v71
    v_fmac_f32 v42, s44, v70
    v_fmac_f32 v43, s44, v71
    v_fmac_f32 v44, s60, v70
    v_fmac_f32 v45, s60, v71
    s_waitcnt vmcnt(63)
    v_lshlrev_b32 v70, 16, v153
    v_and_b32 v71, 0xffff0000, v153
    v_add_f32 v40, v40, v70
    v_add_f32 v41, v41, v71
    v_fmac_f32 v42, s45, v70
    v_fmac_f32 v43, s45, v71
    v_fmac_f32 v44, s61, v70
    v_fmac_f32 v45, s61, v71
    s_waitcnt vmcnt(63)
    v_lshlrev_b32 v70, 16, v154
    v_and_b32 v71, 0xffff0000, v154
    v_add_f32 v40, v40, v70
    v_add_f32 v41, v41, v71
    v_fmac_f32 v42, s46, v70
    v_fmac_f32 v43, s46, v71
    v_fmac_f32 v44, s62, v70
    v_fmac_f32 v45, s62, v71
    s_waitcnt vmcnt(63)
    v_lshlrev_b32 v70, 16, v155
    v_and_b32 v71, 0xffff0000, v155
    v_add_f32 v40, v40, v70
    v_add_f32 v41, v41, v71
    v_fmac_f32 v42, s47, v70
    v_fmac_f32 v43, s47, v71
    v_fmac_f32 v44, s63, v70
    v_fmac_f32 v45, s63, v71
    s_waitcnt vmcnt(63)
    v_lshlrev_b32 v70, 16, v156
    v_and_b32 v71, 0xffff0000, v156
    v_add_f32 v40, v40, v70
    v_add_f32 v41, v41, v71
    v_fmac_f32 v42, s48, v70
    v_fmac_f32 v43, s48, v71
    v_fmac_f32 v44, s64, v70
    v_fmac_f32 v45, s64, v71
    s_waitcnt vmcnt(63)
    v_lshlrev_b32 v70, 16, v157
    v_and_b32 v71, 0xffff0000, v157
    v_add_f32 v40, v40, v70
    v_add_f32 v41, v41, v71
    v_fmac_f32 v42, s49, v70
    v_fmac_f32 v43, s49, v71
    v_fmac_f32 v44, s65, v70
    v_fmac_f32 v45, s65, v71
    s_waitcnt vmcnt(63)
    v_lshlrev_b32 v70, 16, v158
    v_and_b32 v71, 0xffff0000, v158
    v_add_f32 v40, v40, v70
    v_add_f32 v41, v41, v71
    v_fmac_f32 v42, s50, v70
    v_fmac_f32 v43, s50, v71
    v_fmac_f32 v44, s66, v70
    v_fmac_f32 v45, s66, v71
    s_waitcnt vmcnt(63)
    v_lshlrev_b32 v70, 16, v159
    v_and_b32 v71, 0xffff0000, v159
    v_add_f32 v40, v40, v70
    v_add_f32 v41, v41, v71
    v_fmac_f32 v42, s51, v70
    v_fmac_f32 v43, s51, v71
    v_fmac_f32 v44, s67, v70
    v_fmac_f32 v45, s67, v71
    s_waitcnt vmcnt(63)
    v_lshlrev_b32 v70, 16, v160
    v_and_b32 v71, 0xffff0000, v160
    v_add_f32 v40, v40, v70
    v_add_f32 v41, v41, v71
    v_fmac_f32 v42, s52, v70
    v_fmac_f32 v43, s52, v71
    v_fmac_f32 v44, s68, v70
    v_fmac_f32 v45, s68, v71
    s_waitcnt vmcnt(63)
    v_lshlrev_b32 v70, 16, v161
    v_and_b32 v71, 0xffff0000, v161
    v_add_f32 v40, v40, v70
    v_add_f32 v41, v41, v71
    v_fmac_f32 v42, s53, v70
    v_fmac_f32 v43, s53, v71
    v_fmac_f32 v44, s69, v70
    v_fmac_f32 v45, s69, v71
    s_waitcnt vmcnt(63)
    v_lshlrev_b32 v70, 16, v162
    v_and_b32 v71, 0xffff0000, v162
    v_add_f32 v40, v40, v70
    v_add_f32 v41, v41, v71
    v_fmac_f32 v42, s54, v70
    v_fmac_f32 v43, s54, v71
    v_fmac_f32 v44, s70, v70
    v_fmac_f32 v45, s70, v71
    s_waitcnt vmcnt(63)
    v_lshlrev_b32 v70, 16, v163
    v_and_b32 v71, 0xffff0000, v163
    v_add_f32 v40, v40, v70
    v_add_f32 v41, v41, v71
    v_fmac_f32 v42, s55, v70
    v_fmac_f32 v43, s55, v71
    v_fmac_f32 v44, s71, v70
    v_fmac_f32 v45, s71, v71
    s_load_dwordx16 s[40:55], s[30:31], 8448
    s_load_dwordx16 s[56:71], s[30:31], 6400
    s_waitcnt lgkmcnt(0)
    s_waitcnt vmcnt(63)
    v_lshlrev_b32 v70, 16, v164
    v_and_b32 v71, 0xffff0000, v164
    v_add_f32 v40, v40, v70
    v_add_f32 v41, v41, v71
    v_fmac_f32 v42, s40, v70
    v_fmac_f32 v43, s40, v71
    v_fmac_f32 v44, s56, v70
    v_fmac_f32 v45, s56, v71
    s_waitcnt vmcnt(62)
    v_lshlrev_b32 v70, 16, v165
    v_and_b32 v71, 0xffff0000, v165
    v_add_f32 v40, v40, v70
    v_add_f32 v41, v41, v71
    v_fmac_f32 v42, s41, v70
    v_fmac_f32 v43, s41, v71
    v_fmac_f32 v44, s57, v70
    v_fmac_f32 v45, s57, v71
    s_waitcnt vmcnt(61)
    v_lshlrev_b32 v70, 16, v166
    v_and_b32 v71, 0xffff0000, v166
    v_add_f32 v40, v40, v70
    v_add_f32 v41, v41, v71
    v_fmac_f32 v42, s42, v70
    v_fmac_f32 v43, s42, v71
    v_fmac_f32 v44, s58, v70
    v_fmac_f32 v45, s58, v71
    s_waitcnt vmcnt(60)
    v_lshlrev_b32 v70, 16, v167
    v_and_b32 v71, 0xffff0000, v167
    v_add_f32 v40, v40, v70
    v_add_f32 v41, v41, v71
    v_fmac_f32 v42, s43, v70
    v_fmac_f32 v43, s43, v71
    v_fmac_f32 v44, s59, v70
    v_fmac_f32 v45, s59, v71
    s_waitcnt vmcnt(59)
    v_lshlrev_b32 v70, 16, v168
    v_and_b32 v71, 0xffff0000, v168
    v_add_f32 v40, v40, v70
    v_add_f32 v41, v41, v71
    v_fmac_f32 v42, s44, v70
    v_fmac_f32 v43, s44, v71
    v_fmac_f32 v44, s60, v70
    v_fmac_f32 v45, s60, v71
    s_waitcnt vmcnt(58)
    v_lshlrev_b32 v70, 16, v169
    v_and_b32 v71, 0xffff0000, v169
    v_add_f32 v40, v40, v70
    v_add_f32 v41, v41, v71
    v_fmac_f32 v42, s45, v70
    v_fmac_f32 v43, s45, v71
    v_fmac_f32 v44, s61, v70
    v_fmac_f32 v45, s61, v71
    s_waitcnt vmcnt(57)
    v_lshlrev_b32 v70, 16, v170
    v_and_b32 v71, 0xffff0000, v170
    v_add_f32 v40, v40, v70
    v_add_f32 v41, v41, v71
    v_fmac_f32 v42, s46, v70
    v_fmac_f32 v43, s46, v71
    v_fmac_f32 v44, s62, v70
    v_fmac_f32 v45, s62, v71
    s_waitcnt vmcnt(56)
    v_lshlrev_b32 v70, 16, v171
    v_and_b32 v71, 0xffff0000, v171
    v_add_f32 v40, v40, v70
    v_add_f32 v41, v41, v71
    v_fmac_f32 v42, s47, v70
    v_fmac_f32 v43, s47, v71
    v_fmac_f32 v44, s63, v70
    v_fmac_f32 v45, s63, v71
    s_waitcnt vmcnt(55)
    v_lshlrev_b32 v70, 16, v172
    v_and_b32 v71, 0xffff0000, v172
    v_add_f32 v40, v40, v70
    v_add_f32 v41, v41, v71
    v_fmac_f32 v42, s48, v70
    v_fmac_f32 v43, s48, v71
    v_fmac_f32 v44, s64, v70
    v_fmac_f32 v45, s64, v71
    s_waitcnt vmcnt(54)
    v_lshlrev_b32 v70, 16, v173
    v_and_b32 v71, 0xffff0000, v173
    v_add_f32 v40, v40, v70
    v_add_f32 v41, v41, v71
    v_fmac_f32 v42, s49, v70
    v_fmac_f32 v43, s49, v71
    v_fmac_f32 v44, s65, v70
    v_fmac_f32 v45, s65, v71
    s_waitcnt vmcnt(53)
    v_lshlrev_b32 v70, 16, v174
    v_and_b32 v71, 0xffff0000, v174
    v_add_f32 v40, v40, v70
    v_add_f32 v41, v41, v71
    v_fmac_f32 v42, s50, v70
    v_fmac_f32 v43, s50, v71
    v_fmac_f32 v44, s66, v70
    v_fmac_f32 v45, s66, v71
    s_waitcnt vmcnt(52)
    v_lshlrev_b32 v70, 16, v175
    v_and_b32 v71, 0xffff0000, v175
    v_add_f32 v40, v40, v70
    v_add_f32 v41, v41, v71
    v_fmac_f32 v42, s51, v70
    v_fmac_f32 v43, s51, v71
    v_fmac_f32 v44, s67, v70
    v_fmac_f32 v45, s67, v71
    s_waitcnt vmcnt(51)
    v_lshlrev_b32 v70, 16, v176
    v_and_b32 v71, 0xffff0000, v176
    v_add_f32 v40, v40, v70
    v_add_f32 v41, v41, v71
    v_fmac_f32 v42, s52, v70
    v_fmac_f32 v43, s52, v71
    v_fmac_f32 v44, s68, v70
    v_fmac_f32 v45, s68, v71
    s_waitcnt vmcnt(50)
    v_lshlrev_b32 v70, 16, v177
    v_and_b32 v71, 0xffff0000, v177
    v_add_f32 v40, v40, v70
    v_add_f32 v41, v41, v71
    v_fmac_f32 v42, s53, v70
    v_fmac_f32 v43, s53, v71
    v_fmac_f32 v44, s69, v70
    v_fmac_f32 v45, s69, v71
    s_waitcnt vmcnt(49)
    v_lshlrev_b32 v70, 16, v178
    v_and_b32 v71, 0xffff0000, v178
    v_add_f32 v40, v40, v70
    v_add_f32 v41, v41, v71
    v_fmac_f32 v42, s54, v70
    v_fmac_f32 v43, s54, v71
    v_fmac_f32 v44, s70, v70
    v_fmac_f32 v45, s70, v71
    s_waitcnt vmcnt(48)
    v_lshlrev_b32 v70, 16, v179
    v_and_b32 v71, 0xffff0000, v179
    v_add_f32 v40, v40, v70
    v_add_f32 v41, v41, v71
    v_fmac_f32 v42, s55, v70
    v_fmac_f32 v43, s55, v71
    v_fmac_f32 v44, s71, v70
    v_fmac_f32 v45, s71, v71
    s_load_dwordx16 s[40:55], s[30:31], 8512
    s_load_dwordx16 s[56:71], s[30:31], 6464
    s_waitcnt lgkmcnt(0)
    s_waitcnt vmcnt(47)
    v_lshlrev_b32 v70, 16, v180
    v_and_b32 v71, 0xffff0000, v180
    v_add_f32 v40, v40, v70
    v_add_f32 v41, v41, v71
    v_fmac_f32 v42, s40, v70
    v_fmac_f32 v43, s40, v71
    v_fmac_f32 v44, s56, v70
    v_fmac_f32 v45, s56, v71
    s_waitcnt vmcnt(46)
    v_lshlrev_b32 v70, 16, v181
    v_and_b32 v71, 0xffff0000, v181
    v_add_f32 v40, v40, v70
    v_add_f32 v41, v41, v71
    v_fmac_f32 v42, s41, v70
    v_fmac_f32 v43, s41, v71
    v_fmac_f32 v44, s57, v70
    v_fmac_f32 v45, s57, v71
    s_waitcnt vmcnt(45)
    v_lshlrev_b32 v70, 16, v182
    v_and_b32 v71, 0xffff0000, v182
    v_add_f32 v40, v40, v70
    v_add_f32 v41, v41, v71
    v_fmac_f32 v42, s42, v70
    v_fmac_f32 v43, s42, v71
    v_fmac_f32 v44, s58, v70
    v_fmac_f32 v45, s58, v71
    s_waitcnt vmcnt(44)
    v_lshlrev_b32 v70, 16, v183
    v_and_b32 v71, 0xffff0000, v183
    v_add_f32 v40, v40, v70
    v_add_f32 v41, v41, v71
    v_fmac_f32 v42, s43, v70
    v_fmac_f32 v43, s43, v71
    v_fmac_f32 v44, s59, v70
    v_fmac_f32 v45, s59, v71
    s_waitcnt vmcnt(43)
    v_lshlrev_b32 v70, 16, v184
    v_and_b32 v71, 0xffff0000, v184
    v_add_f32 v40, v40, v70
    v_add_f32 v41, v41, v71
    v_fmac_f32 v42, s44, v70
    v_fmac_f32 v43, s44, v71
    v_fmac_f32 v44, s60, v70
    v_fmac_f32 v45, s60, v71
    s_waitcnt vmcnt(42)
    v_lshlrev_b32 v70, 16, v185
    v_and_b32 v71, 0xffff0000, v185
    v_add_f32 v40, v40, v70
    v_add_f32 v41, v41, v71
    v_fmac_f32 v42, s45, v70
    v_fmac_f32 v43, s45, v71
    v_fmac_f32 v44, s61, v70
    v_fmac_f32 v45, s61, v71
    s_waitcnt vmcnt(41)
    v_lshlrev_b32 v70, 16, v186
    v_and_b32 v71, 0xffff0000, v186
    v_add_f32 v40, v40, v70
    v_add_f32 v41, v41, v71
    v_fmac_f32 v42, s46, v70
    v_fmac_f32 v43, s46, v71
    v_fmac_f32 v44, s62, v70
    v_fmac_f32 v45, s62, v71
    s_waitcnt vmcnt(40)
    v_lshlrev_b32 v70, 16, v187
    v_and_b32 v71, 0xffff0000, v187
    v_add_f32 v40, v40, v70
    v_add_f32 v41, v41, v71
    v_fmac_f32 v42, s47, v70
    v_fmac_f32 v43, s47, v71
    v_fmac_f32 v44, s63, v70
    v_fmac_f32 v45, s63, v71
    s_waitcnt vmcnt(39)
    v_lshlrev_b32 v70, 16, v188
    v_and_b32 v71, 0xffff0000, v188
    v_add_f32 v40, v40, v70
    v_add_f32 v41, v41, v71
    v_fmac_f32 v42, s48, v70
    v_fmac_f32 v43, s48, v71
    v_fmac_f32 v44, s64, v70
    v_fmac_f32 v45, s64, v71
    s_waitcnt vmcnt(38)
    v_lshlrev_b32 v70, 16, v189
    v_and_b32 v71, 0xffff0000, v189
    v_add_f32 v40, v40, v70
    v_add_f32 v41, v41, v71
    v_fmac_f32 v42, s49, v70
    v_fmac_f32 v43, s49, v71
    v_fmac_f32 v44, s65, v70
    v_fmac_f32 v45, s65, v71
    s_waitcnt vmcnt(37)
    v_lshlrev_b32 v70, 16, v190
    v_and_b32 v71, 0xffff0000, v190
    v_add_f32 v40, v40, v70
    v_add_f32 v41, v41, v71
    v_fmac_f32 v42, s50, v70
    v_fmac_f32 v43, s50, v71
    v_fmac_f32 v44, s66, v70
    v_fmac_f32 v45, s66, v71
    s_waitcnt vmcnt(36)
    v_lshlrev_b32 v70, 16, v191
    v_and_b32 v71, 0xffff0000, v191
    v_add_f32 v40, v40, v70
    v_add_f32 v41, v41, v71
    v_fmac_f32 v42, s51, v70
    v_fmac_f32 v43, s51, v71
    v_fmac_f32 v44, s67, v70
    v_fmac_f32 v45, s67, v71
    s_waitcnt vmcnt(35)
    v_lshlrev_b32 v70, 16, v192
    v_and_b32 v71, 0xffff0000, v192
    v_add_f32 v40, v40, v70
    v_add_f32 v41, v41, v71
    v_fmac_f32 v42, s52, v70
    v_fmac_f32 v43, s52, v71
    v_fmac_f32 v44, s68, v70
    v_fmac_f32 v45, s68, v71
    s_waitcnt vmcnt(34)
    v_lshlrev_b32 v70, 16, v193
    v_and_b32 v71, 0xffff0000, v193
    v_add_f32 v40, v40, v70
    v_add_f32 v41, v41, v71
    v_fmac_f32 v42, s53, v70
    v_fmac_f32 v43, s53, v71
    v_fmac_f32 v44, s69, v70
    v_fmac_f32 v45, s69, v71
    s_waitcnt vmcnt(33)
    v_lshlrev_b32 v70, 16, v194
    v_and_b32 v71, 0xffff0000, v194
    v_add_f32 v40, v40, v70
    v_add_f32 v41, v41, v71
    v_fmac_f32 v42, s54, v70
    v_fmac_f32 v43, s54, v71
    v_fmac_f32 v44, s70, v70
    v_fmac_f32 v45, s70, v71
    s_waitcnt vmcnt(32)
    v_lshlrev_b32 v70, 16, v195
    v_and_b32 v71, 0xffff0000, v195
    v_add_f32 v40, v40, v70
    v_add_f32 v41, v41, v71
    v_fmac_f32 v42, s55, v70
    v_fmac_f32 v43, s55, v71
    v_fmac_f32 v44, s71, v70
    v_fmac_f32 v45, s71, v71
    s_load_dwordx16 s[40:55], s[30:31], 8576
    s_load_dwordx16 s[56:71], s[30:31], 6528
    s_waitcnt lgkmcnt(0)
    s_waitcnt vmcnt(31)
    v_lshlrev_b32 v70, 16, v196
    v_and_b32 v71, 0xffff0000, v196
    v_add_f32 v40, v40, v70
    v_add_f32 v41, v41, v71
    v_fmac_f32 v42, s40, v70
    v_fmac_f32 v43, s40, v71
    v_fmac_f32 v44, s56, v70
    v_fmac_f32 v45, s56, v71
    s_waitcnt vmcnt(30)
    v_lshlrev_b32 v70, 16, v197
    v_and_b32 v71, 0xffff0000, v197
    v_add_f32 v40, v40, v70
    v_add_f32 v41, v41, v71
    v_fmac_f32 v42, s41, v70
    v_fmac_f32 v43, s41, v71
    v_fmac_f32 v44, s57, v70
    v_fmac_f32 v45, s57, v71
    s_waitcnt vmcnt(29)
    v_lshlrev_b32 v70, 16, v198
    v_and_b32 v71, 0xffff0000, v198
    v_add_f32 v40, v40, v70
    v_add_f32 v41, v41, v71
    v_fmac_f32 v42, s42, v70
    v_fmac_f32 v43, s42, v71
    v_fmac_f32 v44, s58, v70
    v_fmac_f32 v45, s58, v71
    s_waitcnt vmcnt(28)
    v_lshlrev_b32 v70, 16, v199
    v_and_b32 v71, 0xffff0000, v199
    v_add_f32 v40, v40, v70
    v_add_f32 v41, v41, v71
    v_fmac_f32 v42, s43, v70
    v_fmac_f32 v43, s43, v71
    v_fmac_f32 v44, s59, v70
    v_fmac_f32 v45, s59, v71
    s_waitcnt vmcnt(27)
    v_lshlrev_b32 v70, 16, v200
    v_and_b32 v71, 0xffff0000, v200
    v_add_f32 v40, v40, v70
    v_add_f32 v41, v41, v71
    v_fmac_f32 v42, s44, v70
    v_fmac_f32 v43, s44, v71
    v_fmac_f32 v44, s60, v70
    v_fmac_f32 v45, s60, v71
    s_waitcnt vmcnt(26)
    v_lshlrev_b32 v70, 16, v201
    v_and_b32 v71, 0xffff0000, v201
    v_add_f32 v40, v40, v70
    v_add_f32 v41, v41, v71
    v_fmac_f32 v42, s45, v70
    v_fmac_f32 v43, s45, v71
    v_fmac_f32 v44, s61, v70
    v_fmac_f32 v45, s61, v71
    s_waitcnt vmcnt(25)
    v_lshlrev_b32 v70, 16, v202
    v_and_b32 v71, 0xffff0000, v202
    v_add_f32 v40, v40, v70
    v_add_f32 v41, v41, v71
    v_fmac_f32 v42, s46, v70
    v_fmac_f32 v43, s46, v71
    v_fmac_f32 v44, s62, v70
    v_fmac_f32 v45, s62, v71
    s_waitcnt vmcnt(24)
    v_lshlrev_b32 v70, 16, v203
    v_and_b32 v71, 0xffff0000, v203
    v_add_f32 v40, v40, v70
    v_add_f32 v41, v41, v71
    v_fmac_f32 v42, s47, v70
    v_fmac_f32 v43, s47, v71
    v_fmac_f32 v44, s63, v70
    v_fmac_f32 v45, s63, v71
    s_waitcnt vmcnt(23)
    v_lshlrev_b32 v70, 16, v204
    v_and_b32 v71, 0xffff0000, v204
    v_add_f32 v40, v40, v70
    v_add_f32 v41, v41, v71
    v_fmac_f32 v42, s48, v70
    v_fmac_f32 v43, s48, v71
    v_fmac_f32 v44, s64, v70
    v_fmac_f32 v45, s64, v71
    s_waitcnt vmcnt(22)
    v_lshlrev_b32 v70, 16, v205
    v_and_b32 v71, 0xffff0000, v205
    v_add_f32 v40, v40, v70
    v_add_f32 v41, v41, v71
    v_fmac_f32 v42, s49, v70
    v_fmac_f32 v43, s49, v71
    v_fmac_f32 v44, s65, v70
    v_fmac_f32 v45, s65, v71
    s_waitcnt vmcnt(21)
    v_lshlrev_b32 v70, 16, v206
    v_and_b32 v71, 0xffff0000, v206
    v_add_f32 v40, v40, v70
    v_add_f32 v41, v41, v71
    v_fmac_f32 v42, s50, v70
    v_fmac_f32 v43, s50, v71
    v_fmac_f32 v44, s66, v70
    v_fmac_f32 v45, s66, v71
    s_waitcnt vmcnt(20)
    v_lshlrev_b32 v70, 16, v207
    v_and_b32 v71, 0xffff0000, v207
    v_add_f32 v40, v40, v70
    v_add_f32 v41, v41, v71
    v_fmac_f32 v42, s51, v70
    v_fmac_f32 v43, s51, v71
    v_fmac_f32 v44, s67, v70
    v_fmac_f32 v45, s67, v71
    s_waitcnt vmcnt(19)
    v_lshlrev_b32 v70, 16, v208
    v_and_b32 v71, 0xffff0000, v208
    v_add_f32 v40, v40, v70
    v_add_f32 v41, v41, v71
    v_fmac_f32 v42, s52, v70
    v_fmac_f32 v43, s52, v71
    v_fmac_f32 v44, s68, v70
    v_fmac_f32 v45, s68, v71
    s_waitcnt vmcnt(18)
    v_lshlrev_b32 v70, 16, v209
    v_and_b32 v71, 0xffff0000, v209
    v_add_f32 v40, v40, v70
    v_add_f32 v41, v41, v71
    v_fmac_f32 v42, s53, v70
    v_fmac_f32 v43, s53, v71
    v_fmac_f32 v44, s69, v70
    v_fmac_f32 v45, s69, v71
    s_waitcnt vmcnt(17)
    v_lshlrev_b32 v70, 16, v210
    v_and_b32 v71, 0xffff0000, v210
    v_add_f32 v40, v40, v70
    v_add_f32 v41, v41, v71
    v_fmac_f32 v42, s54, v70
    v_fmac_f32 v43, s54, v71
    v_fmac_f32 v44, s70, v70
    v_fmac_f32 v45, s70, v71
    s_waitcnt vmcnt(16)
    v_lshlrev_b32 v70, 16, v211
    v_and_b32 v71, 0xffff0000, v211
    v_add_f32 v40, v40, v70
    v_add_f32 v41, v41, v71
    v_fmac_f32 v42, s55, v70
    v_fmac_f32 v43, s55, v71
    v_fmac_f32 v44, s71, v70
    v_fmac_f32 v45, s71, v71
    s_load_dwordx16 s[40:55], s[30:31], 8640
    s_load_dwordx16 s[56:71], s[30:31], 6592
    s_waitcnt lgkmcnt(0)
    s_waitcnt vmcnt(15)
    v_lshlrev_b32 v70, 16, v212
    v_and_b32 v71, 0xffff0000, v212
    v_add_f32 v40, v40, v70
    v_add_f32 v41, v41, v71
    v_fmac_f32 v42, s40, v70
    v_fmac_f32 v43, s40, v71
    v_fmac_f32 v44, s56, v70
    v_fmac_f32 v45, s56, v71
    s_waitcnt vmcnt(14)
    v_lshlrev_b32 v70, 16, v213
    v_and_b32 v71, 0xffff0000, v213
    v_add_f32 v40, v40, v70
    v_add_f32 v41, v41, v71
    v_fmac_f32 v42, s41, v70
    v_fmac_f32 v43, s41, v71
    v_fmac_f32 v44, s57, v70
    v_fmac_f32 v45, s57, v71
    s_waitcnt vmcnt(13)
    v_lshlrev_b32 v70, 16, v214
    v_and_b32 v71, 0xffff0000, v214
    v_add_f32 v40, v40, v70
    v_add_f32 v41, v41, v71
    v_fmac_f32 v42, s42, v70
    v_fmac_f32 v43, s42, v71
    v_fmac_f32 v44, s58, v70
    v_fmac_f32 v45, s58, v71
    s_waitcnt vmcnt(12)
    v_lshlrev_b32 v70, 16, v215
    v_and_b32 v71, 0xffff0000, v215
    v_add_f32 v40, v40, v70
    v_add_f32 v41, v41, v71
    v_fmac_f32 v42, s43, v70
    v_fmac_f32 v43, s43, v71
    v_fmac_f32 v44, s59, v70
    v_fmac_f32 v45, s59, v71
    s_waitcnt vmcnt(11)
    v_lshlrev_b32 v70, 16, v216
    v_and_b32 v71, 0xffff0000, v216
    v_add_f32 v40, v40, v70
    v_add_f32 v41, v41, v71
    v_fmac_f32 v42, s44, v70
    v_fmac_f32 v43, s44, v71
    v_fmac_f32 v44, s60, v70
    v_fmac_f32 v45, s60, v71
    s_waitcnt vmcnt(10)
    v_lshlrev_b32 v70, 16, v217
    v_and_b32 v71, 0xffff0000, v217
    v_add_f32 v40, v40, v70
    v_add_f32 v41, v41, v71
    v_fmac_f32 v42, s45, v70
    v_fmac_f32 v43, s45, v71
    v_fmac_f32 v44, s61, v70
    v_fmac_f32 v45, s61, v71
    s_waitcnt vmcnt(9)
    v_lshlrev_b32 v70, 16, v218
    v_and_b32 v71, 0xffff0000, v218
    v_add_f32 v40, v40, v70
    v_add_f32 v41, v41, v71
    v_fmac_f32 v42, s46, v70
    v_fmac_f32 v43, s46, v71
    v_fmac_f32 v44, s62, v70
    v_fmac_f32 v45, s62, v71
    s_waitcnt vmcnt(8)
    v_lshlrev_b32 v70, 16, v219
    v_and_b32 v71, 0xffff0000, v219
    v_add_f32 v40, v40, v70
    v_add_f32 v41, v41, v71
    v_fmac_f32 v42, s47, v70
    v_fmac_f32 v43, s47, v71
    v_fmac_f32 v44, s63, v70
    v_fmac_f32 v45, s63, v71
    s_waitcnt vmcnt(7)
    v_lshlrev_b32 v70, 16, v220
    v_and_b32 v71, 0xffff0000, v220
    v_add_f32 v40, v40, v70
    v_add_f32 v41, v41, v71
    v_fmac_f32 v42, s48, v70
    v_fmac_f32 v43, s48, v71
    v_fmac_f32 v44, s64, v70
    v_fmac_f32 v45, s64, v71
    s_waitcnt vmcnt(6)
    v_lshlrev_b32 v70, 16, v221
    v_and_b32 v71, 0xffff0000, v221
    v_add_f32 v40, v40, v70
    v_add_f32 v41, v41, v71
    v_fmac_f32 v42, s49, v70
    v_fmac_f32 v43, s49, v71
    v_fmac_f32 v44, s65, v70
    v_fmac_f32 v45, s65, v71
    s_waitcnt vmcnt(5)
    v_lshlrev_b32 v70, 16, v222
    v_and_b32 v71, 0xffff0000, v222
    v_add_f32 v40, v40, v70
    v_add_f32 v41, v41, v71
    v_fmac_f32 v42, s50, v70
    v_fmac_f32 v43, s50, v71
    v_fmac_f32 v44, s66, v70
    v_fmac_f32 v45, s66, v71
    s_waitcnt vmcnt(4)
    v_lshlrev_b32 v70, 16, v223
    v_and_b32 v71, 0xffff0000, v223
    v_add_f32 v40, v40, v70
    v_add_f32 v41, v41, v71
    v_fmac_f32 v42, s51, v70
    v_fmac_f32 v43, s51, v71
    v_fmac_f32 v44, s67, v70
    v_fmac_f32 v45, s67, v71
    s_waitcnt vmcnt(3)
    v_lshlrev_b32 v70, 16, v224
    v_and_b32 v71, 0xffff0000, v224
    v_add_f32 v40, v40, v70
    v_add_f32 v41, v41, v71
    v_fmac_f32 v42, s52, v70
    v_fmac_f32 v43, s52, v71
    v_fmac_f32 v44, s68, v70
    v_fmac_f32 v45, s68, v71
    s_waitcnt vmcnt(2)
    v_lshlrev_b32 v70, 16, v225
    v_and_b32 v71, 0xffff0000, v225
    v_add_f32 v40, v40, v70
    v_add_f32 v41, v41, v71
    v_fmac_f32 v42, s53, v70
    v_fmac_f32 v43, s53, v71
    v_fmac_f32 v44, s69, v70
    v_fmac_f32 v45, s69, v71
    s_waitcnt vmcnt(1)
    v_lshlrev_b32 v70, 16, v226
    v_and_b32 v71, 0xffff0000, v226
    v_add_f32 v40, v40, v70
    v_add_f32 v41, v41, v71
    v_fmac_f32 v42, s54, v70
    v_fmac_f32 v43, s54, v71
    v_fmac_f32 v44, s70, v70
    v_fmac_f32 v45, s70, v71
    s_waitcnt vmcnt(0)
    v_lshlrev_b32 v70, 16, v227
    v_and_b32 v71, 0xffff0000, v227
    v_add_f32 v40, v40, v70
    v_add_f32 v41, v41, v71
    v_fmac_f32 v42, s55, v70
    v_fmac_f32 v43, s55, v71
    v_fmac_f32 v44, s71, v70
    v_fmac_f32 v45, s71, v71
    v_add_f32 v42, v42, v40
    v_add_f32 v43, v43, v41
    v_lshlrev_b32 v4, 4, v0
    ds_write_b128 v4, v[42:45]
    s_waitcnt lgkmcnt(0)
    s_barrier
    s_cmp_lg_u32 s26, 0
    s_cbranch_scc1 K1_END
    ds_read_b128 v[46:49], v4 offset:1024
    ds_read_b128 v[50:53], v4 offset:2048
    ds_read_b128 v[54:57], v4 offset:3072
    s_waitcnt lgkmcnt(0)
    v_add_f32 v42, v42, v46
    v_add_f32 v50, v50, v54
    v_add_f32 v42, v42, v50
    v_add_f32 v43, v43, v47
    v_add_f32 v51, v51, v55
    v_add_f32 v43, v43, v51
    v_add_f32 v44, v44, v48
    v_add_f32 v52, v52, v56
    v_add_f32 v44, v44, v52
    v_add_f32 v45, v45, v49
    v_add_f32 v53, v53, v57
    v_add_f32 v45, v45, v53
    s_mul_i32 s28, s25, 7168
    s_lshl_b32 s29, s24, 9
    s_add_u32 s28, s28, s29
    s_add_u32 s28, s28, 32768
    v_lshlrev_b32 v3, 3, v1
    buffer_store_dwordx2 v[42:43], v3, s[20:23], s28 offen
    s_add_u32 s28, s28, 14336
    buffer_store_dwordx2 v[44:45], v3, s[20:23], s28 offen
K1_END:
    s_endpgm

.globl k2_kernel
.p2align 8
.type k2_kernel,@function
k2_kernel:

    s_cmp_ge_u32 s2, 284
    s_cbranch_scc1 K2_END
    s_cmp_ge_u32 s2, 256
    s_cbranch_scc1 K1_GEMV
    s_load_dwordx2 s[6:7], s[0:1], 16
    s_load_dwordx2 s[8:9], s[0:1], 88
    s_load_dwordx2 s[4:5], s[0:1], 0
    s_and_b32 s27, s2, 7
    s_lshr_b32 s28, s2, 3
    s_lshl_b32 s24, s27, 2
    s_and_b32 s29, s28, 3
    s_add_u32 s24, s24, s29
    s_lshr_b32 s25, s28, 2
    v_and_b32 v1, 63, v0
    v_lshrrev_b32 v2, 6, v0
    s_nop 0
    v_readfirstlane_b32 s26, v2
    s_waitcnt lgkmcnt(0)
    s_add_u32 s12, s8, 1048576
    s_addc_u32 s13, s9, 0
    s_mov_b32 s14, 2097152
    s_mov_b32 s15, 0x00020000
    s_mov_b32 s16, s6
    s_mov_b32 s17, s7
    s_mov_b32 s18, 524288
    s_mov_b32 s19, 0x00020000
    s_mov_b32 s20, s8
    s_mov_b32 s21, s9
    s_mov_b32 s22, 16777216
    s_mov_b32 s23, 0x00020000
    v_lshrrev_b32 v5, 4, v1
    v_and_b32 v6, 15, v1
    v_add_u32 v7, 0, v5
    v_xor_b32 v7, v7, v6
    v_lshlrev_b32 v7, 4, v7
    v_mul_u32_u24 v8, 1024, v5
    v_add_u32 v10, v7, v8
    v_add_u32 v7, 4, v5
    v_xor_b32 v7, v7, v6
    v_lshlrev_b32 v7, 4, v7
    v_mul_u32_u24 v8, 1024, v5
    v_add_u32 v11, v7, v8
    v_add_u32 v7, 8, v5
    v_xor_b32 v7, v7, v6
    v_lshlrev_b32 v7, 4, v7
    v_mul_u32_u24 v8, 1024, v5
    v_add_u32 v12, v7, v8
    v_add_u32 v7, 12, v5
    v_xor_b32 v7, v7, v6
    v_lshlrev_b32 v7, 4, v7
    v_mul_u32_u24 v8, 1024, v5
    v_add_u32 v13, v7, v8
    v_lshrrev_b32 v7, 3, v1
    v_mul_u32_u24 v7, 1024, v7
    v_and_b32 v8, 7, v1
    v_lshrrev_b32 v9, 4, v1
    v_and_b32 v9, 1, v9
    v_lshlrev_b32 v9, 1, v9
    v_xor_b32 v16, v8, v9
    v_lshl_add_u32 v14, v16, 4, v7
    v_or_b32 v9, 4, v9
    v_xor_b32 v16, v8, v9
    v_lshl_add_u32 v15, v16, 4, v7
    s_lshl_b32 s27, s24, 6
    s_lshl_b32 s28, s26, 4
    s_add_u32 s27, s27, s28
    s_mul_i32 s30, s27, 1024
    s_lshl_b32 s28, s26, 15
    s_lshl_b32 s29, s25, 7
    s_add_u32 s31, s28, s29
    s_lshl_b32 s32, s26, 12
    s_lshl_b32 s33, s26, 12
    s_add_u32 s34, s32, 0
    s_mov_b32 m0, s34
    s_add_u32 s35, s30, 0
    buffer_load_dwordx4 v10, s[12:15], s35 offen lds
    s_add_u32 s34, s32, 1024
    s_mov_b32 m0, s34
    s_add_u32 s35, s30, 4096
    buffer_load_dwordx4 v11, s[12:15], s35 offen lds
    s_add_u32 s34, s32, 2048
    s_mov_b32 m0, s34
    s_add_u32 s35, s30, 8192
    buffer_load_dwordx4 v12, s[12:15], s35 offen lds
    s_add_u32 s34, s32, 3072
    s_mov_b32 m0, s34
    s_add_u32 s35, s30, 12288
    buffer_load_dwordx4 v13, s[12:15], s35 offen lds
    s_add_u32 s34, s33, 16384
    s_mov_b32 m0, s34
    s_add_u32 s35, s31, 0
    buffer_load_dwordx4 v14, s[16:19], s35 offen lds
    s_add_u32 s34, s33, 17408
    s_mov_b32 m0, s34
    s_add_u32 s35, s31, 8192
    buffer_load_dwordx4 v15, s[16:19], s35 offen lds
    s_add_u32 s34, s33, 18432
    s_mov_b32 m0, s34
    s_add_u32 s35, s31, 16384
    buffer_load_dwordx4 v14, s[16:19], s35 offen lds
    s_add_u32 s34, s33, 19456
    s_mov_b32 m0, s34
    s_add_u32 s35, s31, 24576
    buffer_load_dwordx4 v15, s[16:19], s35 offen lds
    s_add_u32 s34, s32, 32768
    s_mov_b32 m0, s34
    s_add_u32 s35, s30, 256
    buffer_load_dwordx4 v10, s[12:15], s35 offen lds
    s_add_u32 s34, s32, 33792
    s_mov_b32 m0, s34
    s_add_u32 s35, s30, 4352
    buffer_load_dwordx4 v11, s[12:15], s35 offen lds
    s_add_u32 s34, s32, 34816
    s_mov_b32 m0, s34
    s_add_u32 s35, s30, 8448
    buffer_load_dwordx4 v12, s[12:15], s35 offen lds
    s_add_u32 s34, s32, 35840
    s_mov_b32 m0, s34
    s_add_u32 s35, s30, 12544
    buffer_load_dwordx4 v13, s[12:15], s35 offen lds
    s_add_u32 s34, s33, 49152
    s_mov_b32 m0, s34
    s_add_u32 s35, s31, 131072
    buffer_load_dwordx4 v14, s[16:19], s35 offen lds
    s_add_u32 s34, s33, 50176
    s_mov_b32 m0, s34
    s_add_u32 s35, s31, 139264
    buffer_load_dwordx4 v15, s[16:19], s35 offen lds
    s_add_u32 s34, s33, 51200
    s_mov_b32 m0, s34
    s_add_u32 s35, s31, 147456
    buffer_load_dwordx4 v14, s[16:19], s35 offen lds
    s_add_u32 s34, s33, 52224
    s_mov_b32 m0, s34
    s_add_u32 s35, s31, 155648
    buffer_load_dwordx4 v15, s[16:19], s35 offen lds
    s_and_b32 s28, s26, 1
    s_lshr_b32 s29, s26, 1
    s_lshl_b32 s34, s28, 13
    v_add_u32 v7, 0, v5
    v_xor_b32 v7, v7, v6
    v_lshlrev_b32 v7, 4, v7
    v_lshl_add_u32 v7, v6, 8, v7
    v_add_u32 v20, s34, v7
    v_add_u32 v7, 4, v5
    v_xor_b32 v7, v7, v6
    v_lshlrev_b32 v7, 4, v7
    v_lshl_add_u32 v7, v6, 8, v7
    v_add_u32 v21, s34, v7
    v_add_u32 v7, 8, v5
    v_xor_b32 v7, v7, v6
    v_lshlrev_b32 v7, 4, v7
    v_lshl_add_u32 v7, v6, 8, v7
    v_add_u32 v22, s34, v7
    v_add_u32 v7, 12, v5
    v_xor_b32 v7, v7, v6
    v_lshlrev_b32 v7, 4, v7
    v_lshl_add_u32 v7, v6, 8, v7
    v_add_u32 v23, s34, v7
    v_lshrrev_b32 v7, 2, v6
    v_lshl_add_u32 v7, v5, 3, v7
    v_lshlrev_b32 v7, 7, v7
    v_and_b32 v8, 3, v1
    v_lshl_add_u32 v7, v8, 3, v7
    v_add_u32 v7, 0x4000, v7
    v_lshrrev_b32 v8, 3, v1
    v_and_b32 v8, 3, v8
    s_lshl_b32 s34, s29, 1
    v_xor_b32 v9, s34, v8
    v_lshl_add_u32 v24, v9, 5, v7
    s_add_u32 s34, s34, 1
    v_xor_b32 v9, s34, v8
    v_lshl_add_u32 v25, v9, 5, v7
    v_add_u32 v26, 0x10000, v20
    v_add_u32 v27, 0x10000, v21
    v_add_u32 v28, 0x10000, v22
    v_add_u32 v29, 0x10000, v23
    v_add_u32 v30, 0x10000, v24
    v_add_u32 v31, 0x10000, v25
    v_mov_b32 v64, 0
    v_mov_b32 v65, 0
    v_mov_b32 v66, 0
    v_mov_b32 v67, 0
    v_mov_b32 v68, 0
    v_mov_b32 v69, 0
    v_mov_b32 v70, 0
    v_mov_b32 v71, 0
    v_mov_b32 v72, 0
    v_mov_b32 v73, 0
    v_mov_b32 v74, 0
    v_mov_b32 v75, 0
    v_mov_b32 v76, 0
    v_mov_b32 v77, 0
    v_mov_b32 v78, 0
    v_mov_b32 v79, 0
    s_waitcnt vmcnt(8)
    s_barrier
    ds_read_b64_tr_b16 v[40:41], v24 offset:0
    ds_read_b64_tr_b16 v[42:43], v24 offset:512
    ds_read_b64_tr_b16 v[44:45], v25 offset:0
    ds_read_b64_tr_b16 v[46:47], v25 offset:512
    ds_read_b128 v[32:35], v20 offset:0
    ds_read_b128 v[36:39], v20 offset:4096
    s_waitcnt lgkmcnt(0)
    v_mfma_f32_16x16x32_bf16 v[64:67], v[40:43], v[32:35], v[64:67]
    ds_read_b64_tr_b16 v[56:57], v24 offset:4096
    ds_read_b64_tr_b16 v[58:59], v24 offset:4608
    v_mfma_f32_16x16x32_bf16 v[68:71], v[40:43], v[36:39], v[68:71]
    ds_read_b64_tr_b16 v[60:61], v25 offset:4096
    ds_read_b64_tr_b16 v[62:63], v25 offset:4608
    v_mfma_f32_16x16x32_bf16 v[72:75], v[44:47], v[32:35], v[72:75]
    ds_read_b128 v[48:51], v21 offset:0
    ds_read_b128 v[52:55], v21 offset:4096
    v_mfma_f32_16x16x32_bf16 v[76:79], v[44:47], v[36:39], v[76:79]
    s_waitcnt lgkmcnt(0)
    v_mfma_f32_16x16x32_bf16 v[64:67], v[56:59], v[48:51], v[64:67]
    ds_read_b64_tr_b16 v[40:41], v24 offset:8192
    ds_read_b64_tr_b16 v[42:43], v24 offset:8704
    v_mfma_f32_16x16x32_bf16 v[68:71], v[56:59], v[52:55], v[68:71]
    ds_read_b64_tr_b16 v[44:45], v25 offset:8192
    ds_read_b64_tr_b16 v[46:47], v25 offset:8704
    v_mfma_f32_16x16x32_bf16 v[72:75], v[60:63], v[48:51], v[72:75]
    ds_read_b128 v[32:35], v22 offset:0
    ds_read_b128 v[36:39], v22 offset:4096
    v_mfma_f32_16x16x32_bf16 v[76:79], v[60:63], v[52:55], v[76:79]
    s_waitcnt lgkmcnt(0)
    v_mfma_f32_16x16x32_bf16 v[64:67], v[40:43], v[32:35], v[64:67]
    ds_read_b64_tr_b16 v[56:57], v24 offset:12288
    ds_read_b64_tr_b16 v[58:59], v24 offset:12800
    v_mfma_f32_16x16x32_bf16 v[68:71], v[40:43], v[36:39], v[68:71]
    ds_read_b64_tr_b16 v[60:61], v25 offset:12288
    ds_read_b64_tr_b16 v[62:63], v25 offset:12800
    v_mfma_f32_16x16x32_bf16 v[72:75], v[44:47], v[32:35], v[72:75]
    ds_read_b128 v[48:51], v23 offset:0
    ds_read_b128 v[52:55], v23 offset:4096
    v_mfma_f32_16x16x32_bf16 v[76:79], v[44:47], v[36:39], v[76:79]
    s_waitcnt lgkmcnt(0)
    s_waitcnt vmcnt(0)
    s_barrier
    s_add_u32 s34, s32, 0
    s_mov_b32 m0, s34
    s_add_u32 s35, s30, 512
    buffer_load_dwordx4 v10, s[12:15], s35 offen lds
    s_add_u32 s34, s32, 1024
    s_mov_b32 m0, s34
    s_add_u32 s35, s30, 4608
    buffer_load_dwordx4 v11, s[12:15], s35 offen lds
    s_add_u32 s34, s32, 2048
    s_mov_b32 m0, s34
    s_add_u32 s35, s30, 8704
    buffer_load_dwordx4 v12, s[12:15], s35 offen lds
    s_add_u32 s34, s32, 3072
    s_mov_b32 m0, s34
    s_add_u32 s35, s30, 12800
    buffer_load_dwordx4 v13, s[12:15], s35 offen lds
    s_add_u32 s34, s33, 16384
    s_mov_b32 m0, s34
    s_add_u32 s35, s31, 262144
    buffer_load_dwordx4 v14, s[16:19], s35 offen lds
    s_add_u32 s34, s33, 17408
    s_mov_b32 m0, s34
    s_add_u32 s35, s31, 270336
    buffer_load_dwordx4 v15, s[16:19], s35 offen lds
    s_add_u32 s34, s33, 18432
    s_mov_b32 m0, s34
    s_add_u32 s35, s31, 278528
    buffer_load_dwordx4 v14, s[16:19], s35 offen lds
    s_add_u32 s34, s33, 19456
    s_mov_b32 m0, s34
    s_add_u32 s35, s31, 286720
    buffer_load_dwordx4 v15, s[16:19], s35 offen lds
    v_mfma_f32_16x16x32_bf16 v[64:67], v[56:59], v[48:51], v[64:67]
    ds_read_b64_tr_b16 v[40:41], v24 offset:32768
    ds_read_b64_tr_b16 v[42:43], v24 offset:33280
    v_mfma_f32_16x16x32_bf16 v[68:71], v[56:59], v[52:55], v[68:71]
    ds_read_b64_tr_b16 v[44:45], v25 offset:32768
    ds_read_b64_tr_b16 v[46:47], v25 offset:33280
    v_mfma_f32_16x16x32_bf16 v[72:75], v[60:63], v[48:51], v[72:75]
    ds_read_b128 v[32:35], v20 offset:32768
    ds_read_b128 v[36:39], v20 offset:36864
    v_mfma_f32_16x16x32_bf16 v[76:79], v[60:63], v[52:55], v[76:79]
    s_waitcnt lgkmcnt(0)
    v_mfma_f32_16x16x32_bf16 v[64:67], v[40:43], v[32:35], v[64:67]
    ds_read_b64_tr_b16 v[56:57], v24 offset:36864
    ds_read_b64_tr_b16 v[58:59], v24 offset:37376
    v_mfma_f32_16x16x32_bf16 v[68:71], v[40:43], v[36:39], v[68:71]
    ds_read_b64_tr_b16 v[60:61], v25 offset:36864
    ds_read_b64_tr_b16 v[62:63], v25 offset:37376
    v_mfma_f32_16x16x32_bf16 v[72:75], v[44:47], v[32:35], v[72:75]
    ds_read_b128 v[48:51], v21 offset:32768
    ds_read_b128 v[52:55], v21 offset:36864
    v_mfma_f32_16x16x32_bf16 v[76:79], v[44:47], v[36:39], v[76:79]
    s_waitcnt lgkmcnt(0)
    v_mfma_f32_16x16x32_bf16 v[64:67], v[56:59], v[48:51], v[64:67]
    ds_read_b64_tr_b16 v[40:41], v24 offset:40960
    ds_read_b64_tr_b16 v[42:43], v24 offset:41472
    v_mfma_f32_16x16x32_bf16 v[68:71], v[56:59], v[52:55], v[68:71]
    ds_read_b64_tr_b16 v[44:45], v25 offset:40960
    ds_read_b64_tr_b16 v[46:47], v25 offset:41472
    v_mfma_f32_16x16x32_bf16 v[72:75], v[60:63], v[48:51], v[72:75]
    ds_read_b128 v[32:35], v22 offset:32768
    ds_read_b128 v[36:39], v22 offset:36864
    v_mfma_f32_16x16x32_bf16 v[76:79], v[60:63], v[52:55], v[76:79]
    s_waitcnt lgkmcnt(0)
    v_mfma_f32_16x16x32_bf16 v[64:67], v[40:43], v[32:35], v[64:67]
    ds_read_b64_tr_b16 v[56:57], v24 offset:45056
    ds_read_b64_tr_b16 v[58:59], v24 offset:45568
    v_mfma_f32_16x16x32_bf16 v[68:71], v[40:43], v[36:39], v[68:71]
    ds_read_b64_tr_b16 v[60:61], v25 offset:45056
    ds_read_b64_tr_b16 v[62:63], v25 offset:45568
    v_mfma_f32_16x16x32_bf16 v[72:75], v[44:47], v[32:35], v[72:75]
    ds_read_b128 v[48:51], v23 offset:32768
    ds_read_b128 v[52:55], v23 offset:36864
    v_mfma_f32_16x16x32_bf16 v[76:79], v[44:47], v[36:39], v[76:79]
    s_waitcnt lgkmcnt(0)
    s_waitcnt vmcnt(0)
    s_barrier
    s_add_u32 s34, s32, 32768
    s_mov_b32 m0, s34
    s_add_u32 s35, s30, 768
    buffer_load_dwordx4 v10, s[12:15], s35 offen lds
    s_add_u32 s34, s32, 33792
    s_mov_b32 m0, s34
    s_add_u32 s35, s30, 4864
    buffer_load_dwordx4 v11, s[12:15], s35 offen lds
    s_add_u32 s34, s32, 34816
    s_mov_b32 m0, s34
    s_add_u32 s35, s30, 8960
    buffer_load_dwordx4 v12, s[12:15], s35 offen lds
    s_add_u32 s34, s32, 35840
    s_mov_b32 m0, s34
    s_add_u32 s35, s30, 13056
    buffer_load_dwordx4 v13, s[12:15], s35 offen lds
    s_add_u32 s34, s33, 49152
    s_mov_b32 m0, s34
    s_add_u32 s35, s31, 393216
    buffer_load_dwordx4 v14, s[16:19], s35 offen lds
    s_add_u32 s34, s33, 50176
    s_mov_b32 m0, s34
    s_add_u32 s35, s31, 401408
    buffer_load_dwordx4 v15, s[16:19], s35 offen lds
    s_add_u32 s34, s33, 51200
    s_mov_b32 m0, s34
    s_add_u32 s35, s31, 409600
    buffer_load_dwordx4 v14, s[16:19], s35 offen lds
    s_add_u32 s34, s33, 52224
    s_mov_b32 m0, s34
    s_add_u32 s35, s31, 417792
    buffer_load_dwordx4 v15, s[16:19], s35 offen lds
    v_mfma_f32_16x16x32_bf16 v[64:67], v[56:59], v[48:51], v[64:67]
    ds_read_b64_tr_b16 v[40:41], v24 offset:0
    ds_read_b64_tr_b16 v[42:43], v24 offset:512
    v_mfma_f32_16x16x32_bf16 v[68:71], v[56:59], v[52:55], v[68:71]
    ds_read_b64_tr_b16 v[44:45], v25 offset:0
    ds_read_b64_tr_b16 v[46:47], v25 offset:512
    v_mfma_f32_16x16x32_bf16 v[72:75], v[60:63], v[48:51], v[72:75]
    ds_read_b128 v[32:35], v20 offset:0
    ds_read_b128 v[36:39], v20 offset:4096
    v_mfma_f32_16x16x32_bf16 v[76:79], v[60:63], v[52:55], v[76:79]
    s_waitcnt lgkmcnt(0)
    v_mfma_f32_16x16x32_bf16 v[64:67], v[40:43], v[32:35], v[64:67]
    ds_read_b64_tr_b16 v[56:57], v24 offset:4096
    ds_read_b64_tr_b16 v[58:59], v24 offset:4608
    v_mfma_f32_16x16x32_bf16 v[68:71], v[40:43], v[36:39], v[68:71]
    ds_read_b64_tr_b16 v[60:61], v25 offset:4096
    ds_read_b64_tr_b16 v[62:63], v25 offset:4608
    v_mfma_f32_16x16x32_bf16 v[72:75], v[44:47], v[32:35], v[72:75]
    ds_read_b128 v[48:51], v21 offset:0
    ds_read_b128 v[52:55], v21 offset:4096
    v_mfma_f32_16x16x32_bf16 v[76:79], v[44:47], v[36:39], v[76:79]
    s_waitcnt lgkmcnt(0)
    v_mfma_f32_16x16x32_bf16 v[64:67], v[56:59], v[48:51], v[64:67]
    ds_read_b64_tr_b16 v[40:41], v24 offset:8192
    ds_read_b64_tr_b16 v[42:43], v24 offset:8704
    v_mfma_f32_16x16x32_bf16 v[68:71], v[56:59], v[52:55], v[68:71]
    ds_read_b64_tr_b16 v[44:45], v25 offset:8192
    ds_read_b64_tr_b16 v[46:47], v25 offset:8704
    v_mfma_f32_16x16x32_bf16 v[72:75], v[60:63], v[48:51], v[72:75]
    ds_read_b128 v[32:35], v22 offset:0
    ds_read_b128 v[36:39], v22 offset:4096
    v_mfma_f32_16x16x32_bf16 v[76:79], v[60:63], v[52:55], v[76:79]
    s_waitcnt lgkmcnt(0)
    v_mfma_f32_16x16x32_bf16 v[64:67], v[40:43], v[32:35], v[64:67]
    ds_read_b64_tr_b16 v[56:57], v24 offset:12288
    ds_read_b64_tr_b16 v[58:59], v24 offset:12800
    v_mfma_f32_16x16x32_bf16 v[68:71], v[40:43], v[36:39], v[68:71]
    ds_read_b64_tr_b16 v[60:61], v25 offset:12288
    ds_read_b64_tr_b16 v[62:63], v25 offset:12800
    v_mfma_f32_16x16x32_bf16 v[72:75], v[44:47], v[32:35], v[72:75]
    ds_read_b128 v[48:51], v23 offset:0
    ds_read_b128 v[52:55], v23 offset:4096
    v_mfma_f32_16x16x32_bf16 v[76:79], v[44:47], v[36:39], v[76:79]
    s_waitcnt lgkmcnt(0)
    s_waitcnt vmcnt(0)
    s_barrier
    v_mfma_f32_16x16x32_bf16 v[64:67], v[56:59], v[48:51], v[64:67]
    ds_read_b64_tr_b16 v[40:41], v24 offset:32768
    ds_read_b64_tr_b16 v[42:43], v24 offset:33280
    v_mfma_f32_16x16x32_bf16 v[68:71], v[56:59], v[52:55], v[68:71]
    ds_read_b64_tr_b16 v[44:45], v25 offset:32768
    ds_read_b64_tr_b16 v[46:47], v25 offset:33280
    v_mfma_f32_16x16x32_bf16 v[72:75], v[60:63], v[48:51], v[72:75]
    ds_read_b128 v[32:35], v20 offset:32768
    ds_read_b128 v[36:39], v20 offset:36864
    v_mfma_f32_16x16x32_bf16 v[76:79], v[60:63], v[52:55], v[76:79]
    s_waitcnt lgkmcnt(0)
    v_mfma_f32_16x16x32_bf16 v[64:67], v[40:43], v[32:35], v[64:67]
    ds_read_b64_tr_b16 v[56:57], v24 offset:36864
    ds_read_b64_tr_b16 v[58:59], v24 offset:37376
    v_mfma_f32_16x16x32_bf16 v[68:71], v[40:43], v[36:39], v[68:71]
    ds_read_b64_tr_b16 v[60:61], v25 offset:36864
    ds_read_b64_tr_b16 v[62:63], v25 offset:37376
    v_mfma_f32_16x16x32_bf16 v[72:75], v[44:47], v[32:35], v[72:75]
    ds_read_b128 v[48:51], v21 offset:32768
    ds_read_b128 v[52:55], v21 offset:36864
    v_mfma_f32_16x16x32_bf16 v[76:79], v[44:47], v[36:39], v[76:79]
    s_waitcnt lgkmcnt(0)
    v_mfma_f32_16x16x32_bf16 v[64:67], v[56:59], v[48:51], v[64:67]
    ds_read_b64_tr_b16 v[40:41], v24 offset:40960
    ds_read_b64_tr_b16 v[42:43], v24 offset:41472
    v_mfma_f32_16x16x32_bf16 v[68:71], v[56:59], v[52:55], v[68:71]
    ds_read_b64_tr_b16 v[44:45], v25 offset:40960
    ds_read_b64_tr_b16 v[46:47], v25 offset:41472
    v_mfma_f32_16x16x32_bf16 v[72:75], v[60:63], v[48:51], v[72:75]
    ds_read_b128 v[32:35], v22 offset:32768
    ds_read_b128 v[36:39], v22 offset:36864
    v_mfma_f32_16x16x32_bf16 v[76:79], v[60:63], v[52:55], v[76:79]
    s_waitcnt lgkmcnt(0)
    v_mfma_f32_16x16x32_bf16 v[64:67], v[40:43], v[32:35], v[64:67]
    ds_read_b64_tr_b16 v[56:57], v24 offset:45056
    ds_read_b64_tr_b16 v[58:59], v24 offset:45568
    v_mfma_f32_16x16x32_bf16 v[68:71], v[40:43], v[36:39], v[68:71]
    ds_read_b64_tr_b16 v[60:61], v25 offset:45056
    ds_read_b64_tr_b16 v[62:63], v25 offset:45568
    v_mfma_f32_16x16x32_bf16 v[72:75], v[44:47], v[32:35], v[72:75]
    ds_read_b128 v[48:51], v23 offset:32768
    ds_read_b128 v[52:55], v23 offset:36864
    v_mfma_f32_16x16x32_bf16 v[76:79], v[44:47], v[36:39], v[76:79]
    s_waitcnt lgkmcnt(0)
    v_mfma_f32_16x16x32_bf16 v[64:67], v[56:59], v[48:51], v[64:67]
    v_mfma_f32_16x16x32_bf16 v[68:71], v[56:59], v[52:55], v[68:71]
    v_mfma_f32_16x16x32_bf16 v[72:75], v[60:63], v[48:51], v[72:75]
    v_mfma_f32_16x16x32_bf16 v[76:79], v[60:63], v[52:55], v[76:79]
    s_nop 7
    s_nop 7
    s_lshl_b32 s34, s24, 6
    s_lshl_b32 s35, s28, 5
    s_add_u32 s34, s34, s35
    s_lshl_b32 s35, s25, 6
    s_lshl_b32 s36, s29, 5
    s_add_u32 s35, s35, s36
    v_add_u32 v90, s34, v6
    v_lshlrev_b32 v91, 2, v5
    v_add_u32 v91, s35, v91
    v_lshlrev_b32 v92, 10, v90
    v_lshl_add_u32 v92, v91, 1, v92
    v_lshlrev_b32 v93, 2, v91
    s_mov_b32 s36, s4
    s_mov_b32 s37, s5
    s_mov_b32 s38, 2097152
    s_mov_b32 s39, 0x00020000

    v_add_u32 v94, 0x4000, v92
    buffer_load_dwordx2 v[100:101], v92, s[36:39], 0 offen offset:0
    buffer_load_dwordx2 v[102:103], v94, s[36:39], 0 offen offset:0
    s_mov_b32 s44, 4096
    buffer_load_dwordx4 v[120:123], v93, s[20:23], s44 offen offset:0
    s_mov_b32 s44, 8192
    buffer_load_dwordx4 v[128:131], v93, s[20:23], s44 offen offset:0
    buffer_load_dwordx2 v[104:105], v92, s[36:39], 0 offen offset:32
    buffer_load_dwordx2 v[106:107], v94, s[36:39], 0 offen offset:32
    s_mov_b32 s44, 4096
    buffer_load_dwordx4 v[124:127], v93, s[20:23], s44 offen offset:64
    s_mov_b32 s44, 8192
    buffer_load_dwordx4 v[132:135], v93, s[20:23], s44 offen offset:64
    s_waitcnt vmcnt(0)
    v_add_f32 v128, 1.0, v128
    v_add_f32 v129, 1.0, v129
    v_add_f32 v130, 1.0, v130
    v_add_f32 v131, 1.0, v131
    v_add_f32 v132, 1.0, v132
    v_add_f32 v133, 1.0, v133
    v_add_f32 v134, 1.0, v134
    v_add_f32 v135, 1.0, v135
    v_mov_b32 v140, 0
    v_mov_b32 v141, 0
    v_mov_b32 v142, 0
    v_mov_b32 v143, 0
    v_lshlrev_b32 v110, 16, v100
    v_and_b32 v111, 0xffff0000, v100
    v_lshlrev_b32 v112, 16, v101
    v_and_b32 v113, 0xffff0000, v101
    v_fmac_f32 v110, v64, v120
    v_fmac_f32 v111, v65, v121
    v_fmac_f32 v112, v66, v122
    v_fmac_f32 v113, v67, v123
    v_cvt_pk_bf16_f32 v114, v110, v111
    v_cvt_pk_bf16_f32 v115, v112, v113
    s_mov_b32 s44, 3145728
    buffer_store_dwordx2 v[114:115], v92, s[20:23], s44 offen offset:0
    v_lshlrev_b32 v110, 16, v114
    v_and_b32 v111, 0xffff0000, v114
    v_lshlrev_b32 v112, 16, v115
    v_and_b32 v113, 0xffff0000, v115
    v_add_f32 v140, v140, v110
    v_fmac_f32 v142, v110, v110
    v_mul_f32 v110, v110, v128
    v_add_f32 v140, v140, v111
    v_fmac_f32 v142, v111, v111
    v_mul_f32 v111, v111, v129
    v_add_f32 v140, v140, v112
    v_fmac_f32 v142, v112, v112
    v_mul_f32 v112, v112, v130
    v_add_f32 v140, v140, v113
    v_fmac_f32 v142, v113, v113
    v_mul_f32 v113, v113, v131
    v_cvt_pk_bf16_f32 v116, v110, v111
    v_cvt_pk_bf16_f32 v117, v112, v113
    s_mov_b32 s44, 5242880
    buffer_store_dwordx2 v[116:117], v92, s[20:23], s44 offen offset:0
    v_lshlrev_b32 v110, 16, v102
    v_and_b32 v111, 0xffff0000, v102
    v_lshlrev_b32 v112, 16, v103
    v_and_b32 v113, 0xffff0000, v103
    v_fmac_f32 v110, v68, v120
    v_fmac_f32 v111, v69, v121
    v_fmac_f32 v112, v70, v122
    v_fmac_f32 v113, v71, v123
    v_cvt_pk_bf16_f32 v114, v110, v111
    v_cvt_pk_bf16_f32 v115, v112, v113
    s_mov_b32 s44, 3145728
    buffer_store_dwordx2 v[114:115], v94, s[20:23], s44 offen offset:0
    v_lshlrev_b32 v110, 16, v114
    v_and_b32 v111, 0xffff0000, v114
    v_lshlrev_b32 v112, 16, v115
    v_and_b32 v113, 0xffff0000, v115
    v_add_f32 v141, v141, v110
    v_fmac_f32 v143, v110, v110
    v_mul_f32 v110, v110, v128
    v_add_f32 v141, v141, v111
    v_fmac_f32 v143, v111, v111
    v_mul_f32 v111, v111, v129
    v_add_f32 v141, v141, v112
    v_fmac_f32 v143, v112, v112
    v_mul_f32 v112, v112, v130
    v_add_f32 v141, v141, v113
    v_fmac_f32 v143, v113, v113
    v_mul_f32 v113, v113, v131
    v_cvt_pk_bf16_f32 v116, v110, v111
    v_cvt_pk_bf16_f32 v117, v112, v113
    s_mov_b32 s44, 5242880
    buffer_store_dwordx2 v[116:117], v94, s[20:23], s44 offen offset:0
    v_lshlrev_b32 v110, 16, v104
    v_and_b32 v111, 0xffff0000, v104
    v_lshlrev_b32 v112, 16, v105
    v_and_b32 v113, 0xffff0000, v105
    v_fmac_f32 v110, v72, v124
    v_fmac_f32 v111, v73, v125
    v_fmac_f32 v112, v74, v126
    v_fmac_f32 v113, v75, v127
    v_cvt_pk_bf16_f32 v114, v110, v111
    v_cvt_pk_bf16_f32 v115, v112, v113
    s_mov_b32 s44, 3145728
    buffer_store_dwordx2 v[114:115], v92, s[20:23], s44 offen offset:32
    v_lshlrev_b32 v110, 16, v114
    v_and_b32 v111, 0xffff0000, v114
    v_lshlrev_b32 v112, 16, v115
    v_and_b32 v113, 0xffff0000, v115
    v_add_f32 v140, v140, v110
    v_fmac_f32 v142, v110, v110
    v_mul_f32 v110, v110, v132
    v_add_f32 v140, v140, v111
    v_fmac_f32 v142, v111, v111
    v_mul_f32 v111, v111, v133
    v_add_f32 v140, v140, v112
    v_fmac_f32 v142, v112, v112
    v_mul_f32 v112, v112, v134
    v_add_f32 v140, v140, v113
    v_fmac_f32 v142, v113, v113
    v_mul_f32 v113, v113, v135
    v_cvt_pk_bf16_f32 v116, v110, v111
    v_cvt_pk_bf16_f32 v117, v112, v113
    s_mov_b32 s44, 5242880
    buffer_store_dwordx2 v[116:117], v92, s[20:23], s44 offen offset:32
    v_lshlrev_b32 v110, 16, v106
    v_and_b32 v111, 0xffff0000, v106
    v_lshlrev_b32 v112, 16, v107
    v_and_b32 v113, 0xffff0000, v107
    v_fmac_f32 v110, v76, v124
    v_fmac_f32 v111, v77, v125
    v_fmac_f32 v112, v78, v126
    v_fmac_f32 v113, v79, v127
    v_cvt_pk_bf16_f32 v114, v110, v111
    v_cvt_pk_bf16_f32 v115, v112, v113
    s_mov_b32 s44, 3145728
    buffer_store_dwordx2 v[114:115], v94, s[20:23], s44 offen offset:32
    v_lshlrev_b32 v110, 16, v114
    v_and_b32 v111, 0xffff0000, v114
    v_lshlrev_b32 v112, 16, v115
    v_and_b32 v113, 0xffff0000, v115
    v_add_f32 v141, v141, v110
    v_fmac_f32 v143, v110, v110
    v_mul_f32 v110, v110, v132
    v_add_f32 v141, v141, v111
    v_fmac_f32 v143, v111, v111
    v_mul_f32 v111, v111, v133
    v_add_f32 v141, v141, v112
    v_fmac_f32 v143, v112, v112
    v_mul_f32 v112, v112, v134
    v_add_f32 v141, v141, v113
    v_fmac_f32 v143, v113, v113
    v_mul_f32 v113, v113, v135
    v_cvt_pk_bf16_f32 v116, v110, v111
    v_cvt_pk_bf16_f32 v117, v112, v113
    s_mov_b32 s44, 5242880
    buffer_store_dwordx2 v[116:117], v94, s[20:23], s44 offen offset:32
    v_mov_b32 v144, v140
    s_nop 1
    v_permlane16_swap_b32 v144, v140
    s_nop 1
    v_add_f32 v140, v140, v144
    v_mov_b32 v144, v140
    s_nop 1
    v_permlane32_swap_b32 v144, v140
    s_nop 1
    v_add_f32 v140, v140, v144
    v_mov_b32 v144, v141
    s_nop 1
    v_permlane16_swap_b32 v144, v141
    s_nop 1
    v_add_f32 v141, v141, v144
    v_mov_b32 v144, v141
    s_nop 1
    v_permlane32_swap_b32 v144, v141
    s_nop 1
    v_add_f32 v141, v141, v144
    v_mov_b32 v144, v142
    s_nop 1
    v_permlane16_swap_b32 v144, v142
    s_nop 1
    v_add_f32 v142, v142, v144
    v_mov_b32 v144, v142
    s_nop 1
    v_permlane32_swap_b32 v144, v142
    s_nop 1
    v_add_f32 v142, v142, v144
    v_mov_b32 v144, v143
    s_nop 1
    v_permlane16_swap_b32 v144, v143
    s_nop 1
    v_add_f32 v143, v143, v144
    v_mov_b32 v144, v143
    s_nop 1
    v_permlane32_swap_b32 v144, v143
    s_nop 1
    v_add_f32 v143, v143, v144
    v_mov_b32 v144, v140
    v_mov_b32 v145, v142
    v_mov_b32 v146, v141
    v_mov_b32 v147, v143
    s_lshl_b32 s44, s25, 1
    s_add_u32 s44, s44, s29
    s_lshl_b32 s44, s44, 3
    s_add_u32 s44, s44, 65536
    v_lshlrev_b32 v148, 7, v90
    buffer_store_dwordx2 v[144:145], v148, s[20:23], s44 offen
    buffer_store_dwordx2 v[146:147], v148, s[20:23], s44 offen offset:2048
K2_END:
    s_endpgm

.globl k3_kernel
.p2align 8
.type k3_kernel,@function
k3_kernel:

    s_cmp_ge_u32 s2, 256
    s_cbranch_scc1 K3_END
    s_load_dwordx2 s[4:5], s[0:1], 32
    s_load_dwordx2 s[6:7], s[0:1], 40
    s_load_dwordx2 s[8:9], s[0:1], 88
    s_and_b32 s27, s2, 7
    s_lshr_b32 s28, s2, 3
    s_lshr_b32 s24, s27, 1
    s_lshl_b32 s24, s24, 2
    s_and_b32 s29, s28, 3
    s_add_u32 s24, s24, s29
    s_and_b32 s25, s27, 1
    s_lshl_b32 s25, s25, 3
    s_lshr_b32 s29, s28, 2
    s_add_u32 s25, s25, s29
    v_and_b32 v1, 63, v0
    v_lshrrev_b32 v2, 6, v0
    s_nop 0
    v_readfirstlane_b32 s26, v2
    s_waitcnt lgkmcnt(0)
    s_add_u32 s12, s8, 5242880
    s_addc_u32 s13, s9, 0
    s_mov_b32 s14, 2097152
    s_mov_b32 s15, 0x00020000
    s_mov_b32 s16, s4
    s_mov_b32 s17, s5
    s_mov_b32 s18, 1835008
    s_mov_b32 s19, 0x00020000
    s_mov_b32 s44, s6
    s_mov_b32 s45, s7
    s_mov_b32 s46, 1835008
    s_mov_b32 s47, 0x00020000
    s_mov_b32 s20, s8
    s_mov_b32 s21, s9
    s_mov_b32 s22, 16777216
    s_mov_b32 s23, 0x00020000
    v_lshrrev_b32 v5, 4, v1
    v_and_b32 v6, 15, v1
    v_lshrrev_b32 v7, 3, v1
    v_lshlrev_b32 v7, 10, v7
    v_and_b32 v8, 7, v1
    v_add_u32 v9, 0, v5
    v_xor_b32 v9, v9, v8
    v_lshl_add_u32 v10, v9, 4, v7
    v_add_u32 v9, 4, v5
    v_xor_b32 v9, v9, v8
    v_lshl_add_u32 v11, v9, 4, v7
    v_lshl_or_b32 v9, 0, 2, v5
    v_lshlrev_b32 v9, 1, v9
    v_xor_b32 v9, v9, v6
    v_mul_u32_u24 v16, 3584, v5
    v_lshl_add_u32 v12, v9, 4, v16
    v_lshl_or_b32 v9, 1, 2, v5
    v_lshlrev_b32 v9, 1, v9
    v_xor_b32 v9, v9, v6
    v_mul_u32_u24 v16, 3584, v5
    v_lshl_add_u32 v13, v9, 4, v16
    s_lshl_b32 s27, s24, 7
    s_lshl_b32 s28, s26, 5
    s_add_u32 s27, s27, s28
    s_lshl_b32 s30, s27, 10
    s_mul_i32 s31, s25, 224
    s_mul_i32 s28, s26, 57344
    s_add_u32 s31, s31, s28
    s_lshl_b32 s32, s26, 12
    s_lshl_b32 s33, s26, 12
    s_add_u32 s34, s32, 0
    s_mov_b32 m0, s34
    s_add_u32 s35, s30, 0
    buffer_load_dwordx4 v10, s[12:15], s35 offen lds
    s_add_u32 s34, s32, 1024
    s_mov_b32 m0, s34
    s_add_u32 s35, s30, 8192
    buffer_load_dwordx4 v11, s[12:15], s35 offen lds
    s_add_u32 s34, s32, 2048
    s_mov_b32 m0, s34
    s_add_u32 s35, s30, 16384
    buffer_load_dwordx4 v10, s[12:15], s35 offen lds
    s_add_u32 s34, s32, 3072
    s_mov_b32 m0, s34
    s_add_u32 s35, s30, 24576
    buffer_load_dwordx4 v11, s[12:15], s35 offen lds
    s_add_u32 s34, s33, 16384
    s_mov_b32 m0, s34
    s_add_u32 s35, s31, 0
    buffer_load_dwordx4 v12, s[16:19], s35 offen lds
    s_add_u32 s34, s33, 17408
    s_mov_b32 m0, s34
    s_add_u32 s35, s31, 14336
    buffer_load_dwordx4 v12, s[16:19], s35 offen lds
    s_add_u32 s34, s33, 18432
    s_mov_b32 m0, s34
    s_add_u32 s35, s31, 28672
    buffer_load_dwordx4 v13, s[16:19], s35 offen lds
    s_add_u32 s34, s33, 19456
    s_mov_b32 m0, s34
    s_add_u32 s35, s31, 43008
    buffer_load_dwordx4 v13, s[16:19], s35 offen lds
    s_add_u32 s34, s33, 32768
    s_mov_b32 m0, s34
    s_add_u32 s35, s31, 0
    buffer_load_dwordx4 v12, s[44:47], s35 offen lds
    s_add_u32 s34, s33, 33792
    s_mov_b32 m0, s34
    s_add_u32 s35, s31, 14336
    buffer_load_dwordx4 v12, s[44:47], s35 offen lds
    s_add_u32 s34, s33, 34816
    s_mov_b32 m0, s34
    s_add_u32 s35, s31, 28672
    buffer_load_dwordx4 v13, s[44:47], s35 offen lds
    s_add_u32 s34, s33, 35840
    s_mov_b32 m0, s34
    s_add_u32 s35, s31, 43008
    buffer_load_dwordx4 v13, s[44:47], s35 offen lds
    s_add_u32 s34, s32, 49152
    s_mov_b32 m0, s34
    s_add_u32 s35, s30, 128
    buffer_load_dwordx4 v10, s[12:15], s35 offen lds
    s_add_u32 s34, s32, 50176
    s_mov_b32 m0, s34
    s_add_u32 s35, s30, 8320
    buffer_load_dwordx4 v11, s[12:15], s35 offen lds
    s_add_u32 s34, s32, 51200
    s_mov_b32 m0, s34
    s_add_u32 s35, s30, 16512
    buffer_load_dwordx4 v10, s[12:15], s35 offen lds
    s_add_u32 s34, s32, 52224
    s_mov_b32 m0, s34
    s_add_u32 s35, s30, 24704
    buffer_load_dwordx4 v11, s[12:15], s35 offen lds
    s_add_u32 s34, s33, 65536
    s_mov_b32 m0, s34
    s_add_u32 s35, s31, 229376
    buffer_load_dwordx4 v12, s[16:19], s35 offen lds
    s_add_u32 s34, s33, 66560
    s_mov_b32 m0, s34
    s_add_u32 s35, s31, 243712
    buffer_load_dwordx4 v12, s[16:19], s35 offen lds
    s_add_u32 s34, s33, 67584
    s_mov_b32 m0, s34
    s_add_u32 s35, s31, 258048
    buffer_load_dwordx4 v13, s[16:19], s35 offen lds
    s_add_u32 s34, s33, 68608
    s_mov_b32 m0, s34
    s_add_u32 s35, s31, 272384
    buffer_load_dwordx4 v13, s[16:19], s35 offen lds
    s_add_u32 s34, s33, 81920
    s_mov_b32 m0, s34
    s_add_u32 s35, s31, 229376
    buffer_load_dwordx4 v12, s[44:47], s35 offen lds
    s_add_u32 s34, s33, 82944
    s_mov_b32 m0, s34
    s_add_u32 s35, s31, 243712
    buffer_load_dwordx4 v12, s[44:47], s35 offen lds
    s_add_u32 s34, s33, 83968
    s_mov_b32 m0, s34
    s_add_u32 s35, s31, 258048
    buffer_load_dwordx4 v13, s[44:47], s35 offen lds
    s_add_u32 s34, s33, 84992
    s_mov_b32 m0, s34
    s_add_u32 s35, s31, 272384
    buffer_load_dwordx4 v13, s[44:47], s35 offen lds
    s_add_u32 s34, s32, 98304
    s_mov_b32 m0, s34
    s_add_u32 s35, s30, 256
    buffer_load_dwordx4 v10, s[12:15], s35 offen lds
    s_add_u32 s34, s32, 99328
    s_mov_b32 m0, s34
    s_add_u32 s35, s30, 8448
    buffer_load_dwordx4 v11, s[12:15], s35 offen lds
    s_add_u32 s34, s32, 100352
    s_mov_b32 m0, s34
    s_add_u32 s35, s30, 16640
    buffer_load_dwordx4 v10, s[12:15], s35 offen lds
    s_add_u32 s34, s32, 101376
    s_mov_b32 m0, s34
    s_add_u32 s35, s30, 24832
    buffer_load_dwordx4 v11, s[12:15], s35 offen lds
    s_add_u32 s34, s33, 114688
    s_mov_b32 m0, s34
    s_add_u32 s35, s31, 458752
    buffer_load_dwordx4 v12, s[16:19], s35 offen lds
    s_add_u32 s34, s33, 115712
    s_mov_b32 m0, s34
    s_add_u32 s35, s31, 473088
    buffer_load_dwordx4 v12, s[16:19], s35 offen lds
    s_add_u32 s34, s33, 116736
    s_mov_b32 m0, s34
    s_add_u32 s35, s31, 487424
    buffer_load_dwordx4 v13, s[16:19], s35 offen lds
    s_add_u32 s34, s33, 117760
    s_mov_b32 m0, s34
    s_add_u32 s35, s31, 501760
    buffer_load_dwordx4 v13, s[16:19], s35 offen lds
    s_add_u32 s34, s33, 131072
    s_mov_b32 m0, s34
    s_add_u32 s35, s31, 458752
    buffer_load_dwordx4 v12, s[44:47], s35 offen lds
    s_add_u32 s34, s33, 132096
    s_mov_b32 m0, s34
    s_add_u32 s35, s31, 473088
    buffer_load_dwordx4 v12, s[44:47], s35 offen lds
    s_add_u32 s34, s33, 133120
    s_mov_b32 m0, s34
    s_add_u32 s35, s31, 487424
    buffer_load_dwordx4 v13, s[44:47], s35 offen lds
    s_add_u32 s34, s33, 134144
    s_mov_b32 m0, s34
    s_add_u32 s35, s31, 501760
    buffer_load_dwordx4 v13, s[44:47], s35 offen lds
    v_and_b32 v9, 31, v1
    v_add_u32 v9, s27, v9
    v_lshlrev_b32 v9, 7, v9
    s_mov_b32 s34, 65536
    buffer_load_dwordx4 v[170:173], v9, s[20:23], s34 offen offset:0
    buffer_load_dwordx4 v[174:177], v9, s[20:23], s34 offen offset:16
    buffer_load_dwordx4 v[178:181], v9, s[20:23], s34 offen offset:32
    buffer_load_dwordx4 v[182:185], v9, s[20:23], s34 offen offset:48
    buffer_load_dwordx4 v[186:189], v9, s[20:23], s34 offen offset:64
    buffer_load_dwordx4 v[190:193], v9, s[20:23], s34 offen offset:80
    buffer_load_dwordx4 v[194:197], v9, s[20:23], s34 offen offset:96
    buffer_load_dwordx4 v[198:201], v9, s[20:23], s34 offen offset:112
    v_lshrrev_b32 v7, 1, v6
    v_add_u32 v8, 0, v5
    v_xor_b32 v8, v8, v7
    v_lshlrev_b32 v8, 4, v8
    v_lshl_add_u32 v8, v6, 7, v8
    v_add_u32 v20, s32, v8
    v_add_u32 v8, 4, v5
    v_xor_b32 v8, v8, v7
    v_lshlrev_b32 v8, 4, v8
    v_lshl_add_u32 v8, v6, 7, v8
    v_add_u32 v21, s32, v8
    v_lshrrev_b32 v7, 2, v6
    v_lshl_add_u32 v8, v5, 3, v7
    v_lshlrev_b32 v8, 8, v8
    v_and_b32 v9, 3, v1
    v_lshl_add_u32 v8, v9, 3, v8
    v_add_u32 v8, 0x4000, v8
    v_and_b32 v9, 1, v5
    v_lshl_or_b32 v7, v9, 2, v7
    v_xor_b32 v9, 0, v7
    v_lshl_add_u32 v22, v9, 5, v8
    v_xor_b32 v9, 1, v7
    v_lshl_add_u32 v23, v9, 5, v8
    v_xor_b32 v9, 2, v7
    v_lshl_add_u32 v24, v9, 5, v8
    v_xor_b32 v9, 3, v7
    v_lshl_add_u32 v25, v9, 5, v8
    v_xor_b32 v9, 4, v7
    v_lshl_add_u32 v26, v9, 5, v8
    v_xor_b32 v9, 5, v7
    v_lshl_add_u32 v27, v9, 5, v8
    v_xor_b32 v9, 6, v7
    v_lshl_add_u32 v28, v9, 5, v8
    v_add_u32 v30, 98304, v20
    v_add_u32 v31, 98304, v21
    v_add_u32 v32, 98304, v22
    v_add_u32 v33, 98304, v23
    v_add_u32 v34, 98304, v24
    v_add_u32 v35, 98304, v25
    v_add_u32 v36, 98304, v26
    v_add_u32 v37, 98304, v27
    v_add_u32 v38, 98304, v28
    v_add_u32 v218, 49152, v20
    v_add_u32 v219, 49152, v21
    v_add_u32 v220, 49152, v22
    v_add_u32 v221, 49152, v23
    v_add_u32 v222, 49152, v24
    v_add_u32 v223, 49152, v25
    v_add_u32 v224, 49152, v26
    v_add_u32 v225, 49152, v27
    v_add_u32 v226, 49152, v28
    v_lshlrev_b32 v9, 2, v0
    s_mul_i32 s34, s25, 448
    s_add_u32 s34, s34, 32768
    v_cmp_gt_u32 vcc, 112, v0
    s_and_saveexec_b64 s[48:49], vcc
    s_add_u32 s35, s34, 0
    buffer_load_dword v202, v9, s[20:23], s35 offen
    s_add_u32 s35, s34, 7168
    buffer_load_dword v203, v9, s[20:23], s35 offen
    s_add_u32 s35, s34, 14336
    buffer_load_dword v204, v9, s[20:23], s35 offen
    s_add_u32 s35, s34, 21504
    buffer_load_dword v205, v9, s[20:23], s35 offen
    s_mov_b64 exec, s[48:49]
    v_accvgpr_write_b32 a0, 0
    v_accvgpr_write_b32 a1, 0
    v_accvgpr_write_b32 a2, 0
    v_accvgpr_write_b32 a3, 0
    v_accvgpr_write_b32 a4, 0
    v_accvgpr_write_b32 a5, 0
    v_accvgpr_write_b32 a6, 0
    v_accvgpr_write_b32 a7, 0
    v_accvgpr_write_b32 a8, 0
    v_accvgpr_write_b32 a9, 0
    v_accvgpr_write_b32 a10, 0
    v_accvgpr_write_b32 a11, 0
    v_accvgpr_write_b32 a12, 0
    v_accvgpr_write_b32 a13, 0
    v_accvgpr_write_b32 a14, 0
    v_accvgpr_write_b32 a15, 0
    v_accvgpr_write_b32 a16, 0
    v_accvgpr_write_b32 a17, 0
    v_accvgpr_write_b32 a18, 0
    v_accvgpr_write_b32 a19, 0
    v_accvgpr_write_b32 a20, 0
    v_accvgpr_write_b32 a21, 0
    v_accvgpr_write_b32 a22, 0
    v_accvgpr_write_b32 a23, 0
    v_accvgpr_write_b32 a24, 0
    v_accvgpr_write_b32 a25, 0
    v_accvgpr_write_b32 a26, 0
    v_accvgpr_write_b32 a27, 0
    v_accvgpr_write_b32 a28, 0
    v_accvgpr_write_b32 a29, 0
    v_accvgpr_write_b32 a30, 0
    v_accvgpr_write_b32 a31, 0
    v_accvgpr_write_b32 a32, 0
    v_accvgpr_write_b32 a33, 0
    v_accvgpr_write_b32 a34, 0
    v_accvgpr_write_b32 a35, 0
    v_accvgpr_write_b32 a36, 0
    v_accvgpr_write_b32 a37, 0
    v_accvgpr_write_b32 a38, 0
    v_accvgpr_write_b32 a39, 0
    v_accvgpr_write_b32 a40, 0
    v_accvgpr_write_b32 a41, 0
    v_accvgpr_write_b32 a42, 0
    v_accvgpr_write_b32 a43, 0
    v_accvgpr_write_b32 a44, 0
    v_accvgpr_write_b32 a45, 0
    v_accvgpr_write_b32 a46, 0
    v_accvgpr_write_b32 a47, 0
    v_accvgpr_write_b32 a48, 0
    v_accvgpr_write_b32 a49, 0
    v_accvgpr_write_b32 a50, 0
    v_accvgpr_write_b32 a51, 0
    v_accvgpr_write_b32 a52, 0
    v_accvgpr_write_b32 a53, 0
    v_accvgpr_write_b32 a54, 0
    v_accvgpr_write_b32 a55, 0
    v_accvgpr_write_b32 a56, 0
    v_accvgpr_write_b32 a57, 0
    v_accvgpr_write_b32 a58, 0
    v_accvgpr_write_b32 a59, 0
    v_accvgpr_write_b32 a60, 0
    v_accvgpr_write_b32 a61, 0
    v_accvgpr_write_b32 a62, 0
    v_accvgpr_write_b32 a63, 0
    v_accvgpr_write_b32 a64, 0
    v_accvgpr_write_b32 a65, 0
    v_accvgpr_write_b32 a66, 0
    v_accvgpr_write_b32 a67, 0
    v_accvgpr_write_b32 a68, 0
    v_accvgpr_write_b32 a69, 0
    v_accvgpr_write_b32 a70, 0
    v_accvgpr_write_b32 a71, 0
    v_accvgpr_write_b32 a72, 0
    v_accvgpr_write_b32 a73, 0
    v_accvgpr_write_b32 a74, 0
    v_accvgpr_write_b32 a75, 0
    v_accvgpr_write_b32 a76, 0
    v_accvgpr_write_b32 a77, 0
    v_accvgpr_write_b32 a78, 0
    v_accvgpr_write_b32 a79, 0
    v_accvgpr_write_b32 a80, 0
    v_accvgpr_write_b32 a81, 0
    v_accvgpr_write_b32 a82, 0
    v_accvgpr_write_b32 a83, 0
    v_accvgpr_write_b32 a84, 0
    v_accvgpr_write_b32 a85, 0
    v_accvgpr_write_b32 a86, 0
    v_accvgpr_write_b32 a87, 0
    v_accvgpr_write_b32 a88, 0
    v_accvgpr_write_b32 a89, 0
    v_accvgpr_write_b32 a90, 0
    v_accvgpr_write_b32 a91, 0
    v_accvgpr_write_b32 a92, 0
    v_accvgpr_write_b32 a93, 0
    v_accvgpr_write_b32 a94, 0
    v_accvgpr_write_b32 a95, 0
    v_accvgpr_write_b32 a96, 0
    v_accvgpr_write_b32 a97, 0
    v_accvgpr_write_b32 a98, 0
    v_accvgpr_write_b32 a99, 0
    v_accvgpr_write_b32 a100, 0
    v_accvgpr_write_b32 a101, 0
    v_accvgpr_write_b32 a102, 0
    v_accvgpr_write_b32 a103, 0
    v_accvgpr_write_b32 a104, 0
    v_accvgpr_write_b32 a105, 0
    v_accvgpr_write_b32 a106, 0
    v_accvgpr_write_b32 a107, 0
    v_accvgpr_write_b32 a108, 0
    v_accvgpr_write_b32 a109, 0
    v_accvgpr_write_b32 a110, 0
    v_accvgpr_write_b32 a111, 0
    s_waitcnt vmcnt(0)
    s_mov_b64 exec, s[48:49]
    s_and_b64 exec, exec, vcc
    v_add_u32 v227, 147456, v9
    ds_write_b32 v227, v202 offset:0
    ds_write_b32 v227, v203 offset:448
    ds_write_b32 v227, v204 offset:896
    ds_write_b32 v227, v205 offset:1344
    s_mov_b64 exec, s[48:49]
    s_waitcnt lgkmcnt(0)
    s_barrier
    ds_read_b128 v[40:43], v20 offset:0
    ds_read_b128 v[44:47], v20 offset:2048
    ds_read_b64_tr_b16 v[56:57], v22 offset:0
    ds_read_b64_tr_b16 v[58:59], v22 offset:1024
    ds_read_b64_tr_b16 v[60:61], v23 offset:0
    ds_read_b64_tr_b16 v[62:63], v23 offset:1024
    ds_read_b64_tr_b16 v[64:65], v24 offset:0
    ds_read_b64_tr_b16 v[66:67], v24 offset:1024
    ds_read_b64_tr_b16 v[68:69], v25 offset:0
    ds_read_b64_tr_b16 v[70:71], v25 offset:1024
    ds_read_b64_tr_b16 v[72:73], v26 offset:0
    ds_read_b64_tr_b16 v[74:75], v26 offset:1024
    ds_read_b64_tr_b16 v[76:77], v27 offset:0
    ds_read_b64_tr_b16 v[78:79], v27 offset:1024
    ds_read_b64_tr_b16 v[80:81], v28 offset:0
    ds_read_b64_tr_b16 v[82:83], v28 offset:1024
    ds_read_b64_tr_b16 v[84:85], v22 offset:16384
    ds_read_b64_tr_b16 v[86:87], v22 offset:17408
    ds_read_b64_tr_b16 v[88:89], v23 offset:16384
    ds_read_b64_tr_b16 v[90:91], v23 offset:17408
    ds_read_b64_tr_b16 v[92:93], v24 offset:16384
    ds_read_b64_tr_b16 v[94:95], v24 offset:17408
    ds_read_b64_tr_b16 v[96:97], v25 offset:16384
    ds_read_b64_tr_b16 v[98:99], v25 offset:17408
    ds_read_b64_tr_b16 v[100:101], v26 offset:16384
    ds_read_b64_tr_b16 v[102:103], v26 offset:17408
    ds_read_b64_tr_b16 v[104:105], v27 offset:16384
    ds_read_b64_tr_b16 v[106:107], v27 offset:17408
    ds_read_b64_tr_b16 v[108:109], v28 offset:16384
    ds_read_b64_tr_b16 v[110:111], v28 offset:17408
    s_waitcnt lgkmcnt(0)
    v_mfma_f32_16x16x32_bf16 a[0:3], v[56:59], v[40:43], a[0:3]
    ds_read_b128 v[48:51], v21 offset:0
    v_mfma_f32_16x16x32_bf16 a[4:7], v[56:59], v[44:47], a[4:7]
    ds_read_b128 v[52:55], v21 offset:2048
    v_mfma_f32_16x16x32_bf16 a[8:11], v[60:63], v[40:43], a[8:11]
    ds_read_b64_tr_b16 v[112:113], v22 offset:8192
    v_mfma_f32_16x16x32_bf16 a[12:15], v[60:63], v[44:47], a[12:15]
    ds_read_b64_tr_b16 v[114:115], v22 offset:9216
    v_mfma_f32_16x16x32_bf16 a[16:19], v[64:67], v[40:43], a[16:19]
    ds_read_b64_tr_b16 v[116:117], v23 offset:8192
    v_mfma_f32_16x16x32_bf16 a[20:23], v[64:67], v[44:47], a[20:23]
    ds_read_b64_tr_b16 v[118:119], v23 offset:9216
    v_mfma_f32_16x16x32_bf16 a[24:27], v[68:71], v[40:43], a[24:27]
    ds_read_b64_tr_b16 v[120:121], v24 offset:8192
    v_mfma_f32_16x16x32_bf16 a[28:31], v[68:71], v[44:47], a[28:31]
    ds_read_b64_tr_b16 v[122:123], v24 offset:9216
    v_mfma_f32_16x16x32_bf16 a[32:35], v[72:75], v[40:43], a[32:35]
    ds_read_b64_tr_b16 v[124:125], v25 offset:8192
    v_mfma_f32_16x16x32_bf16 a[36:39], v[72:75], v[44:47], a[36:39]
    ds_read_b64_tr_b16 v[126:127], v25 offset:9216
    v_mfma_f32_16x16x32_bf16 a[40:43], v[76:79], v[40:43], a[40:43]
    ds_read_b64_tr_b16 v[128:129], v26 offset:8192
    v_mfma_f32_16x16x32_bf16 a[44:47], v[76:79], v[44:47], a[44:47]
    ds_read_b64_tr_b16 v[130:131], v26 offset:9216
    v_mfma_f32_16x16x32_bf16 a[48:51], v[80:83], v[40:43], a[48:51]
    ds_read_b64_tr_b16 v[132:133], v27 offset:8192
    v_mfma_f32_16x16x32_bf16 a[52:55], v[80:83], v[44:47], a[52:55]
    ds_read_b64_tr_b16 v[134:135], v27 offset:9216
    v_mfma_f32_16x16x32_bf16 a[56:59], v[84:87], v[40:43], a[56:59]
    ds_read_b64_tr_b16 v[136:137], v28 offset:8192
    v_mfma_f32_16x16x32_bf16 a[60:63], v[84:87], v[44:47], a[60:63]
    ds_read_b64_tr_b16 v[138:139], v28 offset:9216
    v_mfma_f32_16x16x32_bf16 a[64:67], v[88:91], v[40:43], a[64:67]
    ds_read_b64_tr_b16 v[140:141], v22 offset:24576
    v_mfma_f32_16x16x32_bf16 a[68:71], v[88:91], v[44:47], a[68:71]
    ds_read_b64_tr_b16 v[142:143], v22 offset:25600
    v_mfma_f32_16x16x32_bf16 a[72:75], v[92:95], v[40:43], a[72:75]
    ds_read_b64_tr_b16 v[144:145], v23 offset:24576
    v_mfma_f32_16x16x32_bf16 a[76:79], v[92:95], v[44:47], a[76:79]
    ds_read_b64_tr_b16 v[146:147], v23 offset:25600
    v_mfma_f32_16x16x32_bf16 a[80:83], v[96:99], v[40:43], a[80:83]
    ds_read_b64_tr_b16 v[148:149], v24 offset:24576
    v_mfma_f32_16x16x32_bf16 a[84:87], v[96:99], v[44:47], a[84:87]
    ds_read_b64_tr_b16 v[150:151], v24 offset:25600
    v_mfma_f32_16x16x32_bf16 a[88:91], v[100:103], v[40:43], a[88:91]
    ds_read_b64_tr_b16 v[152:153], v25 offset:24576
    v_mfma_f32_16x16x32_bf16 a[92:95], v[100:103], v[44:47], a[92:95]
    ds_read_b64_tr_b16 v[154:155], v25 offset:25600
    v_mfma_f32_16x16x32_bf16 a[96:99], v[104:107], v[40:43], a[96:99]
    ds_read_b64_tr_b16 v[156:157], v26 offset:24576
    v_mfma_f32_16x16x32_bf16 a[100:103], v[104:107], v[44:47], a[100:103]
    ds_read_b64_tr_b16 v[158:159], v26 offset:25600
    v_mfma_f32_16x16x32_bf16 a[104:107], v[108:111], v[40:43], a[104:107]
    ds_read_b64_tr_b16 v[160:161], v27 offset:24576
    v_mfma_f32_16x16x32_bf16 a[108:111], v[108:111], v[44:47], a[108:111]
    ds_read_b64_tr_b16 v[162:163], v27 offset:25600
    ds_read_b64_tr_b16 v[164:165], v28 offset:24576
    ds_read_b64_tr_b16 v[166:167], v28 offset:25600
    s_waitcnt lgkmcnt(0)
    s_waitcnt vmcnt(12)
    s_barrier
    s_add_u32 s34, s32, 0
    s_mov_b32 m0, s34
    s_add_u32 s35, s30, 384
    buffer_load_dwordx4 v10, s[12:15], s35 offen lds
    s_add_u32 s34, s32, 1024
    s_mov_b32 m0, s34
    s_add_u32 s35, s30, 8576
    buffer_load_dwordx4 v11, s[12:15], s35 offen lds
    s_add_u32 s34, s32, 2048
    s_mov_b32 m0, s34
    s_add_u32 s35, s30, 16768
    buffer_load_dwordx4 v10, s[12:15], s35 offen lds
    s_add_u32 s34, s32, 3072
    s_mov_b32 m0, s34
    s_add_u32 s35, s30, 24960
    buffer_load_dwordx4 v11, s[12:15], s35 offen lds
    s_add_u32 s34, s33, 16384
    s_mov_b32 m0, s34
    s_add_u32 s35, s31, 688128
    buffer_load_dwordx4 v12, s[16:19], s35 offen lds
    s_add_u32 s34, s33, 17408
    s_mov_b32 m0, s34
    s_add_u32 s35, s31, 702464
    buffer_load_dwordx4 v12, s[16:19], s35 offen lds
    s_add_u32 s34, s33, 18432
    s_mov_b32 m0, s34
    s_add_u32 s35, s31, 716800
    buffer_load_dwordx4 v13, s[16:19], s35 offen lds
    s_add_u32 s34, s33, 19456
    s_mov_b32 m0, s34
    s_add_u32 s35, s31, 731136
    buffer_load_dwordx4 v13, s[16:19], s35 offen lds
    s_add_u32 s34, s33, 32768
    s_mov_b32 m0, s34
    s_add_u32 s35, s31, 688128
    buffer_load_dwordx4 v12, s[44:47], s35 offen lds
    s_add_u32 s34, s33, 33792
    s_mov_b32 m0, s34
    s_add_u32 s35, s31, 702464
    buffer_load_dwordx4 v12, s[44:47], s35 offen lds
    s_add_u32 s34, s33, 34816
    s_mov_b32 m0, s34
    s_add_u32 s35, s31, 716800
    buffer_load_dwordx4 v13, s[44:47], s35 offen lds
    s_add_u32 s34, s33, 35840
    s_mov_b32 m0, s34
    s_add_u32 s35, s31, 731136
    buffer_load_dwordx4 v13, s[44:47], s35 offen lds
    v_mfma_f32_16x16x32_bf16 a[0:3], v[112:115], v[48:51], a[0:3]
    ds_read_b128 v[40:43], v218 offset:0
    v_mfma_f32_16x16x32_bf16 a[4:7], v[112:115], v[52:55], a[4:7]
    ds_read_b128 v[44:47], v218 offset:2048
    v_mfma_f32_16x16x32_bf16 a[8:11], v[116:119], v[48:51], a[8:11]
    ds_read_b64_tr_b16 v[56:57], v220 offset:0
    v_mfma_f32_16x16x32_bf16 a[12:15], v[116:119], v[52:55], a[12:15]
    ds_read_b64_tr_b16 v[58:59], v220 offset:1024
    v_mfma_f32_16x16x32_bf16 a[16:19], v[120:123], v[48:51], a[16:19]
    ds_read_b64_tr_b16 v[60:61], v221 offset:0
    v_mfma_f32_16x16x32_bf16 a[20:23], v[120:123], v[52:55], a[20:23]
    ds_read_b64_tr_b16 v[62:63], v221 offset:1024
    v_mfma_f32_16x16x32_bf16 a[24:27], v[124:127], v[48:51], a[24:27]
    ds_read_b64_tr_b16 v[64:65], v222 offset:0
    v_mfma_f32_16x16x32_bf16 a[28:31], v[124:127], v[52:55], a[28:31]
    ds_read_b64_tr_b16 v[66:67], v222 offset:1024
    v_mfma_f32_16x16x32_bf16 a[32:35], v[128:131], v[48:51], a[32:35]
    ds_read_b64_tr_b16 v[68:69], v223 offset:0
    v_mfma_f32_16x16x32_bf16 a[36:39], v[128:131], v[52:55], a[36:39]
    ds_read_b64_tr_b16 v[70:71], v223 offset:1024
    v_mfma_f32_16x16x32_bf16 a[40:43], v[132:135], v[48:51], a[40:43]
    ds_read_b64_tr_b16 v[72:73], v224 offset:0
    v_mfma_f32_16x16x32_bf16 a[44:47], v[132:135], v[52:55], a[44:47]
    ds_read_b64_tr_b16 v[74:75], v224 offset:1024
    v_mfma_f32_16x16x32_bf16 a[48:51], v[136:139], v[48:51], a[48:51]
    ds_read_b64_tr_b16 v[76:77], v225 offset:0
    v_mfma_f32_16x16x32_bf16 a[52:55], v[136:139], v[52:55], a[52:55]
    ds_read_b64_tr_b16 v[78:79], v225 offset:1024
    v_mfma_f32_16x16x32_bf16 a[56:59], v[140:143], v[48:51], a[56:59]
    ds_read_b64_tr_b16 v[80:81], v226 offset:0
    v_mfma_f32_16x16x32_bf16 a[60:63], v[140:143], v[52:55], a[60:63]
    ds_read_b64_tr_b16 v[82:83], v226 offset:1024
    v_mfma_f32_16x16x32_bf16 a[64:67], v[144:147], v[48:51], a[64:67]
    ds_read_b64_tr_b16 v[84:85], v220 offset:16384
    v_mfma_f32_16x16x32_bf16 a[68:71], v[144:147], v[52:55], a[68:71]
    ds_read_b64_tr_b16 v[86:87], v220 offset:17408
    v_mfma_f32_16x16x32_bf16 a[72:75], v[148:151], v[48:51], a[72:75]
    ds_read_b64_tr_b16 v[88:89], v221 offset:16384
    v_mfma_f32_16x16x32_bf16 a[76:79], v[148:151], v[52:55], a[76:79]
    ds_read_b64_tr_b16 v[90:91], v221 offset:17408
    v_mfma_f32_16x16x32_bf16 a[80:83], v[152:155], v[48:51], a[80:83]
    ds_read_b64_tr_b16 v[92:93], v222 offset:16384
    v_mfma_f32_16x16x32_bf16 a[84:87], v[152:155], v[52:55], a[84:87]
    ds_read_b64_tr_b16 v[94:95], v222 offset:17408
    v_mfma_f32_16x16x32_bf16 a[88:91], v[156:159], v[48:51], a[88:91]
    ds_read_b64_tr_b16 v[96:97], v223 offset:16384
    v_mfma_f32_16x16x32_bf16 a[92:95], v[156:159], v[52:55], a[92:95]
    ds_read_b64_tr_b16 v[98:99], v223 offset:17408
    v_mfma_f32_16x16x32_bf16 a[96:99], v[160:163], v[48:51], a[96:99]
    ds_read_b64_tr_b16 v[100:101], v224 offset:16384
    v_mfma_f32_16x16x32_bf16 a[100:103], v[160:163], v[52:55], a[100:103]
    ds_read_b64_tr_b16 v[102:103], v224 offset:17408
    v_mfma_f32_16x16x32_bf16 a[104:107], v[164:167], v[48:51], a[104:107]
    ds_read_b64_tr_b16 v[104:105], v225 offset:16384
    v_mfma_f32_16x16x32_bf16 a[108:111], v[164:167], v[52:55], a[108:111]
    ds_read_b64_tr_b16 v[106:107], v225 offset:17408
    ds_read_b64_tr_b16 v[108:109], v226 offset:16384
    ds_read_b64_tr_b16 v[110:111], v226 offset:17408
    s_waitcnt lgkmcnt(0)
    v_mfma_f32_16x16x32_bf16 a[0:3], v[56:59], v[40:43], a[0:3]
    ds_read_b128 v[48:51], v219 offset:0
    v_mfma_f32_16x16x32_bf16 a[4:7], v[56:59], v[44:47], a[4:7]
    ds_read_b128 v[52:55], v219 offset:2048
    v_mfma_f32_16x16x32_bf16 a[8:11], v[60:63], v[40:43], a[8:11]
    ds_read_b64_tr_b16 v[112:113], v220 offset:8192
    v_mfma_f32_16x16x32_bf16 a[12:15], v[60:63], v[44:47], a[12:15]
    ds_read_b64_tr_b16 v[114:115], v220 offset:9216
    v_mfma_f32_16x16x32_bf16 a[16:19], v[64:67], v[40:43], a[16:19]
    ds_read_b64_tr_b16 v[116:117], v221 offset:8192
    v_mfma_f32_16x16x32_bf16 a[20:23], v[64:67], v[44:47], a[20:23]
    ds_read_b64_tr_b16 v[118:119], v221 offset:9216
    v_mfma_f32_16x16x32_bf16 a[24:27], v[68:71], v[40:43], a[24:27]
    ds_read_b64_tr_b16 v[120:121], v222 offset:8192
    v_mfma_f32_16x16x32_bf16 a[28:31], v[68:71], v[44:47], a[28:31]
    ds_read_b64_tr_b16 v[122:123], v222 offset:9216
    v_mfma_f32_16x16x32_bf16 a[32:35], v[72:75], v[40:43], a[32:35]
    ds_read_b64_tr_b16 v[124:125], v223 offset:8192
    v_mfma_f32_16x16x32_bf16 a[36:39], v[72:75], v[44:47], a[36:39]
    ds_read_b64_tr_b16 v[126:127], v223 offset:9216
    v_mfma_f32_16x16x32_bf16 a[40:43], v[76:79], v[40:43], a[40:43]
    ds_read_b64_tr_b16 v[128:129], v224 offset:8192
    v_mfma_f32_16x16x32_bf16 a[44:47], v[76:79], v[44:47], a[44:47]
    ds_read_b64_tr_b16 v[130:131], v224 offset:9216
    v_mfma_f32_16x16x32_bf16 a[48:51], v[80:83], v[40:43], a[48:51]
    ds_read_b64_tr_b16 v[132:133], v225 offset:8192
    v_mfma_f32_16x16x32_bf16 a[52:55], v[80:83], v[44:47], a[52:55]
    ds_read_b64_tr_b16 v[134:135], v225 offset:9216
    v_mfma_f32_16x16x32_bf16 a[56:59], v[84:87], v[40:43], a[56:59]
    ds_read_b64_tr_b16 v[136:137], v226 offset:8192
    v_mfma_f32_16x16x32_bf16 a[60:63], v[84:87], v[44:47], a[60:63]
    ds_read_b64_tr_b16 v[138:139], v226 offset:9216
    v_mfma_f32_16x16x32_bf16 a[64:67], v[88:91], v[40:43], a[64:67]
    ds_read_b64_tr_b16 v[140:141], v220 offset:24576
    v_mfma_f32_16x16x32_bf16 a[68:71], v[88:91], v[44:47], a[68:71]
    ds_read_b64_tr_b16 v[142:143], v220 offset:25600
    v_mfma_f32_16x16x32_bf16 a[72:75], v[92:95], v[40:43], a[72:75]
    ds_read_b64_tr_b16 v[144:145], v221 offset:24576
    v_mfma_f32_16x16x32_bf16 a[76:79], v[92:95], v[44:47], a[76:79]
    ds_read_b64_tr_b16 v[146:147], v221 offset:25600
    v_mfma_f32_16x16x32_bf16 a[80:83], v[96:99], v[40:43], a[80:83]
    ds_read_b64_tr_b16 v[148:149], v222 offset:24576
    v_mfma_f32_16x16x32_bf16 a[84:87], v[96:99], v[44:47], a[84:87]
    ds_read_b64_tr_b16 v[150:151], v222 offset:25600
    v_mfma_f32_16x16x32_bf16 a[88:91], v[100:103], v[40:43], a[88:91]
    ds_read_b64_tr_b16 v[152:153], v223 offset:24576
    v_mfma_f32_16x16x32_bf16 a[92:95], v[100:103], v[44:47], a[92:95]
    ds_read_b64_tr_b16 v[154:155], v223 offset:25600
    v_mfma_f32_16x16x32_bf16 a[96:99], v[104:107], v[40:43], a[96:99]
    ds_read_b64_tr_b16 v[156:157], v224 offset:24576
    v_mfma_f32_16x16x32_bf16 a[100:103], v[104:107], v[44:47], a[100:103]
    ds_read_b64_tr_b16 v[158:159], v224 offset:25600
    v_mfma_f32_16x16x32_bf16 a[104:107], v[108:111], v[40:43], a[104:107]
    ds_read_b64_tr_b16 v[160:161], v225 offset:24576
    v_mfma_f32_16x16x32_bf16 a[108:111], v[108:111], v[44:47], a[108:111]
    ds_read_b64_tr_b16 v[162:163], v225 offset:25600
    ds_read_b64_tr_b16 v[164:165], v226 offset:24576
    ds_read_b64_tr_b16 v[166:167], v226 offset:25600
    s_waitcnt lgkmcnt(0)
    s_waitcnt vmcnt(12)
    s_barrier
    s_add_u32 s34, s32, 49152
    s_mov_b32 m0, s34
    s_add_u32 s35, s30, 512
    buffer_load_dwordx4 v10, s[12:15], s35 offen lds
    s_add_u32 s34, s32, 50176
    s_mov_b32 m0, s34
    s_add_u32 s35, s30, 8704
    buffer_load_dwordx4 v11, s[12:15], s35 offen lds
    s_add_u32 s34, s32, 51200
    s_mov_b32 m0, s34
    s_add_u32 s35, s30, 16896
    buffer_load_dwordx4 v10, s[12:15], s35 offen lds
    s_add_u32 s34, s32, 52224
    s_mov_b32 m0, s34
    s_add_u32 s35, s30, 25088
    buffer_load_dwordx4 v11, s[12:15], s35 offen lds
    s_add_u32 s34, s33, 65536
    s_mov_b32 m0, s34
    s_add_u32 s35, s31, 917504
    buffer_load_dwordx4 v12, s[16:19], s35 offen lds
    s_add_u32 s34, s33, 66560
    s_mov_b32 m0, s34
    s_add_u32 s35, s31, 931840
    buffer_load_dwordx4 v12, s[16:19], s35 offen lds
    s_add_u32 s34, s33, 67584
    s_mov_b32 m0, s34
    s_add_u32 s35, s31, 946176
    buffer_load_dwordx4 v13, s[16:19], s35 offen lds
    s_add_u32 s34, s33, 68608
    s_mov_b32 m0, s34
    s_add_u32 s35, s31, 960512
    buffer_load_dwordx4 v13, s[16:19], s35 offen lds
    s_add_u32 s34, s33, 81920
    s_mov_b32 m0, s34
    s_add_u32 s35, s31, 917504
    buffer_load_dwordx4 v12, s[44:47], s35 offen lds
    s_add_u32 s34, s33, 82944
    s_mov_b32 m0, s34
    s_add_u32 s35, s31, 931840
    buffer_load_dwordx4 v12, s[44:47], s35 offen lds
    s_add_u32 s34, s33, 83968
    s_mov_b32 m0, s34
    s_add_u32 s35, s31, 946176
    buffer_load_dwordx4 v13, s[44:47], s35 offen lds
    s_add_u32 s34, s33, 84992
    s_mov_b32 m0, s34
    s_add_u32 s35, s31, 960512
    buffer_load_dwordx4 v13, s[44:47], s35 offen lds
    v_mfma_f32_16x16x32_bf16 a[0:3], v[112:115], v[48:51], a[0:3]
    ds_read_b128 v[40:43], v30 offset:0
    v_mfma_f32_16x16x32_bf16 a[4:7], v[112:115], v[52:55], a[4:7]
    ds_read_b128 v[44:47], v30 offset:2048
    v_mfma_f32_16x16x32_bf16 a[8:11], v[116:119], v[48:51], a[8:11]
    ds_read_b64_tr_b16 v[56:57], v32 offset:0
    v_mfma_f32_16x16x32_bf16 a[12:15], v[116:119], v[52:55], a[12:15]
    ds_read_b64_tr_b16 v[58:59], v32 offset:1024
    v_mfma_f32_16x16x32_bf16 a[16:19], v[120:123], v[48:51], a[16:19]
    ds_read_b64_tr_b16 v[60:61], v33 offset:0
    v_mfma_f32_16x16x32_bf16 a[20:23], v[120:123], v[52:55], a[20:23]
    ds_read_b64_tr_b16 v[62:63], v33 offset:1024
    v_mfma_f32_16x16x32_bf16 a[24:27], v[124:127], v[48:51], a[24:27]
    ds_read_b64_tr_b16 v[64:65], v34 offset:0
    v_mfma_f32_16x16x32_bf16 a[28:31], v[124:127], v[52:55], a[28:31]
    ds_read_b64_tr_b16 v[66:67], v34 offset:1024
    v_mfma_f32_16x16x32_bf16 a[32:35], v[128:131], v[48:51], a[32:35]
    ds_read_b64_tr_b16 v[68:69], v35 offset:0
    v_mfma_f32_16x16x32_bf16 a[36:39], v[128:131], v[52:55], a[36:39]
    ds_read_b64_tr_b16 v[70:71], v35 offset:1024
    v_mfma_f32_16x16x32_bf16 a[40:43], v[132:135], v[48:51], a[40:43]
    ds_read_b64_tr_b16 v[72:73], v36 offset:0
    v_mfma_f32_16x16x32_bf16 a[44:47], v[132:135], v[52:55], a[44:47]
    ds_read_b64_tr_b16 v[74:75], v36 offset:1024
    v_mfma_f32_16x16x32_bf16 a[48:51], v[136:139], v[48:51], a[48:51]
    ds_read_b64_tr_b16 v[76:77], v37 offset:0
    v_mfma_f32_16x16x32_bf16 a[52:55], v[136:139], v[52:55], a[52:55]
    ds_read_b64_tr_b16 v[78:79], v37 offset:1024
    v_mfma_f32_16x16x32_bf16 a[56:59], v[140:143], v[48:51], a[56:59]
    ds_read_b64_tr_b16 v[80:81], v38 offset:0
    v_mfma_f32_16x16x32_bf16 a[60:63], v[140:143], v[52:55], a[60:63]
    ds_read_b64_tr_b16 v[82:83], v38 offset:1024
    v_mfma_f32_16x16x32_bf16 a[64:67], v[144:147], v[48:51], a[64:67]
    ds_read_b64_tr_b16 v[84:85], v32 offset:16384
    v_mfma_f32_16x16x32_bf16 a[68:71], v[144:147], v[52:55], a[68:71]
    ds_read_b64_tr_b16 v[86:87], v32 offset:17408
    v_mfma_f32_16x16x32_bf16 a[72:75], v[148:151], v[48:51], a[72:75]
    ds_read_b64_tr_b16 v[88:89], v33 offset:16384
    v_mfma_f32_16x16x32_bf16 a[76:79], v[148:151], v[52:55], a[76:79]
    ds_read_b64_tr_b16 v[90:91], v33 offset:17408
    v_mfma_f32_16x16x32_bf16 a[80:83], v[152:155], v[48:51], a[80:83]
    ds_read_b64_tr_b16 v[92:93], v34 offset:16384
    v_mfma_f32_16x16x32_bf16 a[84:87], v[152:155], v[52:55], a[84:87]
    ds_read_b64_tr_b16 v[94:95], v34 offset:17408
    v_mfma_f32_16x16x32_bf16 a[88:91], v[156:159], v[48:51], a[88:91]
    ds_read_b64_tr_b16 v[96:97], v35 offset:16384
    v_mfma_f32_16x16x32_bf16 a[92:95], v[156:159], v[52:55], a[92:95]
    ds_read_b64_tr_b16 v[98:99], v35 offset:17408
    v_mfma_f32_16x16x32_bf16 a[96:99], v[160:163], v[48:51], a[96:99]
    ds_read_b64_tr_b16 v[100:101], v36 offset:16384
    v_mfma_f32_16x16x32_bf16 a[100:103], v[160:163], v[52:55], a[100:103]
    ds_read_b64_tr_b16 v[102:103], v36 offset:17408
    v_mfma_f32_16x16x32_bf16 a[104:107], v[164:167], v[48:51], a[104:107]
    ds_read_b64_tr_b16 v[104:105], v37 offset:16384
    v_mfma_f32_16x16x32_bf16 a[108:111], v[164:167], v[52:55], a[108:111]
    ds_read_b64_tr_b16 v[106:107], v37 offset:17408
    ds_read_b64_tr_b16 v[108:109], v38 offset:16384
    ds_read_b64_tr_b16 v[110:111], v38 offset:17408
    s_waitcnt lgkmcnt(0)
    v_mfma_f32_16x16x32_bf16 a[0:3], v[56:59], v[40:43], a[0:3]
    ds_read_b128 v[48:51], v31 offset:0
    v_mfma_f32_16x16x32_bf16 a[4:7], v[56:59], v[44:47], a[4:7]
    ds_read_b128 v[52:55], v31 offset:2048
    v_mfma_f32_16x16x32_bf16 a[8:11], v[60:63], v[40:43], a[8:11]
    ds_read_b64_tr_b16 v[112:113], v32 offset:8192
    v_mfma_f32_16x16x32_bf16 a[12:15], v[60:63], v[44:47], a[12:15]
    ds_read_b64_tr_b16 v[114:115], v32 offset:9216
    v_mfma_f32_16x16x32_bf16 a[16:19], v[64:67], v[40:43], a[16:19]
    ds_read_b64_tr_b16 v[116:117], v33 offset:8192
    v_mfma_f32_16x16x32_bf16 a[20:23], v[64:67], v[44:47], a[20:23]
    ds_read_b64_tr_b16 v[118:119], v33 offset:9216
    v_mfma_f32_16x16x32_bf16 a[24:27], v[68:71], v[40:43], a[24:27]
    ds_read_b64_tr_b16 v[120:121], v34 offset:8192
    v_mfma_f32_16x16x32_bf16 a[28:31], v[68:71], v[44:47], a[28:31]
    ds_read_b64_tr_b16 v[122:123], v34 offset:9216
    v_mfma_f32_16x16x32_bf16 a[32:35], v[72:75], v[40:43], a[32:35]
    ds_read_b64_tr_b16 v[124:125], v35 offset:8192
    v_mfma_f32_16x16x32_bf16 a[36:39], v[72:75], v[44:47], a[36:39]
    ds_read_b64_tr_b16 v[126:127], v35 offset:9216
    v_mfma_f32_16x16x32_bf16 a[40:43], v[76:79], v[40:43], a[40:43]
    ds_read_b64_tr_b16 v[128:129], v36 offset:8192
    v_mfma_f32_16x16x32_bf16 a[44:47], v[76:79], v[44:47], a[44:47]
    ds_read_b64_tr_b16 v[130:131], v36 offset:9216
    v_mfma_f32_16x16x32_bf16 a[48:51], v[80:83], v[40:43], a[48:51]
    ds_read_b64_tr_b16 v[132:133], v37 offset:8192
    v_mfma_f32_16x16x32_bf16 a[52:55], v[80:83], v[44:47], a[52:55]
    ds_read_b64_tr_b16 v[134:135], v37 offset:9216
    v_mfma_f32_16x16x32_bf16 a[56:59], v[84:87], v[40:43], a[56:59]
    ds_read_b64_tr_b16 v[136:137], v38 offset:8192
    v_mfma_f32_16x16x32_bf16 a[60:63], v[84:87], v[44:47], a[60:63]
    ds_read_b64_tr_b16 v[138:139], v38 offset:9216
    v_mfma_f32_16x16x32_bf16 a[64:67], v[88:91], v[40:43], a[64:67]
    ds_read_b64_tr_b16 v[140:141], v32 offset:24576
    v_mfma_f32_16x16x32_bf16 a[68:71], v[88:91], v[44:47], a[68:71]
    ds_read_b64_tr_b16 v[142:143], v32 offset:25600
    v_mfma_f32_16x16x32_bf16 a[72:75], v[92:95], v[40:43], a[72:75]
    ds_read_b64_tr_b16 v[144:145], v33 offset:24576
    v_mfma_f32_16x16x32_bf16 a[76:79], v[92:95], v[44:47], a[76:79]
    ds_read_b64_tr_b16 v[146:147], v33 offset:25600
    v_mfma_f32_16x16x32_bf16 a[80:83], v[96:99], v[40:43], a[80:83]
    ds_read_b64_tr_b16 v[148:149], v34 offset:24576
    v_mfma_f32_16x16x32_bf16 a[84:87], v[96:99], v[44:47], a[84:87]
    ds_read_b64_tr_b16 v[150:151], v34 offset:25600
    v_mfma_f32_16x16x32_bf16 a[88:91], v[100:103], v[40:43], a[88:91]
    ds_read_b64_tr_b16 v[152:153], v35 offset:24576
    v_mfma_f32_16x16x32_bf16 a[92:95], v[100:103], v[44:47], a[92:95]
    ds_read_b64_tr_b16 v[154:155], v35 offset:25600
    v_mfma_f32_16x16x32_bf16 a[96:99], v[104:107], v[40:43], a[96:99]
    ds_read_b64_tr_b16 v[156:157], v36 offset:24576
    v_mfma_f32_16x16x32_bf16 a[100:103], v[104:107], v[44:47], a[100:103]
    ds_read_b64_tr_b16 v[158:159], v36 offset:25600
    v_mfma_f32_16x16x32_bf16 a[104:107], v[108:111], v[40:43], a[104:107]
    ds_read_b64_tr_b16 v[160:161], v37 offset:24576
    v_mfma_f32_16x16x32_bf16 a[108:111], v[108:111], v[44:47], a[108:111]
    ds_read_b64_tr_b16 v[162:163], v37 offset:25600
    ds_read_b64_tr_b16 v[164:165], v38 offset:24576
    ds_read_b64_tr_b16 v[166:167], v38 offset:25600
    s_waitcnt lgkmcnt(0)
    s_waitcnt vmcnt(12)
    s_barrier
    s_add_u32 s34, s32, 98304
    s_mov_b32 m0, s34
    s_add_u32 s35, s30, 640
    buffer_load_dwordx4 v10, s[12:15], s35 offen lds
    s_add_u32 s34, s32, 99328
    s_mov_b32 m0, s34
    s_add_u32 s35, s30, 8832
    buffer_load_dwordx4 v11, s[12:15], s35 offen lds
    s_add_u32 s34, s32, 100352
    s_mov_b32 m0, s34
    s_add_u32 s35, s30, 17024
    buffer_load_dwordx4 v10, s[12:15], s35 offen lds
    s_add_u32 s34, s32, 101376
    s_mov_b32 m0, s34
    s_add_u32 s35, s30, 25216
    buffer_load_dwordx4 v11, s[12:15], s35 offen lds
    s_add_u32 s34, s33, 114688
    s_mov_b32 m0, s34
    s_add_u32 s35, s31, 1146880
    buffer_load_dwordx4 v12, s[16:19], s35 offen lds
    s_add_u32 s34, s33, 115712
    s_mov_b32 m0, s34
    s_add_u32 s35, s31, 1161216
    buffer_load_dwordx4 v12, s[16:19], s35 offen lds
    s_add_u32 s34, s33, 116736
    s_mov_b32 m0, s34
    s_add_u32 s35, s31, 1175552
    buffer_load_dwordx4 v13, s[16:19], s35 offen lds
    s_add_u32 s34, s33, 117760
    s_mov_b32 m0, s34
    s_add_u32 s35, s31, 1189888
    buffer_load_dwordx4 v13, s[16:19], s35 offen lds
    s_add_u32 s34, s33, 131072
    s_mov_b32 m0, s34
    s_add_u32 s35, s31, 1146880
    buffer_load_dwordx4 v12, s[44:47], s35 offen lds
    s_add_u32 s34, s33, 132096
    s_mov_b32 m0, s34
    s_add_u32 s35, s31, 1161216
    buffer_load_dwordx4 v12, s[44:47], s35 offen lds
    s_add_u32 s34, s33, 133120
    s_mov_b32 m0, s34
    s_add_u32 s35, s31, 1175552
    buffer_load_dwordx4 v13, s[44:47], s35 offen lds
    s_add_u32 s34, s33, 134144
    s_mov_b32 m0, s34
    s_add_u32 s35, s31, 1189888
    buffer_load_dwordx4 v13, s[44:47], s35 offen lds
    v_mfma_f32_16x16x32_bf16 a[0:3], v[112:115], v[48:51], a[0:3]
    ds_read_b128 v[40:43], v20 offset:0
    v_mfma_f32_16x16x32_bf16 a[4:7], v[112:115], v[52:55], a[4:7]
    ds_read_b128 v[44:47], v20 offset:2048
    v_mfma_f32_16x16x32_bf16 a[8:11], v[116:119], v[48:51], a[8:11]
    ds_read_b64_tr_b16 v[56:57], v22 offset:0
    v_mfma_f32_16x16x32_bf16 a[12:15], v[116:119], v[52:55], a[12:15]
    ds_read_b64_tr_b16 v[58:59], v22 offset:1024
    v_mfma_f32_16x16x32_bf16 a[16:19], v[120:123], v[48:51], a[16:19]
    ds_read_b64_tr_b16 v[60:61], v23 offset:0
    v_mfma_f32_16x16x32_bf16 a[20:23], v[120:123], v[52:55], a[20:23]
    ds_read_b64_tr_b16 v[62:63], v23 offset:1024
    v_mfma_f32_16x16x32_bf16 a[24:27], v[124:127], v[48:51], a[24:27]
    ds_read_b64_tr_b16 v[64:65], v24 offset:0
    v_mfma_f32_16x16x32_bf16 a[28:31], v[124:127], v[52:55], a[28:31]
    ds_read_b64_tr_b16 v[66:67], v24 offset:1024
    v_mfma_f32_16x16x32_bf16 a[32:35], v[128:131], v[48:51], a[32:35]
    ds_read_b64_tr_b16 v[68:69], v25 offset:0
    v_mfma_f32_16x16x32_bf16 a[36:39], v[128:131], v[52:55], a[36:39]
    ds_read_b64_tr_b16 v[70:71], v25 offset:1024
    v_mfma_f32_16x16x32_bf16 a[40:43], v[132:135], v[48:51], a[40:43]
    ds_read_b64_tr_b16 v[72:73], v26 offset:0
    v_mfma_f32_16x16x32_bf16 a[44:47], v[132:135], v[52:55], a[44:47]
    ds_read_b64_tr_b16 v[74:75], v26 offset:1024
    v_mfma_f32_16x16x32_bf16 a[48:51], v[136:139], v[48:51], a[48:51]
    ds_read_b64_tr_b16 v[76:77], v27 offset:0
    v_mfma_f32_16x16x32_bf16 a[52:55], v[136:139], v[52:55], a[52:55]
    ds_read_b64_tr_b16 v[78:79], v27 offset:1024
    v_mfma_f32_16x16x32_bf16 a[56:59], v[140:143], v[48:51], a[56:59]
    ds_read_b64_tr_b16 v[80:81], v28 offset:0
    v_mfma_f32_16x16x32_bf16 a[60:63], v[140:143], v[52:55], a[60:63]
    ds_read_b64_tr_b16 v[82:83], v28 offset:1024
    v_mfma_f32_16x16x32_bf16 a[64:67], v[144:147], v[48:51], a[64:67]
    ds_read_b64_tr_b16 v[84:85], v22 offset:16384
    v_mfma_f32_16x16x32_bf16 a[68:71], v[144:147], v[52:55], a[68:71]
    ds_read_b64_tr_b16 v[86:87], v22 offset:17408
    v_mfma_f32_16x16x32_bf16 a[72:75], v[148:151], v[48:51], a[72:75]
    ds_read_b64_tr_b16 v[88:89], v23 offset:16384
    v_mfma_f32_16x16x32_bf16 a[76:79], v[148:151], v[52:55], a[76:79]
    ds_read_b64_tr_b16 v[90:91], v23 offset:17408
    v_mfma_f32_16x16x32_bf16 a[80:83], v[152:155], v[48:51], a[80:83]
    ds_read_b64_tr_b16 v[92:93], v24 offset:16384
    v_mfma_f32_16x16x32_bf16 a[84:87], v[152:155], v[52:55], a[84:87]
    ds_read_b64_tr_b16 v[94:95], v24 offset:17408
    v_mfma_f32_16x16x32_bf16 a[88:91], v[156:159], v[48:51], a[88:91]
    ds_read_b64_tr_b16 v[96:97], v25 offset:16384
    v_mfma_f32_16x16x32_bf16 a[92:95], v[156:159], v[52:55], a[92:95]
    ds_read_b64_tr_b16 v[98:99], v25 offset:17408
    v_mfma_f32_16x16x32_bf16 a[96:99], v[160:163], v[48:51], a[96:99]
    ds_read_b64_tr_b16 v[100:101], v26 offset:16384
    v_mfma_f32_16x16x32_bf16 a[100:103], v[160:163], v[52:55], a[100:103]
    ds_read_b64_tr_b16 v[102:103], v26 offset:17408
    v_mfma_f32_16x16x32_bf16 a[104:107], v[164:167], v[48:51], a[104:107]
    ds_read_b64_tr_b16 v[104:105], v27 offset:16384
    v_mfma_f32_16x16x32_bf16 a[108:111], v[164:167], v[52:55], a[108:111]
    ds_read_b64_tr_b16 v[106:107], v27 offset:17408
    ds_read_b64_tr_b16 v[108:109], v28 offset:16384
    ds_read_b64_tr_b16 v[110:111], v28 offset:17408
    s_waitcnt lgkmcnt(0)
    v_mfma_f32_16x16x32_bf16 a[0:3], v[56:59], v[40:43], a[0:3]
    ds_read_b128 v[48:51], v21 offset:0
    v_mfma_f32_16x16x32_bf16 a[4:7], v[56:59], v[44:47], a[4:7]
    ds_read_b128 v[52:55], v21 offset:2048
    v_mfma_f32_16x16x32_bf16 a[8:11], v[60:63], v[40:43], a[8:11]
    ds_read_b64_tr_b16 v[112:113], v22 offset:8192
    v_mfma_f32_16x16x32_bf16 a[12:15], v[60:63], v[44:47], a[12:15]
    ds_read_b64_tr_b16 v[114:115], v22 offset:9216
    v_mfma_f32_16x16x32_bf16 a[16:19], v[64:67], v[40:43], a[16:19]
    ds_read_b64_tr_b16 v[116:117], v23 offset:8192
    v_mfma_f32_16x16x32_bf16 a[20:23], v[64:67], v[44:47], a[20:23]
    ds_read_b64_tr_b16 v[118:119], v23 offset:9216
    v_mfma_f32_16x16x32_bf16 a[24:27], v[68:71], v[40:43], a[24:27]
    ds_read_b64_tr_b16 v[120:121], v24 offset:8192
    v_mfma_f32_16x16x32_bf16 a[28:31], v[68:71], v[44:47], a[28:31]
    ds_read_b64_tr_b16 v[122:123], v24 offset:9216
    v_mfma_f32_16x16x32_bf16 a[32:35], v[72:75], v[40:43], a[32:35]
    ds_read_b64_tr_b16 v[124:125], v25 offset:8192
    v_mfma_f32_16x16x32_bf16 a[36:39], v[72:75], v[44:47], a[36:39]
    ds_read_b64_tr_b16 v[126:127], v25 offset:9216
    v_mfma_f32_16x16x32_bf16 a[40:43], v[76:79], v[40:43], a[40:43]
    ds_read_b64_tr_b16 v[128:129], v26 offset:8192
    v_mfma_f32_16x16x32_bf16 a[44:47], v[76:79], v[44:47], a[44:47]
    ds_read_b64_tr_b16 v[130:131], v26 offset:9216
    v_mfma_f32_16x16x32_bf16 a[48:51], v[80:83], v[40:43], a[48:51]
    ds_read_b64_tr_b16 v[132:133], v27 offset:8192
    v_mfma_f32_16x16x32_bf16 a[52:55], v[80:83], v[44:47], a[52:55]
    ds_read_b64_tr_b16 v[134:135], v27 offset:9216
    v_mfma_f32_16x16x32_bf16 a[56:59], v[84:87], v[40:43], a[56:59]
    ds_read_b64_tr_b16 v[136:137], v28 offset:8192
    v_mfma_f32_16x16x32_bf16 a[60:63], v[84:87], v[44:47], a[60:63]
    ds_read_b64_tr_b16 v[138:139], v28 offset:9216
    v_mfma_f32_16x16x32_bf16 a[64:67], v[88:91], v[40:43], a[64:67]
    ds_read_b64_tr_b16 v[140:141], v22 offset:24576
    v_mfma_f32_16x16x32_bf16 a[68:71], v[88:91], v[44:47], a[68:71]
    ds_read_b64_tr_b16 v[142:143], v22 offset:25600
    v_mfma_f32_16x16x32_bf16 a[72:75], v[92:95], v[40:43], a[72:75]
    ds_read_b64_tr_b16 v[144:145], v23 offset:24576
    v_mfma_f32_16x16x32_bf16 a[76:79], v[92:95], v[44:47], a[76:79]
    ds_read_b64_tr_b16 v[146:147], v23 offset:25600
    v_mfma_f32_16x16x32_bf16 a[80:83], v[96:99], v[40:43], a[80:83]
    ds_read_b64_tr_b16 v[148:149], v24 offset:24576
    v_mfma_f32_16x16x32_bf16 a[84:87], v[96:99], v[44:47], a[84:87]
    ds_read_b64_tr_b16 v[150:151], v24 offset:25600
    v_mfma_f32_16x16x32_bf16 a[88:91], v[100:103], v[40:43], a[88:91]
    ds_read_b64_tr_b16 v[152:153], v25 offset:24576
    v_mfma_f32_16x16x32_bf16 a[92:95], v[100:103], v[44:47], a[92:95]
    ds_read_b64_tr_b16 v[154:155], v25 offset:25600
    v_mfma_f32_16x16x32_bf16 a[96:99], v[104:107], v[40:43], a[96:99]
    ds_read_b64_tr_b16 v[156:157], v26 offset:24576
    v_mfma_f32_16x16x32_bf16 a[100:103], v[104:107], v[44:47], a[100:103]
    ds_read_b64_tr_b16 v[158:159], v26 offset:25600
    v_mfma_f32_16x16x32_bf16 a[104:107], v[108:111], v[40:43], a[104:107]
    ds_read_b64_tr_b16 v[160:161], v27 offset:24576
    v_mfma_f32_16x16x32_bf16 a[108:111], v[108:111], v[44:47], a[108:111]
    ds_read_b64_tr_b16 v[162:163], v27 offset:25600
    ds_read_b64_tr_b16 v[164:165], v28 offset:24576
    ds_read_b64_tr_b16 v[166:167], v28 offset:25600
    s_waitcnt lgkmcnt(0)
    s_waitcnt vmcnt(12)
    s_barrier
    s_add_u32 s34, s32, 0
    s_mov_b32 m0, s34
    s_add_u32 s35, s30, 768
    buffer_load_dwordx4 v10, s[12:15], s35 offen lds
    s_add_u32 s34, s32, 1024
    s_mov_b32 m0, s34
    s_add_u32 s35, s30, 8960
    buffer_load_dwordx4 v11, s[12:15], s35 offen lds
    s_add_u32 s34, s32, 2048
    s_mov_b32 m0, s34
    s_add_u32 s35, s30, 17152
    buffer_load_dwordx4 v10, s[12:15], s35 offen lds
    s_add_u32 s34, s32, 3072
    s_mov_b32 m0, s34
    s_add_u32 s35, s30, 25344
    buffer_load_dwordx4 v11, s[12:15], s35 offen lds
    s_add_u32 s34, s33, 16384
    s_mov_b32 m0, s34
    s_add_u32 s35, s31, 1376256
    buffer_load_dwordx4 v12, s[16:19], s35 offen lds
    s_add_u32 s34, s33, 17408
    s_mov_b32 m0, s34
    s_add_u32 s35, s31, 1390592
    buffer_load_dwordx4 v12, s[16:19], s35 offen lds
    s_add_u32 s34, s33, 18432
    s_mov_b32 m0, s34
    s_add_u32 s35, s31, 1404928
    buffer_load_dwordx4 v13, s[16:19], s35 offen lds
    s_add_u32 s34, s33, 19456
    s_mov_b32 m0, s34
    s_add_u32 s35, s31, 1419264
    buffer_load_dwordx4 v13, s[16:19], s35 offen lds
    s_add_u32 s34, s33, 32768
    s_mov_b32 m0, s34
    s_add_u32 s35, s31, 1376256
    buffer_load_dwordx4 v12, s[44:47], s35 offen lds
    s_add_u32 s34, s33, 33792
    s_mov_b32 m0, s34
    s_add_u32 s35, s31, 1390592
    buffer_load_dwordx4 v12, s[44:47], s35 offen lds
    s_add_u32 s34, s33, 34816
    s_mov_b32 m0, s34
    s_add_u32 s35, s31, 1404928
    buffer_load_dwordx4 v13, s[44:47], s35 offen lds
    s_add_u32 s34, s33, 35840
    s_mov_b32 m0, s34
    s_add_u32 s35, s31, 1419264
    buffer_load_dwordx4 v13, s[44:47], s35 offen lds
    v_mfma_f32_16x16x32_bf16 a[0:3], v[112:115], v[48:51], a[0:3]
    ds_read_b128 v[40:43], v218 offset:0
    v_mfma_f32_16x16x32_bf16 a[4:7], v[112:115], v[52:55], a[4:7]
    ds_read_b128 v[44:47], v218 offset:2048
    v_mfma_f32_16x16x32_bf16 a[8:11], v[116:119], v[48:51], a[8:11]
    ds_read_b64_tr_b16 v[56:57], v220 offset:0
    v_mfma_f32_16x16x32_bf16 a[12:15], v[116:119], v[52:55], a[12:15]
    ds_read_b64_tr_b16 v[58:59], v220 offset:1024
    v_mfma_f32_16x16x32_bf16 a[16:19], v[120:123], v[48:51], a[16:19]
    ds_read_b64_tr_b16 v[60:61], v221 offset:0
    v_mfma_f32_16x16x32_bf16 a[20:23], v[120:123], v[52:55], a[20:23]
    ds_read_b64_tr_b16 v[62:63], v221 offset:1024
    v_mfma_f32_16x16x32_bf16 a[24:27], v[124:127], v[48:51], a[24:27]
    ds_read_b64_tr_b16 v[64:65], v222 offset:0
    v_mfma_f32_16x16x32_bf16 a[28:31], v[124:127], v[52:55], a[28:31]
    ds_read_b64_tr_b16 v[66:67], v222 offset:1024
    v_mfma_f32_16x16x32_bf16 a[32:35], v[128:131], v[48:51], a[32:35]
    ds_read_b64_tr_b16 v[68:69], v223 offset:0
    v_mfma_f32_16x16x32_bf16 a[36:39], v[128:131], v[52:55], a[36:39]
    ds_read_b64_tr_b16 v[70:71], v223 offset:1024
    v_mfma_f32_16x16x32_bf16 a[40:43], v[132:135], v[48:51], a[40:43]
    ds_read_b64_tr_b16 v[72:73], v224 offset:0
    v_mfma_f32_16x16x32_bf16 a[44:47], v[132:135], v[52:55], a[44:47]
    ds_read_b64_tr_b16 v[74:75], v224 offset:1024
    v_mfma_f32_16x16x32_bf16 a[48:51], v[136:139], v[48:51], a[48:51]
    ds_read_b64_tr_b16 v[76:77], v225 offset:0
    v_mfma_f32_16x16x32_bf16 a[52:55], v[136:139], v[52:55], a[52:55]
    ds_read_b64_tr_b16 v[78:79], v225 offset:1024
    v_mfma_f32_16x16x32_bf16 a[56:59], v[140:143], v[48:51], a[56:59]
    ds_read_b64_tr_b16 v[80:81], v226 offset:0
    v_mfma_f32_16x16x32_bf16 a[60:63], v[140:143], v[52:55], a[60:63]
    ds_read_b64_tr_b16 v[82:83], v226 offset:1024
    v_mfma_f32_16x16x32_bf16 a[64:67], v[144:147], v[48:51], a[64:67]
    ds_read_b64_tr_b16 v[84:85], v220 offset:16384
    v_mfma_f32_16x16x32_bf16 a[68:71], v[144:147], v[52:55], a[68:71]
    ds_read_b64_tr_b16 v[86:87], v220 offset:17408
    v_mfma_f32_16x16x32_bf16 a[72:75], v[148:151], v[48:51], a[72:75]
    ds_read_b64_tr_b16 v[88:89], v221 offset:16384
    v_mfma_f32_16x16x32_bf16 a[76:79], v[148:151], v[52:55], a[76:79]
    ds_read_b64_tr_b16 v[90:91], v221 offset:17408
    v_mfma_f32_16x16x32_bf16 a[80:83], v[152:155], v[48:51], a[80:83]
    ds_read_b64_tr_b16 v[92:93], v222 offset:16384
    v_mfma_f32_16x16x32_bf16 a[84:87], v[152:155], v[52:55], a[84:87]
    ds_read_b64_tr_b16 v[94:95], v222 offset:17408
    v_mfma_f32_16x16x32_bf16 a[88:91], v[156:159], v[48:51], a[88:91]
    ds_read_b64_tr_b16 v[96:97], v223 offset:16384
    v_mfma_f32_16x16x32_bf16 a[92:95], v[156:159], v[52:55], a[92:95]
    ds_read_b64_tr_b16 v[98:99], v223 offset:17408
    v_mfma_f32_16x16x32_bf16 a[96:99], v[160:163], v[48:51], a[96:99]
    ds_read_b64_tr_b16 v[100:101], v224 offset:16384
    v_mfma_f32_16x16x32_bf16 a[100:103], v[160:163], v[52:55], a[100:103]
    ds_read_b64_tr_b16 v[102:103], v224 offset:17408
    v_mfma_f32_16x16x32_bf16 a[104:107], v[164:167], v[48:51], a[104:107]
    ds_read_b64_tr_b16 v[104:105], v225 offset:16384
    v_mfma_f32_16x16x32_bf16 a[108:111], v[164:167], v[52:55], a[108:111]
    ds_read_b64_tr_b16 v[106:107], v225 offset:17408
    ds_read_b64_tr_b16 v[108:109], v226 offset:16384
    ds_read_b64_tr_b16 v[110:111], v226 offset:17408
    s_waitcnt lgkmcnt(0)
    v_mfma_f32_16x16x32_bf16 a[0:3], v[56:59], v[40:43], a[0:3]
    ds_read_b128 v[48:51], v219 offset:0
    v_mfma_f32_16x16x32_bf16 a[4:7], v[56:59], v[44:47], a[4:7]
    ds_read_b128 v[52:55], v219 offset:2048
    v_mfma_f32_16x16x32_bf16 a[8:11], v[60:63], v[40:43], a[8:11]
    ds_read_b64_tr_b16 v[112:113], v220 offset:8192
    v_mfma_f32_16x16x32_bf16 a[12:15], v[60:63], v[44:47], a[12:15]
    ds_read_b64_tr_b16 v[114:115], v220 offset:9216
    v_mfma_f32_16x16x32_bf16 a[16:19], v[64:67], v[40:43], a[16:19]
    ds_read_b64_tr_b16 v[116:117], v221 offset:8192
    v_mfma_f32_16x16x32_bf16 a[20:23], v[64:67], v[44:47], a[20:23]
    ds_read_b64_tr_b16 v[118:119], v221 offset:9216
    v_mfma_f32_16x16x32_bf16 a[24:27], v[68:71], v[40:43], a[24:27]
    ds_read_b64_tr_b16 v[120:121], v222 offset:8192
    v_mfma_f32_16x16x32_bf16 a[28:31], v[68:71], v[44:47], a[28:31]
    ds_read_b64_tr_b16 v[122:123], v222 offset:9216
    v_mfma_f32_16x16x32_bf16 a[32:35], v[72:75], v[40:43], a[32:35]
    ds_read_b64_tr_b16 v[124:125], v223 offset:8192
    v_mfma_f32_16x16x32_bf16 a[36:39], v[72:75], v[44:47], a[36:39]
    ds_read_b64_tr_b16 v[126:127], v223 offset:9216
    v_mfma_f32_16x16x32_bf16 a[40:43], v[76:79], v[40:43], a[40:43]
    ds_read_b64_tr_b16 v[128:129], v224 offset:8192
    v_mfma_f32_16x16x32_bf16 a[44:47], v[76:79], v[44:47], a[44:47]
    ds_read_b64_tr_b16 v[130:131], v224 offset:9216
    v_mfma_f32_16x16x32_bf16 a[48:51], v[80:83], v[40:43], a[48:51]
    ds_read_b64_tr_b16 v[132:133], v225 offset:8192
    v_mfma_f32_16x16x32_bf16 a[52:55], v[80:83], v[44:47], a[52:55]
    ds_read_b64_tr_b16 v[134:135], v225 offset:9216
    v_mfma_f32_16x16x32_bf16 a[56:59], v[84:87], v[40:43], a[56:59]
    ds_read_b64_tr_b16 v[136:137], v226 offset:8192
    v_mfma_f32_16x16x32_bf16 a[60:63], v[84:87], v[44:47], a[60:63]
    ds_read_b64_tr_b16 v[138:139], v226 offset:9216
    v_mfma_f32_16x16x32_bf16 a[64:67], v[88:91], v[40:43], a[64:67]
    ds_read_b64_tr_b16 v[140:141], v220 offset:24576
    v_mfma_f32_16x16x32_bf16 a[68:71], v[88:91], v[44:47], a[68:71]
    ds_read_b64_tr_b16 v[142:143], v220 offset:25600
    v_mfma_f32_16x16x32_bf16 a[72:75], v[92:95], v[40:43], a[72:75]
    ds_read_b64_tr_b16 v[144:145], v221 offset:24576
    v_mfma_f32_16x16x32_bf16 a[76:79], v[92:95], v[44:47], a[76:79]
    ds_read_b64_tr_b16 v[146:147], v221 offset:25600
    v_mfma_f32_16x16x32_bf16 a[80:83], v[96:99], v[40:43], a[80:83]
    ds_read_b64_tr_b16 v[148:149], v222 offset:24576
    v_mfma_f32_16x16x32_bf16 a[84:87], v[96:99], v[44:47], a[84:87]
    ds_read_b64_tr_b16 v[150:151], v222 offset:25600
    v_mfma_f32_16x16x32_bf16 a[88:91], v[100:103], v[40:43], a[88:91]
    ds_read_b64_tr_b16 v[152:153], v223 offset:24576
    v_mfma_f32_16x16x32_bf16 a[92:95], v[100:103], v[44:47], a[92:95]
    ds_read_b64_tr_b16 v[154:155], v223 offset:25600
    v_mfma_f32_16x16x32_bf16 a[96:99], v[104:107], v[40:43], a[96:99]
    ds_read_b64_tr_b16 v[156:157], v224 offset:24576
    v_mfma_f32_16x16x32_bf16 a[100:103], v[104:107], v[44:47], a[100:103]
    ds_read_b64_tr_b16 v[158:159], v224 offset:25600
    v_mfma_f32_16x16x32_bf16 a[104:107], v[108:111], v[40:43], a[104:107]
    ds_read_b64_tr_b16 v[160:161], v225 offset:24576
    v_mfma_f32_16x16x32_bf16 a[108:111], v[108:111], v[44:47], a[108:111]
    ds_read_b64_tr_b16 v[162:163], v225 offset:25600
    ds_read_b64_tr_b16 v[164:165], v226 offset:24576
    ds_read_b64_tr_b16 v[166:167], v226 offset:25600
    s_waitcnt lgkmcnt(0)
    s_waitcnt vmcnt(12)
    s_barrier
    s_add_u32 s34, s32, 49152
    s_mov_b32 m0, s34
    s_add_u32 s35, s30, 896
    buffer_load_dwordx4 v10, s[12:15], s35 offen lds
    s_add_u32 s34, s32, 50176
    s_mov_b32 m0, s34
    s_add_u32 s35, s30, 9088
    buffer_load_dwordx4 v11, s[12:15], s35 offen lds
    s_add_u32 s34, s32, 51200
    s_mov_b32 m0, s34
    s_add_u32 s35, s30, 17280
    buffer_load_dwordx4 v10, s[12:15], s35 offen lds
    s_add_u32 s34, s32, 52224
    s_mov_b32 m0, s34
    s_add_u32 s35, s30, 25472
    buffer_load_dwordx4 v11, s[12:15], s35 offen lds
    s_add_u32 s34, s33, 65536
    s_mov_b32 m0, s34
    s_add_u32 s35, s31, 1605632
    buffer_load_dwordx4 v12, s[16:19], s35 offen lds
    s_add_u32 s34, s33, 66560
    s_mov_b32 m0, s34
    s_add_u32 s35, s31, 1619968
    buffer_load_dwordx4 v12, s[16:19], s35 offen lds
    s_add_u32 s34, s33, 67584
    s_mov_b32 m0, s34
    s_add_u32 s35, s31, 1634304
    buffer_load_dwordx4 v13, s[16:19], s35 offen lds
    s_add_u32 s34, s33, 68608
    s_mov_b32 m0, s34
    s_add_u32 s35, s31, 1648640
    buffer_load_dwordx4 v13, s[16:19], s35 offen lds
    s_add_u32 s34, s33, 81920
    s_mov_b32 m0, s34
    s_add_u32 s35, s31, 1605632
    buffer_load_dwordx4 v12, s[44:47], s35 offen lds
    s_add_u32 s34, s33, 82944
    s_mov_b32 m0, s34
    s_add_u32 s35, s31, 1619968
    buffer_load_dwordx4 v12, s[44:47], s35 offen lds
    s_add_u32 s34, s33, 83968
    s_mov_b32 m0, s34
    s_add_u32 s35, s31, 1634304
    buffer_load_dwordx4 v13, s[44:47], s35 offen lds
    s_add_u32 s34, s33, 84992
    s_mov_b32 m0, s34
    s_add_u32 s35, s31, 1648640
    buffer_load_dwordx4 v13, s[44:47], s35 offen lds
    v_mfma_f32_16x16x32_bf16 a[0:3], v[112:115], v[48:51], a[0:3]
    ds_read_b128 v[40:43], v30 offset:0
    v_mfma_f32_16x16x32_bf16 a[4:7], v[112:115], v[52:55], a[4:7]
    ds_read_b128 v[44:47], v30 offset:2048
    v_mfma_f32_16x16x32_bf16 a[8:11], v[116:119], v[48:51], a[8:11]
    ds_read_b64_tr_b16 v[56:57], v32 offset:0
    v_mfma_f32_16x16x32_bf16 a[12:15], v[116:119], v[52:55], a[12:15]
    ds_read_b64_tr_b16 v[58:59], v32 offset:1024
    v_mfma_f32_16x16x32_bf16 a[16:19], v[120:123], v[48:51], a[16:19]
    ds_read_b64_tr_b16 v[60:61], v33 offset:0
    v_mfma_f32_16x16x32_bf16 a[20:23], v[120:123], v[52:55], a[20:23]
    ds_read_b64_tr_b16 v[62:63], v33 offset:1024
    v_mfma_f32_16x16x32_bf16 a[24:27], v[124:127], v[48:51], a[24:27]
    ds_read_b64_tr_b16 v[64:65], v34 offset:0
    v_mfma_f32_16x16x32_bf16 a[28:31], v[124:127], v[52:55], a[28:31]
    ds_read_b64_tr_b16 v[66:67], v34 offset:1024
    v_mfma_f32_16x16x32_bf16 a[32:35], v[128:131], v[48:51], a[32:35]
    ds_read_b64_tr_b16 v[68:69], v35 offset:0
    v_mfma_f32_16x16x32_bf16 a[36:39], v[128:131], v[52:55], a[36:39]
    ds_read_b64_tr_b16 v[70:71], v35 offset:1024
    v_mfma_f32_16x16x32_bf16 a[40:43], v[132:135], v[48:51], a[40:43]
    ds_read_b64_tr_b16 v[72:73], v36 offset:0
    v_mfma_f32_16x16x32_bf16 a[44:47], v[132:135], v[52:55], a[44:47]
    ds_read_b64_tr_b16 v[74:75], v36 offset:1024
    v_mfma_f32_16x16x32_bf16 a[48:51], v[136:139], v[48:51], a[48:51]
    ds_read_b64_tr_b16 v[76:77], v37 offset:0
    v_mfma_f32_16x16x32_bf16 a[52:55], v[136:139], v[52:55], a[52:55]
    ds_read_b64_tr_b16 v[78:79], v37 offset:1024
    v_mfma_f32_16x16x32_bf16 a[56:59], v[140:143], v[48:51], a[56:59]
    ds_read_b64_tr_b16 v[80:81], v38 offset:0
    v_mfma_f32_16x16x32_bf16 a[60:63], v[140:143], v[52:55], a[60:63]
    ds_read_b64_tr_b16 v[82:83], v38 offset:1024
    v_mfma_f32_16x16x32_bf16 a[64:67], v[144:147], v[48:51], a[64:67]
    ds_read_b64_tr_b16 v[84:85], v32 offset:16384
    v_mfma_f32_16x16x32_bf16 a[68:71], v[144:147], v[52:55], a[68:71]
    ds_read_b64_tr_b16 v[86:87], v32 offset:17408
    v_mfma_f32_16x16x32_bf16 a[72:75], v[148:151], v[48:51], a[72:75]
    ds_read_b64_tr_b16 v[88:89], v33 offset:16384
    v_mfma_f32_16x16x32_bf16 a[76:79], v[148:151], v[52:55], a[76:79]
    ds_read_b64_tr_b16 v[90:91], v33 offset:17408
    v_mfma_f32_16x16x32_bf16 a[80:83], v[152:155], v[48:51], a[80:83]
    ds_read_b64_tr_b16 v[92:93], v34 offset:16384
    v_mfma_f32_16x16x32_bf16 a[84:87], v[152:155], v[52:55], a[84:87]
    ds_read_b64_tr_b16 v[94:95], v34 offset:17408
    v_mfma_f32_16x16x32_bf16 a[88:91], v[156:159], v[48:51], a[88:91]
    ds_read_b64_tr_b16 v[96:97], v35 offset:16384
    v_mfma_f32_16x16x32_bf16 a[92:95], v[156:159], v[52:55], a[92:95]
    ds_read_b64_tr_b16 v[98:99], v35 offset:17408
    v_mfma_f32_16x16x32_bf16 a[96:99], v[160:163], v[48:51], a[96:99]
    ds_read_b64_tr_b16 v[100:101], v36 offset:16384
    v_mfma_f32_16x16x32_bf16 a[100:103], v[160:163], v[52:55], a[100:103]
    ds_read_b64_tr_b16 v[102:103], v36 offset:17408
    v_mfma_f32_16x16x32_bf16 a[104:107], v[164:167], v[48:51], a[104:107]
    ds_read_b64_tr_b16 v[104:105], v37 offset:16384
    v_mfma_f32_16x16x32_bf16 a[108:111], v[164:167], v[52:55], a[108:111]
    ds_read_b64_tr_b16 v[106:107], v37 offset:17408
    ds_read_b64_tr_b16 v[108:109], v38 offset:16384
    ds_read_b64_tr_b16 v[110:111], v38 offset:17408
    s_waitcnt lgkmcnt(0)
    v_mfma_f32_16x16x32_bf16 a[0:3], v[56:59], v[40:43], a[0:3]
    ds_read_b128 v[48:51], v31 offset:0
    v_mfma_f32_16x16x32_bf16 a[4:7], v[56:59], v[44:47], a[4:7]
    ds_read_b128 v[52:55], v31 offset:2048
    v_mfma_f32_16x16x32_bf16 a[8:11], v[60:63], v[40:43], a[8:11]
    ds_read_b64_tr_b16 v[112:113], v32 offset:8192
    v_mfma_f32_16x16x32_bf16 a[12:15], v[60:63], v[44:47], a[12:15]
    ds_read_b64_tr_b16 v[114:115], v32 offset:9216
    v_mfma_f32_16x16x32_bf16 a[16:19], v[64:67], v[40:43], a[16:19]
    ds_read_b64_tr_b16 v[116:117], v33 offset:8192
    v_mfma_f32_16x16x32_bf16 a[20:23], v[64:67], v[44:47], a[20:23]
    ds_read_b64_tr_b16 v[118:119], v33 offset:9216
    v_mfma_f32_16x16x32_bf16 a[24:27], v[68:71], v[40:43], a[24:27]
    ds_read_b64_tr_b16 v[120:121], v34 offset:8192
    v_mfma_f32_16x16x32_bf16 a[28:31], v[68:71], v[44:47], a[28:31]
    ds_read_b64_tr_b16 v[122:123], v34 offset:9216
    v_mfma_f32_16x16x32_bf16 a[32:35], v[72:75], v[40:43], a[32:35]
    ds_read_b64_tr_b16 v[124:125], v35 offset:8192
    v_mfma_f32_16x16x32_bf16 a[36:39], v[72:75], v[44:47], a[36:39]
    ds_read_b64_tr_b16 v[126:127], v35 offset:9216
    v_mfma_f32_16x16x32_bf16 a[40:43], v[76:79], v[40:43], a[40:43]
    ds_read_b64_tr_b16 v[128:129], v36 offset:8192
    v_mfma_f32_16x16x32_bf16 a[44:47], v[76:79], v[44:47], a[44:47]
    ds_read_b64_tr_b16 v[130:131], v36 offset:9216
    v_mfma_f32_16x16x32_bf16 a[48:51], v[80:83], v[40:43], a[48:51]
    ds_read_b64_tr_b16 v[132:133], v37 offset:8192
    v_mfma_f32_16x16x32_bf16 a[52:55], v[80:83], v[44:47], a[52:55]
    ds_read_b64_tr_b16 v[134:135], v37 offset:9216
    v_mfma_f32_16x16x32_bf16 a[56:59], v[84:87], v[40:43], a[56:59]
    ds_read_b64_tr_b16 v[136:137], v38 offset:8192
    v_mfma_f32_16x16x32_bf16 a[60:63], v[84:87], v[44:47], a[60:63]
    ds_read_b64_tr_b16 v[138:139], v38 offset:9216
    v_mfma_f32_16x16x32_bf16 a[64:67], v[88:91], v[40:43], a[64:67]
    ds_read_b64_tr_b16 v[140:141], v32 offset:24576
    v_mfma_f32_16x16x32_bf16 a[68:71], v[88:91], v[44:47], a[68:71]
    ds_read_b64_tr_b16 v[142:143], v32 offset:25600
    v_mfma_f32_16x16x32_bf16 a[72:75], v[92:95], v[40:43], a[72:75]
    ds_read_b64_tr_b16 v[144:145], v33 offset:24576
    v_mfma_f32_16x16x32_bf16 a[76:79], v[92:95], v[44:47], a[76:79]
    ds_read_b64_tr_b16 v[146:147], v33 offset:25600
    v_mfma_f32_16x16x32_bf16 a[80:83], v[96:99], v[40:43], a[80:83]
    ds_read_b64_tr_b16 v[148:149], v34 offset:24576
    v_mfma_f32_16x16x32_bf16 a[84:87], v[96:99], v[44:47], a[84:87]
    ds_read_b64_tr_b16 v[150:151], v34 offset:25600
    v_mfma_f32_16x16x32_bf16 a[88:91], v[100:103], v[40:43], a[88:91]
    ds_read_b64_tr_b16 v[152:153], v35 offset:24576
    v_mfma_f32_16x16x32_bf16 a[92:95], v[100:103], v[44:47], a[92:95]
    ds_read_b64_tr_b16 v[154:155], v35 offset:25600
    v_mfma_f32_16x16x32_bf16 a[96:99], v[104:107], v[40:43], a[96:99]
    ds_read_b64_tr_b16 v[156:157], v36 offset:24576
    v_mfma_f32_16x16x32_bf16 a[100:103], v[104:107], v[44:47], a[100:103]
    ds_read_b64_tr_b16 v[158:159], v36 offset:25600
    v_mfma_f32_16x16x32_bf16 a[104:107], v[108:111], v[40:43], a[104:107]
    ds_read_b64_tr_b16 v[160:161], v37 offset:24576
    v_mfma_f32_16x16x32_bf16 a[108:111], v[108:111], v[44:47], a[108:111]
    ds_read_b64_tr_b16 v[162:163], v37 offset:25600
    ds_read_b64_tr_b16 v[164:165], v38 offset:24576
    ds_read_b64_tr_b16 v[166:167], v38 offset:25600
    s_waitcnt lgkmcnt(0)
    s_waitcnt vmcnt(12)
    s_barrier
    v_mfma_f32_16x16x32_bf16 a[0:3], v[112:115], v[48:51], a[0:3]
    ds_read_b128 v[40:43], v20 offset:0
    v_mfma_f32_16x16x32_bf16 a[4:7], v[112:115], v[52:55], a[4:7]
    ds_read_b128 v[44:47], v20 offset:2048
    v_mfma_f32_16x16x32_bf16 a[8:11], v[116:119], v[48:51], a[8:11]
    ds_read_b64_tr_b16 v[56:57], v22 offset:0
    v_mfma_f32_16x16x32_bf16 a[12:15], v[116:119], v[52:55], a[12:15]
    ds_read_b64_tr_b16 v[58:59], v22 offset:1024
    v_mfma_f32_16x16x32_bf16 a[16:19], v[120:123], v[48:51], a[16:19]
    ds_read_b64_tr_b16 v[60:61], v23 offset:0
    v_mfma_f32_16x16x32_bf16 a[20:23], v[120:123], v[52:55], a[20:23]
    ds_read_b64_tr_b16 v[62:63], v23 offset:1024
    v_mfma_f32_16x16x32_bf16 a[24:27], v[124:127], v[48:51], a[24:27]
    ds_read_b64_tr_b16 v[64:65], v24 offset:0
    v_mfma_f32_16x16x32_bf16 a[28:31], v[124:127], v[52:55], a[28:31]
    ds_read_b64_tr_b16 v[66:67], v24 offset:1024
    v_mfma_f32_16x16x32_bf16 a[32:35], v[128:131], v[48:51], a[32:35]
    ds_read_b64_tr_b16 v[68:69], v25 offset:0
    v_mfma_f32_16x16x32_bf16 a[36:39], v[128:131], v[52:55], a[36:39]
    ds_read_b64_tr_b16 v[70:71], v25 offset:1024
    v_mfma_f32_16x16x32_bf16 a[40:43], v[132:135], v[48:51], a[40:43]
    ds_read_b64_tr_b16 v[72:73], v26 offset:0
    v_mfma_f32_16x16x32_bf16 a[44:47], v[132:135], v[52:55], a[44:47]
    ds_read_b64_tr_b16 v[74:75], v26 offset:1024
    v_mfma_f32_16x16x32_bf16 a[48:51], v[136:139], v[48:51], a[48:51]
    ds_read_b64_tr_b16 v[76:77], v27 offset:0
    v_mfma_f32_16x16x32_bf16 a[52:55], v[136:139], v[52:55], a[52:55]
    ds_read_b64_tr_b16 v[78:79], v27 offset:1024
    v_mfma_f32_16x16x32_bf16 a[56:59], v[140:143], v[48:51], a[56:59]
    ds_read_b64_tr_b16 v[80:81], v28 offset:0
    v_mfma_f32_16x16x32_bf16 a[60:63], v[140:143], v[52:55], a[60:63]
    ds_read_b64_tr_b16 v[82:83], v28 offset:1024
    v_mfma_f32_16x16x32_bf16 a[64:67], v[144:147], v[48:51], a[64:67]
    ds_read_b64_tr_b16 v[84:85], v22 offset:16384
    v_mfma_f32_16x16x32_bf16 a[68:71], v[144:147], v[52:55], a[68:71]
    ds_read_b64_tr_b16 v[86:87], v22 offset:17408
    v_mfma_f32_16x16x32_bf16 a[72:75], v[148:151], v[48:51], a[72:75]
    ds_read_b64_tr_b16 v[88:89], v23 offset:16384
    v_mfma_f32_16x16x32_bf16 a[76:79], v[148:151], v[52:55], a[76:79]
    ds_read_b64_tr_b16 v[90:91], v23 offset:17408
    v_mfma_f32_16x16x32_bf16 a[80:83], v[152:155], v[48:51], a[80:83]
    ds_read_b64_tr_b16 v[92:93], v24 offset:16384
    v_mfma_f32_16x16x32_bf16 a[84:87], v[152:155], v[52:55], a[84:87]
    ds_read_b64_tr_b16 v[94:95], v24 offset:17408
    v_mfma_f32_16x16x32_bf16 a[88:91], v[156:159], v[48:51], a[88:91]
    ds_read_b64_tr_b16 v[96:97], v25 offset:16384
    v_mfma_f32_16x16x32_bf16 a[92:95], v[156:159], v[52:55], a[92:95]
    ds_read_b64_tr_b16 v[98:99], v25 offset:17408
    v_mfma_f32_16x16x32_bf16 a[96:99], v[160:163], v[48:51], a[96:99]
    ds_read_b64_tr_b16 v[100:101], v26 offset:16384
    v_mfma_f32_16x16x32_bf16 a[100:103], v[160:163], v[52:55], a[100:103]
    ds_read_b64_tr_b16 v[102:103], v26 offset:17408
    v_mfma_f32_16x16x32_bf16 a[104:107], v[164:167], v[48:51], a[104:107]
    ds_read_b64_tr_b16 v[104:105], v27 offset:16384
    v_mfma_f32_16x16x32_bf16 a[108:111], v[164:167], v[52:55], a[108:111]
    ds_read_b64_tr_b16 v[106:107], v27 offset:17408
    ds_read_b64_tr_b16 v[108:109], v28 offset:16384
    ds_read_b64_tr_b16 v[110:111], v28 offset:17408
    s_waitcnt lgkmcnt(0)
    v_mfma_f32_16x16x32_bf16 a[0:3], v[56:59], v[40:43], a[0:3]
    ds_read_b128 v[48:51], v21 offset:0
    v_mfma_f32_16x16x32_bf16 a[4:7], v[56:59], v[44:47], a[4:7]
    ds_read_b128 v[52:55], v21 offset:2048
    v_mfma_f32_16x16x32_bf16 a[8:11], v[60:63], v[40:43], a[8:11]
    ds_read_b64_tr_b16 v[112:113], v22 offset:8192
    v_mfma_f32_16x16x32_bf16 a[12:15], v[60:63], v[44:47], a[12:15]
    ds_read_b64_tr_b16 v[114:115], v22 offset:9216
    v_mfma_f32_16x16x32_bf16 a[16:19], v[64:67], v[40:43], a[16:19]
    ds_read_b64_tr_b16 v[116:117], v23 offset:8192
    v_mfma_f32_16x16x32_bf16 a[20:23], v[64:67], v[44:47], a[20:23]
    ds_read_b64_tr_b16 v[118:119], v23 offset:9216
    v_mfma_f32_16x16x32_bf16 a[24:27], v[68:71], v[40:43], a[24:27]
    ds_read_b64_tr_b16 v[120:121], v24 offset:8192
    v_mfma_f32_16x16x32_bf16 a[28:31], v[68:71], v[44:47], a[28:31]
    ds_read_b64_tr_b16 v[122:123], v24 offset:9216
    v_mfma_f32_16x16x32_bf16 a[32:35], v[72:75], v[40:43], a[32:35]
    ds_read_b64_tr_b16 v[124:125], v25 offset:8192
    v_mfma_f32_16x16x32_bf16 a[36:39], v[72:75], v[44:47], a[36:39]
    ds_read_b64_tr_b16 v[126:127], v25 offset:9216
    v_mfma_f32_16x16x32_bf16 a[40:43], v[76:79], v[40:43], a[40:43]
    ds_read_b64_tr_b16 v[128:129], v26 offset:8192
    v_mfma_f32_16x16x32_bf16 a[44:47], v[76:79], v[44:47], a[44:47]
    ds_read_b64_tr_b16 v[130:131], v26 offset:9216
    v_mfma_f32_16x16x32_bf16 a[48:51], v[80:83], v[40:43], a[48:51]
    ds_read_b64_tr_b16 v[132:133], v27 offset:8192
    v_mfma_f32_16x16x32_bf16 a[52:55], v[80:83], v[44:47], a[52:55]
    ds_read_b64_tr_b16 v[134:135], v27 offset:9216
    v_mfma_f32_16x16x32_bf16 a[56:59], v[84:87], v[40:43], a[56:59]
    ds_read_b64_tr_b16 v[136:137], v28 offset:8192
    v_mfma_f32_16x16x32_bf16 a[60:63], v[84:87], v[44:47], a[60:63]
    ds_read_b64_tr_b16 v[138:139], v28 offset:9216
    v_mfma_f32_16x16x32_bf16 a[64:67], v[88:91], v[40:43], a[64:67]
    ds_read_b64_tr_b16 v[140:141], v22 offset:24576
    v_mfma_f32_16x16x32_bf16 a[68:71], v[88:91], v[44:47], a[68:71]
    ds_read_b64_tr_b16 v[142:143], v22 offset:25600
    v_mfma_f32_16x16x32_bf16 a[72:75], v[92:95], v[40:43], a[72:75]
    ds_read_b64_tr_b16 v[144:145], v23 offset:24576
    v_mfma_f32_16x16x32_bf16 a[76:79], v[92:95], v[44:47], a[76:79]
    ds_read_b64_tr_b16 v[146:147], v23 offset:25600
    v_mfma_f32_16x16x32_bf16 a[80:83], v[96:99], v[40:43], a[80:83]
    ds_read_b64_tr_b16 v[148:149], v24 offset:24576
    v_mfma_f32_16x16x32_bf16 a[84:87], v[96:99], v[44:47], a[84:87]
    ds_read_b64_tr_b16 v[150:151], v24 offset:25600
    v_mfma_f32_16x16x32_bf16 a[88:91], v[100:103], v[40:43], a[88:91]
    ds_read_b64_tr_b16 v[152:153], v25 offset:24576
    v_mfma_f32_16x16x32_bf16 a[92:95], v[100:103], v[44:47], a[92:95]
    ds_read_b64_tr_b16 v[154:155], v25 offset:25600
    v_mfma_f32_16x16x32_bf16 a[96:99], v[104:107], v[40:43], a[96:99]
    ds_read_b64_tr_b16 v[156:157], v26 offset:24576
    v_mfma_f32_16x16x32_bf16 a[100:103], v[104:107], v[44:47], a[100:103]
    ds_read_b64_tr_b16 v[158:159], v26 offset:25600
    v_mfma_f32_16x16x32_bf16 a[104:107], v[108:111], v[40:43], a[104:107]
    ds_read_b64_tr_b16 v[160:161], v27 offset:24576
    v_mfma_f32_16x16x32_bf16 a[108:111], v[108:111], v[44:47], a[108:111]
    ds_read_b64_tr_b16 v[162:163], v27 offset:25600
    ds_read_b64_tr_b16 v[164:165], v28 offset:24576
    ds_read_b64_tr_b16 v[166:167], v28 offset:25600
    s_waitcnt lgkmcnt(0)
    s_waitcnt vmcnt(0)
    s_barrier
    v_mfma_f32_16x16x32_bf16 a[0:3], v[112:115], v[48:51], a[0:3]
    ds_read_b128 v[40:43], v218 offset:0
    v_mfma_f32_16x16x32_bf16 a[4:7], v[112:115], v[52:55], a[4:7]
    ds_read_b128 v[44:47], v218 offset:2048
    v_mfma_f32_16x16x32_bf16 a[8:11], v[116:119], v[48:51], a[8:11]
    ds_read_b64_tr_b16 v[56:57], v220 offset:0
    v_mfma_f32_16x16x32_bf16 a[12:15], v[116:119], v[52:55], a[12:15]
    ds_read_b64_tr_b16 v[58:59], v220 offset:1024
    v_mfma_f32_16x16x32_bf16 a[16:19], v[120:123], v[48:51], a[16:19]
    ds_read_b64_tr_b16 v[60:61], v221 offset:0
    v_mfma_f32_16x16x32_bf16 a[20:23], v[120:123], v[52:55], a[20:23]
    ds_read_b64_tr_b16 v[62:63], v221 offset:1024
    v_mfma_f32_16x16x32_bf16 a[24:27], v[124:127], v[48:51], a[24:27]
    ds_read_b64_tr_b16 v[64:65], v222 offset:0
    v_mfma_f32_16x16x32_bf16 a[28:31], v[124:127], v[52:55], a[28:31]
    ds_read_b64_tr_b16 v[66:67], v222 offset:1024
    v_mfma_f32_16x16x32_bf16 a[32:35], v[128:131], v[48:51], a[32:35]
    ds_read_b64_tr_b16 v[68:69], v223 offset:0
    v_mfma_f32_16x16x32_bf16 a[36:39], v[128:131], v[52:55], a[36:39]
    ds_read_b64_tr_b16 v[70:71], v223 offset:1024
    v_mfma_f32_16x16x32_bf16 a[40:43], v[132:135], v[48:51], a[40:43]
    ds_read_b64_tr_b16 v[72:73], v224 offset:0
    v_mfma_f32_16x16x32_bf16 a[44:47], v[132:135], v[52:55], a[44:47]
    ds_read_b64_tr_b16 v[74:75], v224 offset:1024
    v_mfma_f32_16x16x32_bf16 a[48:51], v[136:139], v[48:51], a[48:51]
    ds_read_b64_tr_b16 v[76:77], v225 offset:0
    v_mfma_f32_16x16x32_bf16 a[52:55], v[136:139], v[52:55], a[52:55]
    ds_read_b64_tr_b16 v[78:79], v225 offset:1024
    v_mfma_f32_16x16x32_bf16 a[56:59], v[140:143], v[48:51], a[56:59]
    ds_read_b64_tr_b16 v[80:81], v226 offset:0
    v_mfma_f32_16x16x32_bf16 a[60:63], v[140:143], v[52:55], a[60:63]
    ds_read_b64_tr_b16 v[82:83], v226 offset:1024
    v_mfma_f32_16x16x32_bf16 a[64:67], v[144:147], v[48:51], a[64:67]
    ds_read_b64_tr_b16 v[84:85], v220 offset:16384
    v_mfma_f32_16x16x32_bf16 a[68:71], v[144:147], v[52:55], a[68:71]
    ds_read_b64_tr_b16 v[86:87], v220 offset:17408
    v_mfma_f32_16x16x32_bf16 a[72:75], v[148:151], v[48:51], a[72:75]
    ds_read_b64_tr_b16 v[88:89], v221 offset:16384
    v_mfma_f32_16x16x32_bf16 a[76:79], v[148:151], v[52:55], a[76:79]
    ds_read_b64_tr_b16 v[90:91], v221 offset:17408
    v_mfma_f32_16x16x32_bf16 a[80:83], v[152:155], v[48:51], a[80:83]
    ds_read_b64_tr_b16 v[92:93], v222 offset:16384
    v_mfma_f32_16x16x32_bf16 a[84:87], v[152:155], v[52:55], a[84:87]
    ds_read_b64_tr_b16 v[94:95], v222 offset:17408
    v_mfma_f32_16x16x32_bf16 a[88:91], v[156:159], v[48:51], a[88:91]
    ds_read_b64_tr_b16 v[96:97], v223 offset:16384
    v_mfma_f32_16x16x32_bf16 a[92:95], v[156:159], v[52:55], a[92:95]
    ds_read_b64_tr_b16 v[98:99], v223 offset:17408
    v_mfma_f32_16x16x32_bf16 a[96:99], v[160:163], v[48:51], a[96:99]
    ds_read_b64_tr_b16 v[100:101], v224 offset:16384
    v_mfma_f32_16x16x32_bf16 a[100:103], v[160:163], v[52:55], a[100:103]
    ds_read_b64_tr_b16 v[102:103], v224 offset:17408
    v_mfma_f32_16x16x32_bf16 a[104:107], v[164:167], v[48:51], a[104:107]
    ds_read_b64_tr_b16 v[104:105], v225 offset:16384
    v_mfma_f32_16x16x32_bf16 a[108:111], v[164:167], v[52:55], a[108:111]
    ds_read_b64_tr_b16 v[106:107], v225 offset:17408
    ds_read_b64_tr_b16 v[108:109], v226 offset:16384
    ds_read_b64_tr_b16 v[110:111], v226 offset:17408
    s_waitcnt lgkmcnt(0)
    v_mfma_f32_16x16x32_bf16 a[0:3], v[56:59], v[40:43], a[0:3]
    ds_read_b128 v[48:51], v219 offset:0
    v_mfma_f32_16x16x32_bf16 a[4:7], v[56:59], v[44:47], a[4:7]
    ds_read_b128 v[52:55], v219 offset:2048
    v_mfma_f32_16x16x32_bf16 a[8:11], v[60:63], v[40:43], a[8:11]
    ds_read_b64_tr_b16 v[112:113], v220 offset:8192
    v_mfma_f32_16x16x32_bf16 a[12:15], v[60:63], v[44:47], a[12:15]
    ds_read_b64_tr_b16 v[114:115], v220 offset:9216
    v_mfma_f32_16x16x32_bf16 a[16:19], v[64:67], v[40:43], a[16:19]
    ds_read_b64_tr_b16 v[116:117], v221 offset:8192
    v_mfma_f32_16x16x32_bf16 a[20:23], v[64:67], v[44:47], a[20:23]
    ds_read_b64_tr_b16 v[118:119], v221 offset:9216
    v_mfma_f32_16x16x32_bf16 a[24:27], v[68:71], v[40:43], a[24:27]
    ds_read_b64_tr_b16 v[120:121], v222 offset:8192
    v_mfma_f32_16x16x32_bf16 a[28:31], v[68:71], v[44:47], a[28:31]
    ds_read_b64_tr_b16 v[122:123], v222 offset:9216
    v_mfma_f32_16x16x32_bf16 a[32:35], v[72:75], v[40:43], a[32:35]
    ds_read_b64_tr_b16 v[124:125], v223 offset:8192
    v_mfma_f32_16x16x32_bf16 a[36:39], v[72:75], v[44:47], a[36:39]
    ds_read_b64_tr_b16 v[126:127], v223 offset:9216
    v_mfma_f32_16x16x32_bf16 a[40:43], v[76:79], v[40:43], a[40:43]
    ds_read_b64_tr_b16 v[128:129], v224 offset:8192
    v_mfma_f32_16x16x32_bf16 a[44:47], v[76:79], v[44:47], a[44:47]
    ds_read_b64_tr_b16 v[130:131], v224 offset:9216
    v_mfma_f32_16x16x32_bf16 a[48:51], v[80:83], v[40:43], a[48:51]
    ds_read_b64_tr_b16 v[132:133], v225 offset:8192
    v_mfma_f32_16x16x32_bf16 a[52:55], v[80:83], v[44:47], a[52:55]
    ds_read_b64_tr_b16 v[134:135], v225 offset:9216
    v_mfma_f32_16x16x32_bf16 a[56:59], v[84:87], v[40:43], a[56:59]
    ds_read_b64_tr_b16 v[136:137], v226 offset:8192
    v_mfma_f32_16x16x32_bf16 a[60:63], v[84:87], v[44:47], a[60:63]
    ds_read_b64_tr_b16 v[138:139], v226 offset:9216
    v_mfma_f32_16x16x32_bf16 a[64:67], v[88:91], v[40:43], a[64:67]
    ds_read_b64_tr_b16 v[140:141], v220 offset:24576
    v_mfma_f32_16x16x32_bf16 a[68:71], v[88:91], v[44:47], a[68:71]
    ds_read_b64_tr_b16 v[142:143], v220 offset:25600
    v_mfma_f32_16x16x32_bf16 a[72:75], v[92:95], v[40:43], a[72:75]
    ds_read_b64_tr_b16 v[144:145], v221 offset:24576
    v_mfma_f32_16x16x32_bf16 a[76:79], v[92:95], v[44:47], a[76:79]
    ds_read_b64_tr_b16 v[146:147], v221 offset:25600
    v_mfma_f32_16x16x32_bf16 a[80:83], v[96:99], v[40:43], a[80:83]
    ds_read_b64_tr_b16 v[148:149], v222 offset:24576
    v_mfma_f32_16x16x32_bf16 a[84:87], v[96:99], v[44:47], a[84:87]
    ds_read_b64_tr_b16 v[150:151], v222 offset:25600
    v_mfma_f32_16x16x32_bf16 a[88:91], v[100:103], v[40:43], a[88:91]
    ds_read_b64_tr_b16 v[152:153], v223 offset:24576
    v_mfma_f32_16x16x32_bf16 a[92:95], v[100:103], v[44:47], a[92:95]
    ds_read_b64_tr_b16 v[154:155], v223 offset:25600
    v_mfma_f32_16x16x32_bf16 a[96:99], v[104:107], v[40:43], a[96:99]
    ds_read_b64_tr_b16 v[156:157], v224 offset:24576
    v_mfma_f32_16x16x32_bf16 a[100:103], v[104:107], v[44:47], a[100:103]
    ds_read_b64_tr_b16 v[158:159], v224 offset:25600
    v_mfma_f32_16x16x32_bf16 a[104:107], v[108:111], v[40:43], a[104:107]
    ds_read_b64_tr_b16 v[160:161], v225 offset:24576
    v_mfma_f32_16x16x32_bf16 a[108:111], v[108:111], v[44:47], a[108:111]
    ds_read_b64_tr_b16 v[162:163], v225 offset:25600
    ds_read_b64_tr_b16 v[164:165], v226 offset:24576
    ds_read_b64_tr_b16 v[166:167], v226 offset:25600
    s_waitcnt lgkmcnt(0)
    v_mfma_f32_16x16x32_bf16 a[0:3], v[112:115], v[48:51], a[0:3]
    v_mfma_f32_16x16x32_bf16 a[4:7], v[112:115], v[52:55], a[4:7]
    v_mfma_f32_16x16x32_bf16 a[8:11], v[116:119], v[48:51], a[8:11]
    v_mfma_f32_16x16x32_bf16 a[12:15], v[116:119], v[52:55], a[12:15]
    v_mfma_f32_16x16x32_bf16 a[16:19], v[120:123], v[48:51], a[16:19]
    v_mfma_f32_16x16x32_bf16 a[20:23], v[120:123], v[52:55], a[20:23]
    v_mfma_f32_16x16x32_bf16 a[24:27], v[124:127], v[48:51], a[24:27]
    v_mfma_f32_16x16x32_bf16 a[28:31], v[124:127], v[52:55], a[28:31]
    v_mfma_f32_16x16x32_bf16 a[32:35], v[128:131], v[48:51], a[32:35]
    v_mfma_f32_16x16x32_bf16 a[36:39], v[128:131], v[52:55], a[36:39]
    v_mfma_f32_16x16x32_bf16 a[40:43], v[132:135], v[48:51], a[40:43]
    v_mfma_f32_16x16x32_bf16 a[44:47], v[132:135], v[52:55], a[44:47]
    v_mfma_f32_16x16x32_bf16 a[48:51], v[136:139], v[48:51], a[48:51]
    v_mfma_f32_16x16x32_bf16 a[52:55], v[136:139], v[52:55], a[52:55]
    v_mfma_f32_16x16x32_bf16 a[56:59], v[140:143], v[48:51], a[56:59]
    v_mfma_f32_16x16x32_bf16 a[60:63], v[140:143], v[52:55], a[60:63]
    v_mfma_f32_16x16x32_bf16 a[64:67], v[144:147], v[48:51], a[64:67]
    v_mfma_f32_16x16x32_bf16 a[68:71], v[144:147], v[52:55], a[68:71]
    v_mfma_f32_16x16x32_bf16 a[72:75], v[148:151], v[48:51], a[72:75]
    v_mfma_f32_16x16x32_bf16 a[76:79], v[148:151], v[52:55], a[76:79]
    v_mfma_f32_16x16x32_bf16 a[80:83], v[152:155], v[48:51], a[80:83]
    v_mfma_f32_16x16x32_bf16 a[84:87], v[152:155], v[52:55], a[84:87]
    v_mfma_f32_16x16x32_bf16 a[88:91], v[156:159], v[48:51], a[88:91]
    v_mfma_f32_16x16x32_bf16 a[92:95], v[156:159], v[52:55], a[92:95]
    v_mfma_f32_16x16x32_bf16 a[96:99], v[160:163], v[48:51], a[96:99]
    v_mfma_f32_16x16x32_bf16 a[100:103], v[160:163], v[52:55], a[100:103]
    v_mfma_f32_16x16x32_bf16 a[104:107], v[164:167], v[48:51], a[104:107]
    v_mfma_f32_16x16x32_bf16 a[108:111], v[164:167], v[52:55], a[108:111]
    v_add_f32 v206, v170, v172
    v_add_f32 v207, v171, v173
    v_add_f32 v206, v206, v174
    v_add_f32 v207, v207, v175
    v_add_f32 v206, v206, v176
    v_add_f32 v207, v207, v177
    v_add_f32 v206, v206, v178
    v_add_f32 v207, v207, v179
    v_add_f32 v206, v206, v180
    v_add_f32 v207, v207, v181
    v_add_f32 v206, v206, v182
    v_add_f32 v207, v207, v183
    v_add_f32 v206, v206, v184
    v_add_f32 v207, v207, v185
    v_add_f32 v206, v206, v186
    v_add_f32 v207, v207, v187
    v_add_f32 v206, v206, v188
    v_add_f32 v207, v207, v189
    v_add_f32 v206, v206, v190
    v_add_f32 v207, v207, v191
    v_add_f32 v206, v206, v192
    v_add_f32 v207, v207, v193
    v_add_f32 v206, v206, v194
    v_add_f32 v207, v207, v195
    v_add_f32 v206, v206, v196
    v_add_f32 v207, v207, v197
    v_add_f32 v206, v206, v198
    v_add_f32 v207, v207, v199
    v_add_f32 v206, v206, v200
    v_add_f32 v207, v207, v201
    v_mov_b32 v172, v206
    v_mov_b32 v173, v207
    v_mul_f32 v172, 0x3b000000, v172
    v_mul_f32 v173, 0x3b000000, v173
    v_fma_f32 v173, -v172, v172, v173
    v_add_f32 v173, 0x3727c5ac, v173
    v_rsq_f32 v174, v173
    s_nop 0
    v_mul_f32 v175, v172, v174
    v_sub_f32 v175, 0, v175
    s_lshl_b32 s34, s26, 8
    v_and_b32 v9, 31, v1
    v_lshlrev_b32 v9, 3, v9
    v_add_u32 v9, s34, v9
    v_add_u32 v9, 149504, v9
    ds_write_b64 v9, v[174:175]
    v_lshlrev_b32 v9, 3, v6
    v_add_u32 v9, s34, v9
    v_add_u32 v9, 149504, v9
    s_waitcnt lgkmcnt(0)
    ds_read_b64 v[176:177], v9
    ds_read_b64 v[178:179], v9 offset:128
    v_lshlrev_b32 v9, 4, v5
    v_add_u32 v9, 147456, v9
    s_nop 7
    s_nop 7
    v_add_u32 v180, s27, v6
    v_mul_u32_u24 v180, 3584, v180
    v_lshl_add_u32 v180, v5, 3, v180
    v_add_u32 v181, 57344, v180
    s_mov_b32 s50, 0x3d372713
    s_mul_i32 s34, s25, 224
    s_add_u32 s34, s34, 7340032
    ds_read_b128 v[184:187], v9 offset:0
    ds_read_b128 v[188:191], v9 offset:448
    ds_read_b128 v[192:195], v9 offset:896
    ds_read_b128 v[196:199], v9 offset:1344
    s_waitcnt lgkmcnt(0)
    v_accvgpr_read_b32 v200, a0
    v_accvgpr_read_b32 v204, a56
    v_accvgpr_read_b32 v201, a1
    v_accvgpr_read_b32 v205, a57
    v_accvgpr_read_b32 v202, a2
    v_accvgpr_read_b32 v206, a58
    v_accvgpr_read_b32 v203, a3
    v_accvgpr_read_b32 v207, a59
    v_fma_f32 v208, v177, v184, v192
    v_fma_f32 v212, v177, v188, v196
    v_fma_f32 v209, v177, v185, v193
    v_fma_f32 v213, v177, v189, v197
    v_fma_f32 v210, v177, v186, v194
    v_fma_f32 v214, v177, v190, v198
    v_fma_f32 v211, v177, v187, v195
    v_fma_f32 v215, v177, v191, v199
    v_fmac_f32 v208, v200, v176
    v_fmac_f32 v212, v204, v176
    v_fmac_f32 v209, v201, v176
    v_fmac_f32 v213, v205, v176
    v_fmac_f32 v210, v202, v176
    v_fmac_f32 v214, v206, v176
    v_fmac_f32 v211, v203, v176
    v_fmac_f32 v215, v207, v176
    v_mul_f32 v200, v208, v208
    v_fma_f32 v200, v200, s50, 1.0
    v_mul_f32 v200, v200, v208
    v_mul_f32 v200, 0xc0135761, v200
    v_mul_f32 v201, v209, v209
    v_fma_f32 v201, v201, s50, 1.0
    v_mul_f32 v201, v201, v209
    v_mul_f32 v201, 0xc0135761, v201
    v_mul_f32 v202, v210, v210
    v_fma_f32 v202, v202, s50, 1.0
    v_mul_f32 v202, v202, v210
    v_mul_f32 v202, 0xc0135761, v202
    v_mul_f32 v203, v211, v211
    v_fma_f32 v203, v203, s50, 1.0
    v_mul_f32 v203, v203, v211
    v_mul_f32 v203, 0xc0135761, v203
    v_exp_f32 v200, v200
    v_exp_f32 v201, v201
    v_exp_f32 v202, v202
    v_exp_f32 v203, v203
    s_nop 0
    v_add_f32 v200, 1.0, v200
    v_add_f32 v201, 1.0, v201
    v_add_f32 v202, 1.0, v202
    v_add_f32 v203, 1.0, v203
    v_rcp_f32 v200, v200
    v_rcp_f32 v201, v201
    v_rcp_f32 v202, v202
    v_rcp_f32 v203, v203
    s_nop 0
    v_mul_f32 v208, v208, v200
    v_mul_f32 v208, v208, v212
    v_mul_f32 v209, v209, v201
    v_mul_f32 v209, v209, v213
    v_mul_f32 v210, v210, v202
    v_mul_f32 v210, v210, v214
    v_mul_f32 v211, v211, v203
    v_mul_f32 v211, v211, v215
    v_cvt_pk_bf16_f32 v216, v208, v209
    v_cvt_pk_bf16_f32 v217, v210, v211
    buffer_store_dwordx2 v[216:217], v180, s[20:23], s34 offen offset:0
    v_accvgpr_read_b32 v200, a4
    v_accvgpr_read_b32 v204, a60
    v_accvgpr_read_b32 v201, a5
    v_accvgpr_read_b32 v205, a61
    v_accvgpr_read_b32 v202, a6
    v_accvgpr_read_b32 v206, a62
    v_accvgpr_read_b32 v203, a7
    v_accvgpr_read_b32 v207, a63
    v_fma_f32 v208, v179, v184, v192
    v_fma_f32 v212, v179, v188, v196
    v_fma_f32 v209, v179, v185, v193
    v_fma_f32 v213, v179, v189, v197
    v_fma_f32 v210, v179, v186, v194
    v_fma_f32 v214, v179, v190, v198
    v_fma_f32 v211, v179, v187, v195
    v_fma_f32 v215, v179, v191, v199
    v_fmac_f32 v208, v200, v178
    v_fmac_f32 v212, v204, v178
    v_fmac_f32 v209, v201, v178
    v_fmac_f32 v213, v205, v178
    v_fmac_f32 v210, v202, v178
    v_fmac_f32 v214, v206, v178
    v_fmac_f32 v211, v203, v178
    v_fmac_f32 v215, v207, v178
    v_mul_f32 v200, v208, v208
    v_fma_f32 v200, v200, s50, 1.0
    v_mul_f32 v200, v200, v208
    v_mul_f32 v200, 0xc0135761, v200
    v_mul_f32 v201, v209, v209
    v_fma_f32 v201, v201, s50, 1.0
    v_mul_f32 v201, v201, v209
    v_mul_f32 v201, 0xc0135761, v201
    v_mul_f32 v202, v210, v210
    v_fma_f32 v202, v202, s50, 1.0
    v_mul_f32 v202, v202, v210
    v_mul_f32 v202, 0xc0135761, v202
    v_mul_f32 v203, v211, v211
    v_fma_f32 v203, v203, s50, 1.0
    v_mul_f32 v203, v203, v211
    v_mul_f32 v203, 0xc0135761, v203
    v_exp_f32 v200, v200
    v_exp_f32 v201, v201
    v_exp_f32 v202, v202
    v_exp_f32 v203, v203
    s_nop 0
    v_add_f32 v200, 1.0, v200
    v_add_f32 v201, 1.0, v201
    v_add_f32 v202, 1.0, v202
    v_add_f32 v203, 1.0, v203
    v_rcp_f32 v200, v200
    v_rcp_f32 v201, v201
    v_rcp_f32 v202, v202
    v_rcp_f32 v203, v203
    s_nop 0
    v_mul_f32 v208, v208, v200
    v_mul_f32 v208, v208, v212
    v_mul_f32 v209, v209, v201
    v_mul_f32 v209, v209, v213
    v_mul_f32 v210, v210, v202
    v_mul_f32 v210, v210, v214
    v_mul_f32 v211, v211, v203
    v_mul_f32 v211, v211, v215
    v_cvt_pk_bf16_f32 v216, v208, v209
    v_cvt_pk_bf16_f32 v217, v210, v211
    buffer_store_dwordx2 v[216:217], v181, s[20:23], s34 offen offset:0
    ds_read_b128 v[184:187], v9 offset:64
    ds_read_b128 v[188:191], v9 offset:512
    ds_read_b128 v[192:195], v9 offset:960
    ds_read_b128 v[196:199], v9 offset:1408
    s_waitcnt lgkmcnt(0)
    v_accvgpr_read_b32 v200, a8
    v_accvgpr_read_b32 v204, a64
    v_accvgpr_read_b32 v201, a9
    v_accvgpr_read_b32 v205, a65
    v_accvgpr_read_b32 v202, a10
    v_accvgpr_read_b32 v206, a66
    v_accvgpr_read_b32 v203, a11
    v_accvgpr_read_b32 v207, a67
    v_fma_f32 v208, v177, v184, v192
    v_fma_f32 v212, v177, v188, v196
    v_fma_f32 v209, v177, v185, v193
    v_fma_f32 v213, v177, v189, v197
    v_fma_f32 v210, v177, v186, v194
    v_fma_f32 v214, v177, v190, v198
    v_fma_f32 v211, v177, v187, v195
    v_fma_f32 v215, v177, v191, v199
    v_fmac_f32 v208, v200, v176
    v_fmac_f32 v212, v204, v176
    v_fmac_f32 v209, v201, v176
    v_fmac_f32 v213, v205, v176
    v_fmac_f32 v210, v202, v176
    v_fmac_f32 v214, v206, v176
    v_fmac_f32 v211, v203, v176
    v_fmac_f32 v215, v207, v176
    v_mul_f32 v200, v208, v208
    v_fma_f32 v200, v200, s50, 1.0
    v_mul_f32 v200, v200, v208
    v_mul_f32 v200, 0xc0135761, v200
    v_mul_f32 v201, v209, v209
    v_fma_f32 v201, v201, s50, 1.0
    v_mul_f32 v201, v201, v209
    v_mul_f32 v201, 0xc0135761, v201
    v_mul_f32 v202, v210, v210
    v_fma_f32 v202, v202, s50, 1.0
    v_mul_f32 v202, v202, v210
    v_mul_f32 v202, 0xc0135761, v202
    v_mul_f32 v203, v211, v211
    v_fma_f32 v203, v203, s50, 1.0
    v_mul_f32 v203, v203, v211
    v_mul_f32 v203, 0xc0135761, v203
    v_exp_f32 v200, v200
    v_exp_f32 v201, v201
    v_exp_f32 v202, v202
    v_exp_f32 v203, v203
    s_nop 0
    v_add_f32 v200, 1.0, v200
    v_add_f32 v201, 1.0, v201
    v_add_f32 v202, 1.0, v202
    v_add_f32 v203, 1.0, v203
    v_rcp_f32 v200, v200
    v_rcp_f32 v201, v201
    v_rcp_f32 v202, v202
    v_rcp_f32 v203, v203
    s_nop 0
    v_mul_f32 v208, v208, v200
    v_mul_f32 v208, v208, v212
    v_mul_f32 v209, v209, v201
    v_mul_f32 v209, v209, v213
    v_mul_f32 v210, v210, v202
    v_mul_f32 v210, v210, v214
    v_mul_f32 v211, v211, v203
    v_mul_f32 v211, v211, v215
    v_cvt_pk_bf16_f32 v216, v208, v209
    v_cvt_pk_bf16_f32 v217, v210, v211
    buffer_store_dwordx2 v[216:217], v180, s[20:23], s34 offen offset:32
    v_accvgpr_read_b32 v200, a12
    v_accvgpr_read_b32 v204, a68
    v_accvgpr_read_b32 v201, a13
    v_accvgpr_read_b32 v205, a69
    v_accvgpr_read_b32 v202, a14
    v_accvgpr_read_b32 v206, a70
    v_accvgpr_read_b32 v203, a15
    v_accvgpr_read_b32 v207, a71
    v_fma_f32 v208, v179, v184, v192
    v_fma_f32 v212, v179, v188, v196
    v_fma_f32 v209, v179, v185, v193
    v_fma_f32 v213, v179, v189, v197
    v_fma_f32 v210, v179, v186, v194
    v_fma_f32 v214, v179, v190, v198
    v_fma_f32 v211, v179, v187, v195
    v_fma_f32 v215, v179, v191, v199
    v_fmac_f32 v208, v200, v178
    v_fmac_f32 v212, v204, v178
    v_fmac_f32 v209, v201, v178
    v_fmac_f32 v213, v205, v178
    v_fmac_f32 v210, v202, v178
    v_fmac_f32 v214, v206, v178
    v_fmac_f32 v211, v203, v178
    v_fmac_f32 v215, v207, v178
    v_mul_f32 v200, v208, v208
    v_fma_f32 v200, v200, s50, 1.0
    v_mul_f32 v200, v200, v208
    v_mul_f32 v200, 0xc0135761, v200
    v_mul_f32 v201, v209, v209
    v_fma_f32 v201, v201, s50, 1.0
    v_mul_f32 v201, v201, v209
    v_mul_f32 v201, 0xc0135761, v201
    v_mul_f32 v202, v210, v210
    v_fma_f32 v202, v202, s50, 1.0
    v_mul_f32 v202, v202, v210
    v_mul_f32 v202, 0xc0135761, v202
    v_mul_f32 v203, v211, v211
    v_fma_f32 v203, v203, s50, 1.0
    v_mul_f32 v203, v203, v211
    v_mul_f32 v203, 0xc0135761, v203
    v_exp_f32 v200, v200
    v_exp_f32 v201, v201
    v_exp_f32 v202, v202
    v_exp_f32 v203, v203
    s_nop 0
    v_add_f32 v200, 1.0, v200
    v_add_f32 v201, 1.0, v201
    v_add_f32 v202, 1.0, v202
    v_add_f32 v203, 1.0, v203
    v_rcp_f32 v200, v200
    v_rcp_f32 v201, v201
    v_rcp_f32 v202, v202
    v_rcp_f32 v203, v203
    s_nop 0
    v_mul_f32 v208, v208, v200
    v_mul_f32 v208, v208, v212
    v_mul_f32 v209, v209, v201
    v_mul_f32 v209, v209, v213
    v_mul_f32 v210, v210, v202
    v_mul_f32 v210, v210, v214
    v_mul_f32 v211, v211, v203
    v_mul_f32 v211, v211, v215
    v_cvt_pk_bf16_f32 v216, v208, v209
    v_cvt_pk_bf16_f32 v217, v210, v211
    buffer_store_dwordx2 v[216:217], v181, s[20:23], s34 offen offset:32
    ds_read_b128 v[184:187], v9 offset:128
    ds_read_b128 v[188:191], v9 offset:576
    ds_read_b128 v[192:195], v9 offset:1024
    ds_read_b128 v[196:199], v9 offset:1472
    s_waitcnt lgkmcnt(0)
    v_accvgpr_read_b32 v200, a16
    v_accvgpr_read_b32 v204, a72
    v_accvgpr_read_b32 v201, a17
    v_accvgpr_read_b32 v205, a73
    v_accvgpr_read_b32 v202, a18
    v_accvgpr_read_b32 v206, a74
    v_accvgpr_read_b32 v203, a19
    v_accvgpr_read_b32 v207, a75
    v_fma_f32 v208, v177, v184, v192
    v_fma_f32 v212, v177, v188, v196
    v_fma_f32 v209, v177, v185, v193
    v_fma_f32 v213, v177, v189, v197
    v_fma_f32 v210, v177, v186, v194
    v_fma_f32 v214, v177, v190, v198
    v_fma_f32 v211, v177, v187, v195
    v_fma_f32 v215, v177, v191, v199
    v_fmac_f32 v208, v200, v176
    v_fmac_f32 v212, v204, v176
    v_fmac_f32 v209, v201, v176
    v_fmac_f32 v213, v205, v176
    v_fmac_f32 v210, v202, v176
    v_fmac_f32 v214, v206, v176
    v_fmac_f32 v211, v203, v176
    v_fmac_f32 v215, v207, v176
    v_mul_f32 v200, v208, v208
    v_fma_f32 v200, v200, s50, 1.0
    v_mul_f32 v200, v200, v208
    v_mul_f32 v200, 0xc0135761, v200
    v_mul_f32 v201, v209, v209
    v_fma_f32 v201, v201, s50, 1.0
    v_mul_f32 v201, v201, v209
    v_mul_f32 v201, 0xc0135761, v201
    v_mul_f32 v202, v210, v210
    v_fma_f32 v202, v202, s50, 1.0
    v_mul_f32 v202, v202, v210
    v_mul_f32 v202, 0xc0135761, v202
    v_mul_f32 v203, v211, v211
    v_fma_f32 v203, v203, s50, 1.0
    v_mul_f32 v203, v203, v211
    v_mul_f32 v203, 0xc0135761, v203
    v_exp_f32 v200, v200
    v_exp_f32 v201, v201
    v_exp_f32 v202, v202
    v_exp_f32 v203, v203
    s_nop 0
    v_add_f32 v200, 1.0, v200
    v_add_f32 v201, 1.0, v201
    v_add_f32 v202, 1.0, v202
    v_add_f32 v203, 1.0, v203
    v_rcp_f32 v200, v200
    v_rcp_f32 v201, v201
    v_rcp_f32 v202, v202
    v_rcp_f32 v203, v203
    s_nop 0
    v_mul_f32 v208, v208, v200
    v_mul_f32 v208, v208, v212
    v_mul_f32 v209, v209, v201
    v_mul_f32 v209, v209, v213
    v_mul_f32 v210, v210, v202
    v_mul_f32 v210, v210, v214
    v_mul_f32 v211, v211, v203
    v_mul_f32 v211, v211, v215
    v_cvt_pk_bf16_f32 v216, v208, v209
    v_cvt_pk_bf16_f32 v217, v210, v211
    buffer_store_dwordx2 v[216:217], v180, s[20:23], s34 offen offset:64
    v_accvgpr_read_b32 v200, a20
    v_accvgpr_read_b32 v204, a76
    v_accvgpr_read_b32 v201, a21
    v_accvgpr_read_b32 v205, a77
    v_accvgpr_read_b32 v202, a22
    v_accvgpr_read_b32 v206, a78
    v_accvgpr_read_b32 v203, a23
    v_accvgpr_read_b32 v207, a79
    v_fma_f32 v208, v179, v184, v192
    v_fma_f32 v212, v179, v188, v196
    v_fma_f32 v209, v179, v185, v193
    v_fma_f32 v213, v179, v189, v197
    v_fma_f32 v210, v179, v186, v194
    v_fma_f32 v214, v179, v190, v198
    v_fma_f32 v211, v179, v187, v195
    v_fma_f32 v215, v179, v191, v199
    v_fmac_f32 v208, v200, v178
    v_fmac_f32 v212, v204, v178
    v_fmac_f32 v209, v201, v178
    v_fmac_f32 v213, v205, v178
    v_fmac_f32 v210, v202, v178
    v_fmac_f32 v214, v206, v178
    v_fmac_f32 v211, v203, v178
    v_fmac_f32 v215, v207, v178
    v_mul_f32 v200, v208, v208
    v_fma_f32 v200, v200, s50, 1.0
    v_mul_f32 v200, v200, v208
    v_mul_f32 v200, 0xc0135761, v200
    v_mul_f32 v201, v209, v209
    v_fma_f32 v201, v201, s50, 1.0
    v_mul_f32 v201, v201, v209
    v_mul_f32 v201, 0xc0135761, v201
    v_mul_f32 v202, v210, v210
    v_fma_f32 v202, v202, s50, 1.0
    v_mul_f32 v202, v202, v210
    v_mul_f32 v202, 0xc0135761, v202
    v_mul_f32 v203, v211, v211
    v_fma_f32 v203, v203, s50, 1.0
    v_mul_f32 v203, v203, v211
    v_mul_f32 v203, 0xc0135761, v203
    v_exp_f32 v200, v200
    v_exp_f32 v201, v201
    v_exp_f32 v202, v202
    v_exp_f32 v203, v203
    s_nop 0
    v_add_f32 v200, 1.0, v200
    v_add_f32 v201, 1.0, v201
    v_add_f32 v202, 1.0, v202
    v_add_f32 v203, 1.0, v203
    v_rcp_f32 v200, v200
    v_rcp_f32 v201, v201
    v_rcp_f32 v202, v202
    v_rcp_f32 v203, v203
    s_nop 0
    v_mul_f32 v208, v208, v200
    v_mul_f32 v208, v208, v212
    v_mul_f32 v209, v209, v201
    v_mul_f32 v209, v209, v213
    v_mul_f32 v210, v210, v202
    v_mul_f32 v210, v210, v214
    v_mul_f32 v211, v211, v203
    v_mul_f32 v211, v211, v215
    v_cvt_pk_bf16_f32 v216, v208, v209
    v_cvt_pk_bf16_f32 v217, v210, v211
    buffer_store_dwordx2 v[216:217], v181, s[20:23], s34 offen offset:64
    ds_read_b128 v[184:187], v9 offset:192
    ds_read_b128 v[188:191], v9 offset:640
    ds_read_b128 v[192:195], v9 offset:1088
    ds_read_b128 v[196:199], v9 offset:1536
    s_waitcnt lgkmcnt(0)
    v_accvgpr_read_b32 v200, a24
    v_accvgpr_read_b32 v204, a80
    v_accvgpr_read_b32 v201, a25
    v_accvgpr_read_b32 v205, a81
    v_accvgpr_read_b32 v202, a26
    v_accvgpr_read_b32 v206, a82
    v_accvgpr_read_b32 v203, a27
    v_accvgpr_read_b32 v207, a83
    v_fma_f32 v208, v177, v184, v192
    v_fma_f32 v212, v177, v188, v196
    v_fma_f32 v209, v177, v185, v193
    v_fma_f32 v213, v177, v189, v197
    v_fma_f32 v210, v177, v186, v194
    v_fma_f32 v214, v177, v190, v198
    v_fma_f32 v211, v177, v187, v195
    v_fma_f32 v215, v177, v191, v199
    v_fmac_f32 v208, v200, v176
    v_fmac_f32 v212, v204, v176
    v_fmac_f32 v209, v201, v176
    v_fmac_f32 v213, v205, v176
    v_fmac_f32 v210, v202, v176
    v_fmac_f32 v214, v206, v176
    v_fmac_f32 v211, v203, v176
    v_fmac_f32 v215, v207, v176
    v_mul_f32 v200, v208, v208
    v_fma_f32 v200, v200, s50, 1.0
    v_mul_f32 v200, v200, v208
    v_mul_f32 v200, 0xc0135761, v200
    v_mul_f32 v201, v209, v209
    v_fma_f32 v201, v201, s50, 1.0
    v_mul_f32 v201, v201, v209
    v_mul_f32 v201, 0xc0135761, v201
    v_mul_f32 v202, v210, v210
    v_fma_f32 v202, v202, s50, 1.0
    v_mul_f32 v202, v202, v210
    v_mul_f32 v202, 0xc0135761, v202
    v_mul_f32 v203, v211, v211
    v_fma_f32 v203, v203, s50, 1.0
    v_mul_f32 v203, v203, v211
    v_mul_f32 v203, 0xc0135761, v203
    v_exp_f32 v200, v200
    v_exp_f32 v201, v201
    v_exp_f32 v202, v202
    v_exp_f32 v203, v203
    s_nop 0
    v_add_f32 v200, 1.0, v200
    v_add_f32 v201, 1.0, v201
    v_add_f32 v202, 1.0, v202
    v_add_f32 v203, 1.0, v203
    v_rcp_f32 v200, v200
    v_rcp_f32 v201, v201
    v_rcp_f32 v202, v202
    v_rcp_f32 v203, v203
    s_nop 0
    v_mul_f32 v208, v208, v200
    v_mul_f32 v208, v208, v212
    v_mul_f32 v209, v209, v201
    v_mul_f32 v209, v209, v213
    v_mul_f32 v210, v210, v202
    v_mul_f32 v210, v210, v214
    v_mul_f32 v211, v211, v203
    v_mul_f32 v211, v211, v215
    v_cvt_pk_bf16_f32 v216, v208, v209
    v_cvt_pk_bf16_f32 v217, v210, v211
    buffer_store_dwordx2 v[216:217], v180, s[20:23], s34 offen offset:96
    v_accvgpr_read_b32 v200, a28
    v_accvgpr_read_b32 v204, a84
    v_accvgpr_read_b32 v201, a29
    v_accvgpr_read_b32 v205, a85
    v_accvgpr_read_b32 v202, a30
    v_accvgpr_read_b32 v206, a86
    v_accvgpr_read_b32 v203, a31
    v_accvgpr_read_b32 v207, a87
    v_fma_f32 v208, v179, v184, v192
    v_fma_f32 v212, v179, v188, v196
    v_fma_f32 v209, v179, v185, v193
    v_fma_f32 v213, v179, v189, v197
    v_fma_f32 v210, v179, v186, v194
    v_fma_f32 v214, v179, v190, v198
    v_fma_f32 v211, v179, v187, v195
    v_fma_f32 v215, v179, v191, v199
    v_fmac_f32 v208, v200, v178
    v_fmac_f32 v212, v204, v178
    v_fmac_f32 v209, v201, v178
    v_fmac_f32 v213, v205, v178
    v_fmac_f32 v210, v202, v178
    v_fmac_f32 v214, v206, v178
    v_fmac_f32 v211, v203, v178
    v_fmac_f32 v215, v207, v178
    v_mul_f32 v200, v208, v208
    v_fma_f32 v200, v200, s50, 1.0
    v_mul_f32 v200, v200, v208
    v_mul_f32 v200, 0xc0135761, v200
    v_mul_f32 v201, v209, v209
    v_fma_f32 v201, v201, s50, 1.0
    v_mul_f32 v201, v201, v209
    v_mul_f32 v201, 0xc0135761, v201
    v_mul_f32 v202, v210, v210
    v_fma_f32 v202, v202, s50, 1.0
    v_mul_f32 v202, v202, v210
    v_mul_f32 v202, 0xc0135761, v202
    v_mul_f32 v203, v211, v211
    v_fma_f32 v203, v203, s50, 1.0
    v_mul_f32 v203, v203, v211
    v_mul_f32 v203, 0xc0135761, v203
    v_exp_f32 v200, v200
    v_exp_f32 v201, v201
    v_exp_f32 v202, v202
    v_exp_f32 v203, v203
    s_nop 0
    v_add_f32 v200, 1.0, v200
    v_add_f32 v201, 1.0, v201
    v_add_f32 v202, 1.0, v202
    v_add_f32 v203, 1.0, v203
    v_rcp_f32 v200, v200
    v_rcp_f32 v201, v201
    v_rcp_f32 v202, v202
    v_rcp_f32 v203, v203
    s_nop 0
    v_mul_f32 v208, v208, v200
    v_mul_f32 v208, v208, v212
    v_mul_f32 v209, v209, v201
    v_mul_f32 v209, v209, v213
    v_mul_f32 v210, v210, v202
    v_mul_f32 v210, v210, v214
    v_mul_f32 v211, v211, v203
    v_mul_f32 v211, v211, v215
    v_cvt_pk_bf16_f32 v216, v208, v209
    v_cvt_pk_bf16_f32 v217, v210, v211
    buffer_store_dwordx2 v[216:217], v181, s[20:23], s34 offen offset:96
    ds_read_b128 v[184:187], v9 offset:256
    ds_read_b128 v[188:191], v9 offset:704
    ds_read_b128 v[192:195], v9 offset:1152
    ds_read_b128 v[196:199], v9 offset:1600
    s_waitcnt lgkmcnt(0)
    v_accvgpr_read_b32 v200, a32
    v_accvgpr_read_b32 v204, a88
    v_accvgpr_read_b32 v201, a33
    v_accvgpr_read_b32 v205, a89
    v_accvgpr_read_b32 v202, a34
    v_accvgpr_read_b32 v206, a90
    v_accvgpr_read_b32 v203, a35
    v_accvgpr_read_b32 v207, a91
    v_fma_f32 v208, v177, v184, v192
    v_fma_f32 v212, v177, v188, v196
    v_fma_f32 v209, v177, v185, v193
    v_fma_f32 v213, v177, v189, v197
    v_fma_f32 v210, v177, v186, v194
    v_fma_f32 v214, v177, v190, v198
    v_fma_f32 v211, v177, v187, v195
    v_fma_f32 v215, v177, v191, v199
    v_fmac_f32 v208, v200, v176
    v_fmac_f32 v212, v204, v176
    v_fmac_f32 v209, v201, v176
    v_fmac_f32 v213, v205, v176
    v_fmac_f32 v210, v202, v176
    v_fmac_f32 v214, v206, v176
    v_fmac_f32 v211, v203, v176
    v_fmac_f32 v215, v207, v176
    v_mul_f32 v200, v208, v208
    v_fma_f32 v200, v200, s50, 1.0
    v_mul_f32 v200, v200, v208
    v_mul_f32 v200, 0xc0135761, v200
    v_mul_f32 v201, v209, v209
    v_fma_f32 v201, v201, s50, 1.0
    v_mul_f32 v201, v201, v209
    v_mul_f32 v201, 0xc0135761, v201
    v_mul_f32 v202, v210, v210
    v_fma_f32 v202, v202, s50, 1.0
    v_mul_f32 v202, v202, v210
    v_mul_f32 v202, 0xc0135761, v202
    v_mul_f32 v203, v211, v211
    v_fma_f32 v203, v203, s50, 1.0
    v_mul_f32 v203, v203, v211
    v_mul_f32 v203, 0xc0135761, v203
    v_exp_f32 v200, v200
    v_exp_f32 v201, v201
    v_exp_f32 v202, v202
    v_exp_f32 v203, v203
    s_nop 0
    v_add_f32 v200, 1.0, v200
    v_add_f32 v201, 1.0, v201
    v_add_f32 v202, 1.0, v202
    v_add_f32 v203, 1.0, v203
    v_rcp_f32 v200, v200
    v_rcp_f32 v201, v201
    v_rcp_f32 v202, v202
    v_rcp_f32 v203, v203
    s_nop 0
    v_mul_f32 v208, v208, v200
    v_mul_f32 v208, v208, v212
    v_mul_f32 v209, v209, v201
    v_mul_f32 v209, v209, v213
    v_mul_f32 v210, v210, v202
    v_mul_f32 v210, v210, v214
    v_mul_f32 v211, v211, v203
    v_mul_f32 v211, v211, v215
    v_cvt_pk_bf16_f32 v216, v208, v209
    v_cvt_pk_bf16_f32 v217, v210, v211
    buffer_store_dwordx2 v[216:217], v180, s[20:23], s34 offen offset:128
    v_accvgpr_read_b32 v200, a36
    v_accvgpr_read_b32 v204, a92
    v_accvgpr_read_b32 v201, a37
    v_accvgpr_read_b32 v205, a93
    v_accvgpr_read_b32 v202, a38
    v_accvgpr_read_b32 v206, a94
    v_accvgpr_read_b32 v203, a39
    v_accvgpr_read_b32 v207, a95
    v_fma_f32 v208, v179, v184, v192
    v_fma_f32 v212, v179, v188, v196
    v_fma_f32 v209, v179, v185, v193
    v_fma_f32 v213, v179, v189, v197
    v_fma_f32 v210, v179, v186, v194
    v_fma_f32 v214, v179, v190, v198
    v_fma_f32 v211, v179, v187, v195
    v_fma_f32 v215, v179, v191, v199
    v_fmac_f32 v208, v200, v178
    v_fmac_f32 v212, v204, v178
    v_fmac_f32 v209, v201, v178
    v_fmac_f32 v213, v205, v178
    v_fmac_f32 v210, v202, v178
    v_fmac_f32 v214, v206, v178
    v_fmac_f32 v211, v203, v178
    v_fmac_f32 v215, v207, v178
    v_mul_f32 v200, v208, v208
    v_fma_f32 v200, v200, s50, 1.0
    v_mul_f32 v200, v200, v208
    v_mul_f32 v200, 0xc0135761, v200
    v_mul_f32 v201, v209, v209
    v_fma_f32 v201, v201, s50, 1.0
    v_mul_f32 v201, v201, v209
    v_mul_f32 v201, 0xc0135761, v201
    v_mul_f32 v202, v210, v210
    v_fma_f32 v202, v202, s50, 1.0
    v_mul_f32 v202, v202, v210
    v_mul_f32 v202, 0xc0135761, v202
    v_mul_f32 v203, v211, v211
    v_fma_f32 v203, v203, s50, 1.0
    v_mul_f32 v203, v203, v211
    v_mul_f32 v203, 0xc0135761, v203
    v_exp_f32 v200, v200
    v_exp_f32 v201, v201
    v_exp_f32 v202, v202
    v_exp_f32 v203, v203
    s_nop 0
    v_add_f32 v200, 1.0, v200
    v_add_f32 v201, 1.0, v201
    v_add_f32 v202, 1.0, v202
    v_add_f32 v203, 1.0, v203
    v_rcp_f32 v200, v200
    v_rcp_f32 v201, v201
    v_rcp_f32 v202, v202
    v_rcp_f32 v203, v203
    s_nop 0
    v_mul_f32 v208, v208, v200
    v_mul_f32 v208, v208, v212
    v_mul_f32 v209, v209, v201
    v_mul_f32 v209, v209, v213
    v_mul_f32 v210, v210, v202
    v_mul_f32 v210, v210, v214
    v_mul_f32 v211, v211, v203
    v_mul_f32 v211, v211, v215
    v_cvt_pk_bf16_f32 v216, v208, v209
    v_cvt_pk_bf16_f32 v217, v210, v211
    buffer_store_dwordx2 v[216:217], v181, s[20:23], s34 offen offset:128
    ds_read_b128 v[184:187], v9 offset:320
    ds_read_b128 v[188:191], v9 offset:768
    ds_read_b128 v[192:195], v9 offset:1216
    ds_read_b128 v[196:199], v9 offset:1664
    s_waitcnt lgkmcnt(0)
    v_accvgpr_read_b32 v200, a40
    v_accvgpr_read_b32 v204, a96
    v_accvgpr_read_b32 v201, a41
    v_accvgpr_read_b32 v205, a97
    v_accvgpr_read_b32 v202, a42
    v_accvgpr_read_b32 v206, a98
    v_accvgpr_read_b32 v203, a43
    v_accvgpr_read_b32 v207, a99
    v_fma_f32 v208, v177, v184, v192
    v_fma_f32 v212, v177, v188, v196
    v_fma_f32 v209, v177, v185, v193
    v_fma_f32 v213, v177, v189, v197
    v_fma_f32 v210, v177, v186, v194
    v_fma_f32 v214, v177, v190, v198
    v_fma_f32 v211, v177, v187, v195
    v_fma_f32 v215, v177, v191, v199
    v_fmac_f32 v208, v200, v176
    v_fmac_f32 v212, v204, v176
    v_fmac_f32 v209, v201, v176
    v_fmac_f32 v213, v205, v176
    v_fmac_f32 v210, v202, v176
    v_fmac_f32 v214, v206, v176
    v_fmac_f32 v211, v203, v176
    v_fmac_f32 v215, v207, v176
    v_mul_f32 v200, v208, v208
    v_fma_f32 v200, v200, s50, 1.0
    v_mul_f32 v200, v200, v208
    v_mul_f32 v200, 0xc0135761, v200
    v_mul_f32 v201, v209, v209
    v_fma_f32 v201, v201, s50, 1.0
    v_mul_f32 v201, v201, v209
    v_mul_f32 v201, 0xc0135761, v201
    v_mul_f32 v202, v210, v210
    v_fma_f32 v202, v202, s50, 1.0
    v_mul_f32 v202, v202, v210
    v_mul_f32 v202, 0xc0135761, v202
    v_mul_f32 v203, v211, v211
    v_fma_f32 v203, v203, s50, 1.0
    v_mul_f32 v203, v203, v211
    v_mul_f32 v203, 0xc0135761, v203
    v_exp_f32 v200, v200
    v_exp_f32 v201, v201
    v_exp_f32 v202, v202
    v_exp_f32 v203, v203
    s_nop 0
    v_add_f32 v200, 1.0, v200
    v_add_f32 v201, 1.0, v201
    v_add_f32 v202, 1.0, v202
    v_add_f32 v203, 1.0, v203
    v_rcp_f32 v200, v200
    v_rcp_f32 v201, v201
    v_rcp_f32 v202, v202
    v_rcp_f32 v203, v203
    s_nop 0
    v_mul_f32 v208, v208, v200
    v_mul_f32 v208, v208, v212
    v_mul_f32 v209, v209, v201
    v_mul_f32 v209, v209, v213
    v_mul_f32 v210, v210, v202
    v_mul_f32 v210, v210, v214
    v_mul_f32 v211, v211, v203
    v_mul_f32 v211, v211, v215
    v_cvt_pk_bf16_f32 v216, v208, v209
    v_cvt_pk_bf16_f32 v217, v210, v211
    buffer_store_dwordx2 v[216:217], v180, s[20:23], s34 offen offset:160
    v_accvgpr_read_b32 v200, a44
    v_accvgpr_read_b32 v204, a100
    v_accvgpr_read_b32 v201, a45
    v_accvgpr_read_b32 v205, a101
    v_accvgpr_read_b32 v202, a46
    v_accvgpr_read_b32 v206, a102
    v_accvgpr_read_b32 v203, a47
    v_accvgpr_read_b32 v207, a103
    v_fma_f32 v208, v179, v184, v192
    v_fma_f32 v212, v179, v188, v196
    v_fma_f32 v209, v179, v185, v193
    v_fma_f32 v213, v179, v189, v197
    v_fma_f32 v210, v179, v186, v194
    v_fma_f32 v214, v179, v190, v198
    v_fma_f32 v211, v179, v187, v195
    v_fma_f32 v215, v179, v191, v199
    v_fmac_f32 v208, v200, v178
    v_fmac_f32 v212, v204, v178
    v_fmac_f32 v209, v201, v178
    v_fmac_f32 v213, v205, v178
    v_fmac_f32 v210, v202, v178
    v_fmac_f32 v214, v206, v178
    v_fmac_f32 v211, v203, v178
    v_fmac_f32 v215, v207, v178
    v_mul_f32 v200, v208, v208
    v_fma_f32 v200, v200, s50, 1.0
    v_mul_f32 v200, v200, v208
    v_mul_f32 v200, 0xc0135761, v200
    v_mul_f32 v201, v209, v209
    v_fma_f32 v201, v201, s50, 1.0
    v_mul_f32 v201, v201, v209
    v_mul_f32 v201, 0xc0135761, v201
    v_mul_f32 v202, v210, v210
    v_fma_f32 v202, v202, s50, 1.0
    v_mul_f32 v202, v202, v210
    v_mul_f32 v202, 0xc0135761, v202
    v_mul_f32 v203, v211, v211
    v_fma_f32 v203, v203, s50, 1.0
    v_mul_f32 v203, v203, v211
    v_mul_f32 v203, 0xc0135761, v203
    v_exp_f32 v200, v200
    v_exp_f32 v201, v201
    v_exp_f32 v202, v202
    v_exp_f32 v203, v203
    s_nop 0
    v_add_f32 v200, 1.0, v200
    v_add_f32 v201, 1.0, v201
    v_add_f32 v202, 1.0, v202
    v_add_f32 v203, 1.0, v203
    v_rcp_f32 v200, v200
    v_rcp_f32 v201, v201
    v_rcp_f32 v202, v202
    v_rcp_f32 v203, v203
    s_nop 0
    v_mul_f32 v208, v208, v200
    v_mul_f32 v208, v208, v212
    v_mul_f32 v209, v209, v201
    v_mul_f32 v209, v209, v213
    v_mul_f32 v210, v210, v202
    v_mul_f32 v210, v210, v214
    v_mul_f32 v211, v211, v203
    v_mul_f32 v211, v211, v215
    v_cvt_pk_bf16_f32 v216, v208, v209
    v_cvt_pk_bf16_f32 v217, v210, v211
    buffer_store_dwordx2 v[216:217], v181, s[20:23], s34 offen offset:160
    ds_read_b128 v[184:187], v9 offset:384
    ds_read_b128 v[188:191], v9 offset:832
    ds_read_b128 v[192:195], v9 offset:1280
    ds_read_b128 v[196:199], v9 offset:1728
    s_waitcnt lgkmcnt(0)
    v_accvgpr_read_b32 v200, a48
    v_accvgpr_read_b32 v204, a104
    v_accvgpr_read_b32 v201, a49
    v_accvgpr_read_b32 v205, a105
    v_accvgpr_read_b32 v202, a50
    v_accvgpr_read_b32 v206, a106
    v_accvgpr_read_b32 v203, a51
    v_accvgpr_read_b32 v207, a107
    v_fma_f32 v208, v177, v184, v192
    v_fma_f32 v212, v177, v188, v196
    v_fma_f32 v209, v177, v185, v193
    v_fma_f32 v213, v177, v189, v197
    v_fma_f32 v210, v177, v186, v194
    v_fma_f32 v214, v177, v190, v198
    v_fma_f32 v211, v177, v187, v195
    v_fma_f32 v215, v177, v191, v199
    v_fmac_f32 v208, v200, v176
    v_fmac_f32 v212, v204, v176
    v_fmac_f32 v209, v201, v176
    v_fmac_f32 v213, v205, v176
    v_fmac_f32 v210, v202, v176
    v_fmac_f32 v214, v206, v176
    v_fmac_f32 v211, v203, v176
    v_fmac_f32 v215, v207, v176
    v_mul_f32 v200, v208, v208
    v_fma_f32 v200, v200, s50, 1.0
    v_mul_f32 v200, v200, v208
    v_mul_f32 v200, 0xc0135761, v200
    v_mul_f32 v201, v209, v209
    v_fma_f32 v201, v201, s50, 1.0
    v_mul_f32 v201, v201, v209
    v_mul_f32 v201, 0xc0135761, v201
    v_mul_f32 v202, v210, v210
    v_fma_f32 v202, v202, s50, 1.0
    v_mul_f32 v202, v202, v210
    v_mul_f32 v202, 0xc0135761, v202
    v_mul_f32 v203, v211, v211
    v_fma_f32 v203, v203, s50, 1.0
    v_mul_f32 v203, v203, v211
    v_mul_f32 v203, 0xc0135761, v203
    v_exp_f32 v200, v200
    v_exp_f32 v201, v201
    v_exp_f32 v202, v202
    v_exp_f32 v203, v203
    s_nop 0
    v_add_f32 v200, 1.0, v200
    v_add_f32 v201, 1.0, v201
    v_add_f32 v202, 1.0, v202
    v_add_f32 v203, 1.0, v203
    v_rcp_f32 v200, v200
    v_rcp_f32 v201, v201
    v_rcp_f32 v202, v202
    v_rcp_f32 v203, v203
    s_nop 0
    v_mul_f32 v208, v208, v200
    v_mul_f32 v208, v208, v212
    v_mul_f32 v209, v209, v201
    v_mul_f32 v209, v209, v213
    v_mul_f32 v210, v210, v202
    v_mul_f32 v210, v210, v214
    v_mul_f32 v211, v211, v203
    v_mul_f32 v211, v211, v215
    v_cvt_pk_bf16_f32 v216, v208, v209
    v_cvt_pk_bf16_f32 v217, v210, v211
    buffer_store_dwordx2 v[216:217], v180, s[20:23], s34 offen offset:192
    v_accvgpr_read_b32 v200, a52
    v_accvgpr_read_b32 v204, a108
    v_accvgpr_read_b32 v201, a53
    v_accvgpr_read_b32 v205, a109
    v_accvgpr_read_b32 v202, a54
    v_accvgpr_read_b32 v206, a110
    v_accvgpr_read_b32 v203, a55
    v_accvgpr_read_b32 v207, a111
    v_fma_f32 v208, v179, v184, v192
    v_fma_f32 v212, v179, v188, v196
    v_fma_f32 v209, v179, v185, v193
    v_fma_f32 v213, v179, v189, v197
    v_fma_f32 v210, v179, v186, v194
    v_fma_f32 v214, v179, v190, v198
    v_fma_f32 v211, v179, v187, v195
    v_fma_f32 v215, v179, v191, v199
    v_fmac_f32 v208, v200, v178
    v_fmac_f32 v212, v204, v178
    v_fmac_f32 v209, v201, v178
    v_fmac_f32 v213, v205, v178
    v_fmac_f32 v210, v202, v178
    v_fmac_f32 v214, v206, v178
    v_fmac_f32 v211, v203, v178
    v_fmac_f32 v215, v207, v178
    v_mul_f32 v200, v208, v208
    v_fma_f32 v200, v200, s50, 1.0
    v_mul_f32 v200, v200, v208
    v_mul_f32 v200, 0xc0135761, v200
    v_mul_f32 v201, v209, v209
    v_fma_f32 v201, v201, s50, 1.0
    v_mul_f32 v201, v201, v209
    v_mul_f32 v201, 0xc0135761, v201
    v_mul_f32 v202, v210, v210
    v_fma_f32 v202, v202, s50, 1.0
    v_mul_f32 v202, v202, v210
    v_mul_f32 v202, 0xc0135761, v202
    v_mul_f32 v203, v211, v211
    v_fma_f32 v203, v203, s50, 1.0
    v_mul_f32 v203, v203, v211
    v_mul_f32 v203, 0xc0135761, v203
    v_exp_f32 v200, v200
    v_exp_f32 v201, v201
    v_exp_f32 v202, v202
    v_exp_f32 v203, v203
    s_nop 0
    v_add_f32 v200, 1.0, v200
    v_add_f32 v201, 1.0, v201
    v_add_f32 v202, 1.0, v202
    v_add_f32 v203, 1.0, v203
    v_rcp_f32 v200, v200
    v_rcp_f32 v201, v201
    v_rcp_f32 v202, v202
    v_rcp_f32 v203, v203
    s_nop 0
    v_mul_f32 v208, v208, v200
    v_mul_f32 v208, v208, v212
    v_mul_f32 v209, v209, v201
    v_mul_f32 v209, v209, v213
    v_mul_f32 v210, v210, v202
    v_mul_f32 v210, v210, v214
    v_mul_f32 v211, v211, v203
    v_mul_f32 v211, v211, v215
    v_cvt_pk_bf16_f32 v216, v208, v209
    v_cvt_pk_bf16_f32 v217, v210, v211
    buffer_store_dwordx2 v[216:217], v181, s[20:23], s34 offen offset:192
K3_END:
    s_endpgm

.globl k4_kernel
.p2align 8
.type k4_kernel,@function
k4_kernel:

    s_cmp_ge_u32 s2, 256
    s_cbranch_scc1 K4_END
    s_load_dwordx2 s[6:7], s[0:1], 48
    s_load_dwordx2 s[8:9], s[0:1], 88
    s_load_dwordx2 s[4:5], s[0:1], 72
    s_and_b32 s27, s2, 7
    s_lshr_b32 s28, s2, 3
    s_lshl_b32 s24, s27, 2
    s_and_b32 s29, s28, 3
    s_add_u32 s24, s24, s29
    s_lshr_b32 s25, s28, 2
    v_and_b32 v1, 63, v0
    v_lshrrev_b32 v2, 6, v0
    s_nop 0
    v_readfirstlane_b32 s26, v2
    s_waitcnt lgkmcnt(0)
    s_add_u32 s12, s8, 7340032
    s_addc_u32 s13, s9, 0
    s_mov_b32 s14, 7340032
    s_mov_b32 s15, 0x00020000
    s_mov_b32 s16, s6
    s_mov_b32 s17, s7
    s_mov_b32 s18, 1835008
    s_mov_b32 s19, 0x00020000
    s_mov_b32 s20, s8
    s_mov_b32 s21, s9
    s_mov_b32 s22, 16777216
    s_mov_b32 s23, 0x00020000
    v_lshrrev_b32 v5, 4, v1
    v_and_b32 v6, 15, v1
    v_add_u32 v7, 0, v5
    v_xor_b32 v7, v7, v6
    v_lshlrev_b32 v7, 4, v7
    v_mul_u32_u24 v8, 3584, v5
    v_add_u32 v10, v7, v8
    v_add_u32 v7, 4, v5
    v_xor_b32 v7, v7, v6
    v_lshlrev_b32 v7, 4, v7
    v_mul_u32_u24 v8, 3584, v5
    v_add_u32 v11, v7, v8
    v_add_u32 v7, 8, v5
    v_xor_b32 v7, v7, v6
    v_lshlrev_b32 v7, 4, v7
    v_mul_u32_u24 v8, 3584, v5
    v_add_u32 v12, v7, v8
    v_add_u32 v7, 12, v5
    v_xor_b32 v7, v7, v6
    v_lshlrev_b32 v7, 4, v7
    v_mul_u32_u24 v8, 3584, v5
    v_add_u32 v13, v7, v8
    v_lshrrev_b32 v7, 3, v1
    v_mul_u32_u24 v7, 1024, v7
    v_and_b32 v8, 7, v1
    v_lshrrev_b32 v9, 4, v1
    v_and_b32 v9, 1, v9
    v_lshlrev_b32 v9, 1, v9
    v_xor_b32 v16, v8, v9
    v_lshl_add_u32 v14, v16, 4, v7
    v_or_b32 v9, 4, v9
    v_xor_b32 v16, v8, v9
    v_lshl_add_u32 v15, v16, 4, v7
    s_lshl_b32 s27, s24, 6
    s_lshl_b32 s28, s26, 4
    s_add_u32 s27, s27, s28
    s_mul_i32 s30, s27, 3584
    s_lshl_b32 s28, s26, 15
    s_lshl_b32 s29, s25, 7
    s_add_u32 s31, s28, s29
    s_lshl_b32 s32, s26, 12
    s_lshl_b32 s33, s26, 12
    s_add_u32 s34, s32, 0
    s_mov_b32 m0, s34
    s_add_u32 s35, s30, 0
    buffer_load_dwordx4 v10, s[12:15], s35 offen lds
    s_add_u32 s34, s32, 1024
    s_mov_b32 m0, s34
    s_add_u32 s35, s30, 14336
    buffer_load_dwordx4 v11, s[12:15], s35 offen lds
    s_add_u32 s34, s32, 2048
    s_mov_b32 m0, s34
    s_add_u32 s35, s30, 28672
    buffer_load_dwordx4 v12, s[12:15], s35 offen lds
    s_add_u32 s34, s32, 3072
    s_mov_b32 m0, s34
    s_add_u32 s35, s30, 43008
    buffer_load_dwordx4 v13, s[12:15], s35 offen lds
    s_add_u32 s34, s33, 16384
    s_mov_b32 m0, s34
    s_add_u32 s35, s31, 0
    buffer_load_dwordx4 v14, s[16:19], s35 offen lds
    s_add_u32 s34, s33, 17408
    s_mov_b32 m0, s34
    s_add_u32 s35, s31, 8192
    buffer_load_dwordx4 v15, s[16:19], s35 offen lds
    s_add_u32 s34, s33, 18432
    s_mov_b32 m0, s34
    s_add_u32 s35, s31, 16384
    buffer_load_dwordx4 v14, s[16:19], s35 offen lds
    s_add_u32 s34, s33, 19456
    s_mov_b32 m0, s34
    s_add_u32 s35, s31, 24576
    buffer_load_dwordx4 v15, s[16:19], s35 offen lds
    s_add_u32 s34, s32, 32768
    s_mov_b32 m0, s34
    s_add_u32 s35, s30, 256
    buffer_load_dwordx4 v10, s[12:15], s35 offen lds
    s_add_u32 s34, s32, 33792
    s_mov_b32 m0, s34
    s_add_u32 s35, s30, 14592
    buffer_load_dwordx4 v11, s[12:15], s35 offen lds
    s_add_u32 s34, s32, 34816
    s_mov_b32 m0, s34
    s_add_u32 s35, s30, 28928
    buffer_load_dwordx4 v12, s[12:15], s35 offen lds
    s_add_u32 s34, s32, 35840
    s_mov_b32 m0, s34
    s_add_u32 s35, s30, 43264
    buffer_load_dwordx4 v13, s[12:15], s35 offen lds
    s_add_u32 s34, s33, 49152
    s_mov_b32 m0, s34
    s_add_u32 s35, s31, 131072
    buffer_load_dwordx4 v14, s[16:19], s35 offen lds
    s_add_u32 s34, s33, 50176
    s_mov_b32 m0, s34
    s_add_u32 s35, s31, 139264
    buffer_load_dwordx4 v15, s[16:19], s35 offen lds
    s_add_u32 s34, s33, 51200
    s_mov_b32 m0, s34
    s_add_u32 s35, s31, 147456
    buffer_load_dwordx4 v14, s[16:19], s35 offen lds
    s_add_u32 s34, s33, 52224
    s_mov_b32 m0, s34
    s_add_u32 s35, s31, 155648
    buffer_load_dwordx4 v15, s[16:19], s35 offen lds
    s_add_u32 s34, s32, 65536
    s_mov_b32 m0, s34
    s_add_u32 s35, s30, 512
    buffer_load_dwordx4 v10, s[12:15], s35 offen lds
    s_add_u32 s34, s32, 66560
    s_mov_b32 m0, s34
    s_add_u32 s35, s30, 14848
    buffer_load_dwordx4 v11, s[12:15], s35 offen lds
    s_add_u32 s34, s32, 67584
    s_mov_b32 m0, s34
    s_add_u32 s35, s30, 29184
    buffer_load_dwordx4 v12, s[12:15], s35 offen lds
    s_add_u32 s34, s32, 68608
    s_mov_b32 m0, s34
    s_add_u32 s35, s30, 43520
    buffer_load_dwordx4 v13, s[12:15], s35 offen lds
    s_add_u32 s34, s33, 81920
    s_mov_b32 m0, s34
    s_add_u32 s35, s31, 262144
    buffer_load_dwordx4 v14, s[16:19], s35 offen lds
    s_add_u32 s34, s33, 82944
    s_mov_b32 m0, s34
    s_add_u32 s35, s31, 270336
    buffer_load_dwordx4 v15, s[16:19], s35 offen lds
    s_add_u32 s34, s33, 83968
    s_mov_b32 m0, s34
    s_add_u32 s35, s31, 278528
    buffer_load_dwordx4 v14, s[16:19], s35 offen lds
    s_add_u32 s34, s33, 84992
    s_mov_b32 m0, s34
    s_add_u32 s35, s31, 286720
    buffer_load_dwordx4 v15, s[16:19], s35 offen lds
    s_add_u32 s34, s32, 98304
    s_mov_b32 m0, s34
    s_add_u32 s35, s30, 768
    buffer_load_dwordx4 v10, s[12:15], s35 offen lds
    s_add_u32 s34, s32, 99328
    s_mov_b32 m0, s34
    s_add_u32 s35, s30, 15104
    buffer_load_dwordx4 v11, s[12:15], s35 offen lds
    s_add_u32 s34, s32, 100352
    s_mov_b32 m0, s34
    s_add_u32 s35, s30, 29440
    buffer_load_dwordx4 v12, s[12:15], s35 offen lds
    s_add_u32 s34, s32, 101376
    s_mov_b32 m0, s34
    s_add_u32 s35, s30, 43776
    buffer_load_dwordx4 v13, s[12:15], s35 offen lds
    s_add_u32 s34, s33, 114688
    s_mov_b32 m0, s34
    s_add_u32 s35, s31, 393216
    buffer_load_dwordx4 v14, s[16:19], s35 offen lds
    s_add_u32 s34, s33, 115712
    s_mov_b32 m0, s34
    s_add_u32 s35, s31, 401408
    buffer_load_dwordx4 v15, s[16:19], s35 offen lds
    s_add_u32 s34, s33, 116736
    s_mov_b32 m0, s34
    s_add_u32 s35, s31, 409600
    buffer_load_dwordx4 v14, s[16:19], s35 offen lds
    s_add_u32 s34, s33, 117760
    s_mov_b32 m0, s34
    s_add_u32 s35, s31, 417792
    buffer_load_dwordx4 v15, s[16:19], s35 offen lds
    s_and_b32 s28, s26, 1
    s_lshr_b32 s29, s26, 1
    s_lshl_b32 s34, s28, 13
    v_add_u32 v7, 0, v5
    v_xor_b32 v7, v7, v6
    v_lshlrev_b32 v7, 4, v7
    v_lshl_add_u32 v7, v6, 8, v7
    v_add_u32 v20, s34, v7
    v_add_u32 v7, 4, v5
    v_xor_b32 v7, v7, v6
    v_lshlrev_b32 v7, 4, v7
    v_lshl_add_u32 v7, v6, 8, v7
    v_add_u32 v21, s34, v7
    v_add_u32 v7, 8, v5
    v_xor_b32 v7, v7, v6
    v_lshlrev_b32 v7, 4, v7
    v_lshl_add_u32 v7, v6, 8, v7
    v_add_u32 v22, s34, v7
    v_add_u32 v7, 12, v5
    v_xor_b32 v7, v7, v6
    v_lshlrev_b32 v7, 4, v7
    v_lshl_add_u32 v7, v6, 8, v7
    v_add_u32 v23, s34, v7
    v_lshrrev_b32 v7, 2, v6
    v_lshl_add_u32 v7, v5, 3, v7
    v_lshlrev_b32 v7, 7, v7
    v_and_b32 v8, 3, v1
    v_lshl_add_u32 v7, v8, 3, v7
    v_add_u32 v7, 0x4000, v7
    v_lshrrev_b32 v8, 3, v1
    v_and_b32 v8, 3, v8
    s_lshl_b32 s34, s29, 1
    v_xor_b32 v9, s34, v8
    v_lshl_add_u32 v24, v9, 5, v7
    s_add_u32 s34, s34, 1
    v_xor_b32 v9, s34, v8
    v_lshl_add_u32 v25, v9, 5, v7
    v_add_u32 v26, 0x10000, v20
    v_add_u32 v27, 0x10000, v21
    v_add_u32 v28, 0x10000, v22
    v_add_u32 v29, 0x10000, v23
    v_add_u32 v30, 0x10000, v24
    v_add_u32 v31, 0x10000, v25
    v_mov_b32 v64, 0
    v_mov_b32 v65, 0
    v_mov_b32 v66, 0
    v_mov_b32 v67, 0
    v_mov_b32 v68, 0
    v_mov_b32 v69, 0
    v_mov_b32 v70, 0
    v_mov_b32 v71, 0
    v_mov_b32 v72, 0
    v_mov_b32 v73, 0
    v_mov_b32 v74, 0
    v_mov_b32 v75, 0
    v_mov_b32 v76, 0
    v_mov_b32 v77, 0
    v_mov_b32 v78, 0
    v_mov_b32 v79, 0
    s_waitcnt vmcnt(24)
    s_barrier
    ds_read_b64_tr_b16 v[40:41], v24 offset:0
    ds_read_b64_tr_b16 v[42:43], v24 offset:512
    ds_read_b64_tr_b16 v[44:45], v25 offset:0
    ds_read_b64_tr_b16 v[46:47], v25 offset:512
    ds_read_b128 v[32:35], v20 offset:0
    ds_read_b128 v[36:39], v20 offset:4096
    s_waitcnt lgkmcnt(0)
    v_mfma_f32_16x16x32_bf16 v[64:67], v[40:43], v[32:35], v[64:67]
    ds_read_b64_tr_b16 v[56:57], v24 offset:4096
    ds_read_b64_tr_b16 v[58:59], v24 offset:4608
    v_mfma_f32_16x16x32_bf16 v[68:71], v[40:43], v[36:39], v[68:71]
    ds_read_b64_tr_b16 v[60:61], v25 offset:4096
    ds_read_b64_tr_b16 v[62:63], v25 offset:4608
    v_mfma_f32_16x16x32_bf16 v[72:75], v[44:47], v[32:35], v[72:75]
    ds_read_b128 v[48:51], v21 offset:0
    ds_read_b128 v[52:55], v21 offset:4096
    v_mfma_f32_16x16x32_bf16 v[76:79], v[44:47], v[36:39], v[76:79]
    s_waitcnt lgkmcnt(0)
    v_mfma_f32_16x16x32_bf16 v[64:67], v[56:59], v[48:51], v[64:67]
    ds_read_b64_tr_b16 v[40:41], v24 offset:8192
    ds_read_b64_tr_b16 v[42:43], v24 offset:8704
    v_mfma_f32_16x16x32_bf16 v[68:71], v[56:59], v[52:55], v[68:71]
    ds_read_b64_tr_b16 v[44:45], v25 offset:8192
    ds_read_b64_tr_b16 v[46:47], v25 offset:8704
    v_mfma_f32_16x16x32_bf16 v[72:75], v[60:63], v[48:51], v[72:75]
    ds_read_b128 v[32:35], v22 offset:0
    ds_read_b128 v[36:39], v22 offset:4096
    v_mfma_f32_16x16x32_bf16 v[76:79], v[60:63], v[52:55], v[76:79]
    s_waitcnt lgkmcnt(0)
    v_mfma_f32_16x16x32_bf16 v[64:67], v[40:43], v[32:35], v[64:67]
    ds_read_b64_tr_b16 v[56:57], v24 offset:12288
    ds_read_b64_tr_b16 v[58:59], v24 offset:12800
    v_mfma_f32_16x16x32_bf16 v[68:71], v[40:43], v[36:39], v[68:71]
    ds_read_b64_tr_b16 v[60:61], v25 offset:12288
    ds_read_b64_tr_b16 v[62:63], v25 offset:12800
    v_mfma_f32_16x16x32_bf16 v[72:75], v[44:47], v[32:35], v[72:75]
    ds_read_b128 v[48:51], v23 offset:0
    ds_read_b128 v[52:55], v23 offset:4096
    v_mfma_f32_16x16x32_bf16 v[76:79], v[44:47], v[36:39], v[76:79]
    s_waitcnt lgkmcnt(0)
    s_waitcnt vmcnt(16)
    s_barrier
    s_add_u32 s34, s32, 0
    s_mov_b32 m0, s34
    s_add_u32 s35, s30, 1024
    buffer_load_dwordx4 v10, s[12:15], s35 offen lds
    s_add_u32 s34, s32, 1024
    s_mov_b32 m0, s34
    s_add_u32 s35, s30, 15360
    buffer_load_dwordx4 v11, s[12:15], s35 offen lds
    s_add_u32 s34, s32, 2048
    s_mov_b32 m0, s34
    s_add_u32 s35, s30, 29696
    buffer_load_dwordx4 v12, s[12:15], s35 offen lds
    s_add_u32 s34, s32, 3072
    s_mov_b32 m0, s34
    s_add_u32 s35, s30, 44032
    buffer_load_dwordx4 v13, s[12:15], s35 offen lds
    s_add_u32 s34, s33, 16384
    s_mov_b32 m0, s34
    s_add_u32 s35, s31, 524288
    buffer_load_dwordx4 v14, s[16:19], s35 offen lds
    s_add_u32 s34, s33, 17408
    s_mov_b32 m0, s34
    s_add_u32 s35, s31, 532480
    buffer_load_dwordx4 v15, s[16:19], s35 offen lds
    s_add_u32 s34, s33, 18432
    s_mov_b32 m0, s34
    s_add_u32 s35, s31, 540672
    buffer_load_dwordx4 v14, s[16:19], s35 offen lds
    s_add_u32 s34, s33, 19456
    s_mov_b32 m0, s34
    s_add_u32 s35, s31, 548864
    buffer_load_dwordx4 v15, s[16:19], s35 offen lds
    v_mfma_f32_16x16x32_bf16 v[64:67], v[56:59], v[48:51], v[64:67]
    ds_read_b64_tr_b16 v[40:41], v24 offset:32768
    ds_read_b64_tr_b16 v[42:43], v24 offset:33280
    v_mfma_f32_16x16x32_bf16 v[68:71], v[56:59], v[52:55], v[68:71]
    ds_read_b64_tr_b16 v[44:45], v25 offset:32768
    ds_read_b64_tr_b16 v[46:47], v25 offset:33280
    v_mfma_f32_16x16x32_bf16 v[72:75], v[60:63], v[48:51], v[72:75]
    ds_read_b128 v[32:35], v20 offset:32768
    ds_read_b128 v[36:39], v20 offset:36864
    v_mfma_f32_16x16x32_bf16 v[76:79], v[60:63], v[52:55], v[76:79]
    s_waitcnt lgkmcnt(0)
    v_mfma_f32_16x16x32_bf16 v[64:67], v[40:43], v[32:35], v[64:67]
    ds_read_b64_tr_b16 v[56:57], v24 offset:36864
    ds_read_b64_tr_b16 v[58:59], v24 offset:37376
    v_mfma_f32_16x16x32_bf16 v[68:71], v[40:43], v[36:39], v[68:71]
    ds_read_b64_tr_b16 v[60:61], v25 offset:36864
    ds_read_b64_tr_b16 v[62:63], v25 offset:37376
    v_mfma_f32_16x16x32_bf16 v[72:75], v[44:47], v[32:35], v[72:75]
    ds_read_b128 v[48:51], v21 offset:32768
    ds_read_b128 v[52:55], v21 offset:36864
    v_mfma_f32_16x16x32_bf16 v[76:79], v[44:47], v[36:39], v[76:79]
    s_waitcnt lgkmcnt(0)
    v_mfma_f32_16x16x32_bf16 v[64:67], v[56:59], v[48:51], v[64:67]
    ds_read_b64_tr_b16 v[40:41], v24 offset:40960
    ds_read_b64_tr_b16 v[42:43], v24 offset:41472
    v_mfma_f32_16x16x32_bf16 v[68:71], v[56:59], v[52:55], v[68:71]
    ds_read_b64_tr_b16 v[44:45], v25 offset:40960
    ds_read_b64_tr_b16 v[46:47], v25 offset:41472
    v_mfma_f32_16x16x32_bf16 v[72:75], v[60:63], v[48:51], v[72:75]
    ds_read_b128 v[32:35], v22 offset:32768
    ds_read_b128 v[36:39], v22 offset:36864
    v_mfma_f32_16x16x32_bf16 v[76:79], v[60:63], v[52:55], v[76:79]
    s_waitcnt lgkmcnt(0)
    v_mfma_f32_16x16x32_bf16 v[64:67], v[40:43], v[32:35], v[64:67]
    ds_read_b64_tr_b16 v[56:57], v24 offset:45056
    ds_read_b64_tr_b16 v[58:59], v24 offset:45568
    v_mfma_f32_16x16x32_bf16 v[68:71], v[40:43], v[36:39], v[68:71]
    ds_read_b64_tr_b16 v[60:61], v25 offset:45056
    ds_read_b64_tr_b16 v[62:63], v25 offset:45568
    v_mfma_f32_16x16x32_bf16 v[72:75], v[44:47], v[32:35], v[72:75]
    ds_read_b128 v[48:51], v23 offset:32768
    ds_read_b128 v[52:55], v23 offset:36864
    v_mfma_f32_16x16x32_bf16 v[76:79], v[44:47], v[36:39], v[76:79]
    s_waitcnt lgkmcnt(0)
    s_waitcnt vmcnt(16)
    s_barrier
    s_add_u32 s34, s32, 32768
    s_mov_b32 m0, s34
    s_add_u32 s35, s30, 1280
    buffer_load_dwordx4 v10, s[12:15], s35 offen lds
    s_add_u32 s34, s32, 33792
    s_mov_b32 m0, s34
    s_add_u32 s35, s30, 15616
    buffer_load_dwordx4 v11, s[12:15], s35 offen lds
    s_add_u32 s34, s32, 34816
    s_mov_b32 m0, s34
    s_add_u32 s35, s30, 29952
    buffer_load_dwordx4 v12, s[12:15], s35 offen lds
    s_add_u32 s34, s32, 35840
    s_mov_b32 m0, s34
    s_add_u32 s35, s30, 44288
    buffer_load_dwordx4 v13, s[12:15], s35 offen lds
    s_add_u32 s34, s33, 49152
    s_mov_b32 m0, s34
    s_add_u32 s35, s31, 655360
    buffer_load_dwordx4 v14, s[16:19], s35 offen lds
    s_add_u32 s34, s33, 50176
    s_mov_b32 m0, s34
    s_add_u32 s35, s31, 663552
    buffer_load_dwordx4 v15, s[16:19], s35 offen lds
    s_add_u32 s34, s33, 51200
    s_mov_b32 m0, s34
    s_add_u32 s35, s31, 671744
    buffer_load_dwordx4 v14, s[16:19], s35 offen lds
    s_add_u32 s34, s33, 52224
    s_mov_b32 m0, s34
    s_add_u32 s35, s31, 679936
    buffer_load_dwordx4 v15, s[16:19], s35 offen lds
    v_mfma_f32_16x16x32_bf16 v[64:67], v[56:59], v[48:51], v[64:67]
    ds_read_b64_tr_b16 v[40:41], v30 offset:0
    ds_read_b64_tr_b16 v[42:43], v30 offset:512
    v_mfma_f32_16x16x32_bf16 v[68:71], v[56:59], v[52:55], v[68:71]
    ds_read_b64_tr_b16 v[44:45], v31 offset:0
    ds_read_b64_tr_b16 v[46:47], v31 offset:512
    v_mfma_f32_16x16x32_bf16 v[72:75], v[60:63], v[48:51], v[72:75]
    ds_read_b128 v[32:35], v26 offset:0
    ds_read_b128 v[36:39], v26 offset:4096
    v_mfma_f32_16x16x32_bf16 v[76:79], v[60:63], v[52:55], v[76:79]
    s_waitcnt lgkmcnt(0)
    v_mfma_f32_16x16x32_bf16 v[64:67], v[40:43], v[32:35], v[64:67]
    ds_read_b64_tr_b16 v[56:57], v30 offset:4096
    ds_read_b64_tr_b16 v[58:59], v30 offset:4608
    v_mfma_f32_16x16x32_bf16 v[68:71], v[40:43], v[36:39], v[68:71]
    ds_read_b64_tr_b16 v[60:61], v31 offset:4096
    ds_read_b64_tr_b16 v[62:63], v31 offset:4608
    v_mfma_f32_16x16x32_bf16 v[72:75], v[44:47], v[32:35], v[72:75]
    ds_read_b128 v[48:51], v27 offset:0
    ds_read_b128 v[52:55], v27 offset:4096
    v_mfma_f32_16x16x32_bf16 v[76:79], v[44:47], v[36:39], v[76:79]
    s_waitcnt lgkmcnt(0)
    v_mfma_f32_16x16x32_bf16 v[64:67], v[56:59], v[48:51], v[64:67]
    ds_read_b64_tr_b16 v[40:41], v30 offset:8192
    ds_read_b64_tr_b16 v[42:43], v30 offset:8704
    v_mfma_f32_16x16x32_bf16 v[68:71], v[56:59], v[52:55], v[68:71]
    ds_read_b64_tr_b16 v[44:45], v31 offset:8192
    ds_read_b64_tr_b16 v[46:47], v31 offset:8704
    v_mfma_f32_16x16x32_bf16 v[72:75], v[60:63], v[48:51], v[72:75]
    ds_read_b128 v[32:35], v28 offset:0
    ds_read_b128 v[36:39], v28 offset:4096
    v_mfma_f32_16x16x32_bf16 v[76:79], v[60:63], v[52:55], v[76:79]
    s_waitcnt lgkmcnt(0)
    v_mfma_f32_16x16x32_bf16 v[64:67], v[40:43], v[32:35], v[64:67]
    ds_read_b64_tr_b16 v[56:57], v30 offset:12288
    ds_read_b64_tr_b16 v[58:59], v30 offset:12800
    v_mfma_f32_16x16x32_bf16 v[68:71], v[40:43], v[36:39], v[68:71]
    ds_read_b64_tr_b16 v[60:61], v31 offset:12288
    ds_read_b64_tr_b16 v[62:63], v31 offset:12800
    v_mfma_f32_16x16x32_bf16 v[72:75], v[44:47], v[32:35], v[72:75]
    ds_read_b128 v[48:51], v29 offset:0
    ds_read_b128 v[52:55], v29 offset:4096
    v_mfma_f32_16x16x32_bf16 v[76:79], v[44:47], v[36:39], v[76:79]
    s_waitcnt lgkmcnt(0)
    s_waitcnt vmcnt(16)
    s_barrier
    s_add_u32 s34, s32, 65536
    s_mov_b32 m0, s34
    s_add_u32 s35, s30, 1536
    buffer_load_dwordx4 v10, s[12:15], s35 offen lds
    s_add_u32 s34, s32, 66560
    s_mov_b32 m0, s34
    s_add_u32 s35, s30, 15872
    buffer_load_dwordx4 v11, s[12:15], s35 offen lds
    s_add_u32 s34, s32, 67584
    s_mov_b32 m0, s34
    s_add_u32 s35, s30, 30208
    buffer_load_dwordx4 v12, s[12:15], s35 offen lds
    s_add_u32 s34, s32, 68608
    s_mov_b32 m0, s34
    s_add_u32 s35, s30, 44544
    buffer_load_dwordx4 v13, s[12:15], s35 offen lds
    s_add_u32 s34, s33, 81920
    s_mov_b32 m0, s34
    s_add_u32 s35, s31, 786432
    buffer_load_dwordx4 v14, s[16:19], s35 offen lds
    s_add_u32 s34, s33, 82944
    s_mov_b32 m0, s34
    s_add_u32 s35, s31, 794624
    buffer_load_dwordx4 v15, s[16:19], s35 offen lds
    s_add_u32 s34, s33, 83968
    s_mov_b32 m0, s34
    s_add_u32 s35, s31, 802816
    buffer_load_dwordx4 v14, s[16:19], s35 offen lds
    s_add_u32 s34, s33, 84992
    s_mov_b32 m0, s34
    s_add_u32 s35, s31, 811008
    buffer_load_dwordx4 v15, s[16:19], s35 offen lds
    v_mfma_f32_16x16x32_bf16 v[64:67], v[56:59], v[48:51], v[64:67]
    ds_read_b64_tr_b16 v[40:41], v30 offset:32768
    ds_read_b64_tr_b16 v[42:43], v30 offset:33280
    v_mfma_f32_16x16x32_bf16 v[68:71], v[56:59], v[52:55], v[68:71]
    ds_read_b64_tr_b16 v[44:45], v31 offset:32768
    ds_read_b64_tr_b16 v[46:47], v31 offset:33280
    v_mfma_f32_16x16x32_bf16 v[72:75], v[60:63], v[48:51], v[72:75]
    ds_read_b128 v[32:35], v26 offset:32768
    ds_read_b128 v[36:39], v26 offset:36864
    v_mfma_f32_16x16x32_bf16 v[76:79], v[60:63], v[52:55], v[76:79]
    s_waitcnt lgkmcnt(0)
    v_mfma_f32_16x16x32_bf16 v[64:67], v[40:43], v[32:35], v[64:67]
    ds_read_b64_tr_b16 v[56:57], v30 offset:36864
    ds_read_b64_tr_b16 v[58:59], v30 offset:37376
    v_mfma_f32_16x16x32_bf16 v[68:71], v[40:43], v[36:39], v[68:71]
    ds_read_b64_tr_b16 v[60:61], v31 offset:36864
    ds_read_b64_tr_b16 v[62:63], v31 offset:37376
    v_mfma_f32_16x16x32_bf16 v[72:75], v[44:47], v[32:35], v[72:75]
    ds_read_b128 v[48:51], v27 offset:32768
    ds_read_b128 v[52:55], v27 offset:36864
    v_mfma_f32_16x16x32_bf16 v[76:79], v[44:47], v[36:39], v[76:79]
    s_waitcnt lgkmcnt(0)
    v_mfma_f32_16x16x32_bf16 v[64:67], v[56:59], v[48:51], v[64:67]
    ds_read_b64_tr_b16 v[40:41], v30 offset:40960
    ds_read_b64_tr_b16 v[42:43], v30 offset:41472
    v_mfma_f32_16x16x32_bf16 v[68:71], v[56:59], v[52:55], v[68:71]
    ds_read_b64_tr_b16 v[44:45], v31 offset:40960
    ds_read_b64_tr_b16 v[46:47], v31 offset:41472
    v_mfma_f32_16x16x32_bf16 v[72:75], v[60:63], v[48:51], v[72:75]
    ds_read_b128 v[32:35], v28 offset:32768
    ds_read_b128 v[36:39], v28 offset:36864
    v_mfma_f32_16x16x32_bf16 v[76:79], v[60:63], v[52:55], v[76:79]
    s_waitcnt lgkmcnt(0)
    v_mfma_f32_16x16x32_bf16 v[64:67], v[40:43], v[32:35], v[64:67]
    ds_read_b64_tr_b16 v[56:57], v30 offset:45056
    ds_read_b64_tr_b16 v[58:59], v30 offset:45568
    v_mfma_f32_16x16x32_bf16 v[68:71], v[40:43], v[36:39], v[68:71]
    ds_read_b64_tr_b16 v[60:61], v31 offset:45056
    ds_read_b64_tr_b16 v[62:63], v31 offset:45568
    v_mfma_f32_16x16x32_bf16 v[72:75], v[44:47], v[32:35], v[72:75]
    ds_read_b128 v[48:51], v29 offset:32768
    ds_read_b128 v[52:55], v29 offset:36864
    v_mfma_f32_16x16x32_bf16 v[76:79], v[44:47], v[36:39], v[76:79]
    s_waitcnt lgkmcnt(0)
    s_waitcnt vmcnt(16)
    s_barrier
    s_add_u32 s34, s32, 98304
    s_mov_b32 m0, s34
    s_add_u32 s35, s30, 1792
    buffer_load_dwordx4 v10, s[12:15], s35 offen lds
    s_add_u32 s34, s32, 99328
    s_mov_b32 m0, s34
    s_add_u32 s35, s30, 16128
    buffer_load_dwordx4 v11, s[12:15], s35 offen lds
    s_add_u32 s34, s32, 100352
    s_mov_b32 m0, s34
    s_add_u32 s35, s30, 30464
    buffer_load_dwordx4 v12, s[12:15], s35 offen lds
    s_add_u32 s34, s32, 101376
    s_mov_b32 m0, s34
    s_add_u32 s35, s30, 44800
    buffer_load_dwordx4 v13, s[12:15], s35 offen lds
    s_add_u32 s34, s33, 114688
    s_mov_b32 m0, s34
    s_add_u32 s35, s31, 917504
    buffer_load_dwordx4 v14, s[16:19], s35 offen lds
    s_add_u32 s34, s33, 115712
    s_mov_b32 m0, s34
    s_add_u32 s35, s31, 925696
    buffer_load_dwordx4 v15, s[16:19], s35 offen lds
    s_add_u32 s34, s33, 116736
    s_mov_b32 m0, s34
    s_add_u32 s35, s31, 933888
    buffer_load_dwordx4 v14, s[16:19], s35 offen lds
    s_add_u32 s34, s33, 117760
    s_mov_b32 m0, s34
    s_add_u32 s35, s31, 942080
    buffer_load_dwordx4 v15, s[16:19], s35 offen lds
    v_mfma_f32_16x16x32_bf16 v[64:67], v[56:59], v[48:51], v[64:67]
    ds_read_b64_tr_b16 v[40:41], v24 offset:0
    ds_read_b64_tr_b16 v[42:43], v24 offset:512
    v_mfma_f32_16x16x32_bf16 v[68:71], v[56:59], v[52:55], v[68:71]
    ds_read_b64_tr_b16 v[44:45], v25 offset:0
    ds_read_b64_tr_b16 v[46:47], v25 offset:512
    v_mfma_f32_16x16x32_bf16 v[72:75], v[60:63], v[48:51], v[72:75]
    ds_read_b128 v[32:35], v20 offset:0
    ds_read_b128 v[36:39], v20 offset:4096
    v_mfma_f32_16x16x32_bf16 v[76:79], v[60:63], v[52:55], v[76:79]
    s_waitcnt lgkmcnt(0)
    v_mfma_f32_16x16x32_bf16 v[64:67], v[40:43], v[32:35], v[64:67]
    ds_read_b64_tr_b16 v[56:57], v24 offset:4096
    ds_read_b64_tr_b16 v[58:59], v24 offset:4608
    v_mfma_f32_16x16x32_bf16 v[68:71], v[40:43], v[36:39], v[68:71]
    ds_read_b64_tr_b16 v[60:61], v25 offset:4096
    ds_read_b64_tr_b16 v[62:63], v25 offset:4608
    v_mfma_f32_16x16x32_bf16 v[72:75], v[44:47], v[32:35], v[72:75]
    ds_read_b128 v[48:51], v21 offset:0
    ds_read_b128 v[52:55], v21 offset:4096
    v_mfma_f32_16x16x32_bf16 v[76:79], v[44:47], v[36:39], v[76:79]
    s_waitcnt lgkmcnt(0)
    v_mfma_f32_16x16x32_bf16 v[64:67], v[56:59], v[48:51], v[64:67]
    ds_read_b64_tr_b16 v[40:41], v24 offset:8192
    ds_read_b64_tr_b16 v[42:43], v24 offset:8704
    v_mfma_f32_16x16x32_bf16 v[68:71], v[56:59], v[52:55], v[68:71]
    ds_read_b64_tr_b16 v[44:45], v25 offset:8192
    ds_read_b64_tr_b16 v[46:47], v25 offset:8704
    v_mfma_f32_16x16x32_bf16 v[72:75], v[60:63], v[48:51], v[72:75]
    ds_read_b128 v[32:35], v22 offset:0
    ds_read_b128 v[36:39], v22 offset:4096
    v_mfma_f32_16x16x32_bf16 v[76:79], v[60:63], v[52:55], v[76:79]
    s_waitcnt lgkmcnt(0)
    v_mfma_f32_16x16x32_bf16 v[64:67], v[40:43], v[32:35], v[64:67]
    ds_read_b64_tr_b16 v[56:57], v24 offset:12288
    ds_read_b64_tr_b16 v[58:59], v24 offset:12800
    v_mfma_f32_16x16x32_bf16 v[68:71], v[40:43], v[36:39], v[68:71]
    ds_read_b64_tr_b16 v[60:61], v25 offset:12288
    ds_read_b64_tr_b16 v[62:63], v25 offset:12800
    v_mfma_f32_16x16x32_bf16 v[72:75], v[44:47], v[32:35], v[72:75]
    ds_read_b128 v[48:51], v23 offset:0
    ds_read_b128 v[52:55], v23 offset:4096
    v_mfma_f32_16x16x32_bf16 v[76:79], v[44:47], v[36:39], v[76:79]
    s_waitcnt lgkmcnt(0)
    s_waitcnt vmcnt(16)
    s_barrier
    s_add_u32 s34, s32, 0
    s_mov_b32 m0, s34
    s_add_u32 s35, s30, 2048
    buffer_load_dwordx4 v10, s[12:15], s35 offen lds
    s_add_u32 s34, s32, 1024
    s_mov_b32 m0, s34
    s_add_u32 s35, s30, 16384
    buffer_load_dwordx4 v11, s[12:15], s35 offen lds
    s_add_u32 s34, s32, 2048
    s_mov_b32 m0, s34
    s_add_u32 s35, s30, 30720
    buffer_load_dwordx4 v12, s[12:15], s35 offen lds
    s_add_u32 s34, s32, 3072
    s_mov_b32 m0, s34
    s_add_u32 s35, s30, 45056
    buffer_load_dwordx4 v13, s[12:15], s35 offen lds
    s_add_u32 s34, s33, 16384
    s_mov_b32 m0, s34
    s_add_u32 s35, s31, 1048576
    buffer_load_dwordx4 v14, s[16:19], s35 offen lds
    s_add_u32 s34, s33, 17408
    s_mov_b32 m0, s34
    s_add_u32 s35, s31, 1056768
    buffer_load_dwordx4 v15, s[16:19], s35 offen lds
    s_add_u32 s34, s33, 18432
    s_mov_b32 m0, s34
    s_add_u32 s35, s31, 1064960
    buffer_load_dwordx4 v14, s[16:19], s35 offen lds
    s_add_u32 s34, s33, 19456
    s_mov_b32 m0, s34
    s_add_u32 s35, s31, 1073152
    buffer_load_dwordx4 v15, s[16:19], s35 offen lds
    v_mfma_f32_16x16x32_bf16 v[64:67], v[56:59], v[48:51], v[64:67]
    ds_read_b64_tr_b16 v[40:41], v24 offset:32768
    ds_read_b64_tr_b16 v[42:43], v24 offset:33280
    v_mfma_f32_16x16x32_bf16 v[68:71], v[56:59], v[52:55], v[68:71]
    ds_read_b64_tr_b16 v[44:45], v25 offset:32768
    ds_read_b64_tr_b16 v[46:47], v25 offset:33280
    v_mfma_f32_16x16x32_bf16 v[72:75], v[60:63], v[48:51], v[72:75]
    ds_read_b128 v[32:35], v20 offset:32768
    ds_read_b128 v[36:39], v20 offset:36864
    v_mfma_f32_16x16x32_bf16 v[76:79], v[60:63], v[52:55], v[76:79]
    s_waitcnt lgkmcnt(0)
    v_mfma_f32_16x16x32_bf16 v[64:67], v[40:43], v[32:35], v[64:67]
    ds_read_b64_tr_b16 v[56:57], v24 offset:36864
    ds_read_b64_tr_b16 v[58:59], v24 offset:37376
    v_mfma_f32_16x16x32_bf16 v[68:71], v[40:43], v[36:39], v[68:71]
    ds_read_b64_tr_b16 v[60:61], v25 offset:36864
    ds_read_b64_tr_b16 v[62:63], v25 offset:37376
    v_mfma_f32_16x16x32_bf16 v[72:75], v[44:47], v[32:35], v[72:75]
    ds_read_b128 v[48:51], v21 offset:32768
    ds_read_b128 v[52:55], v21 offset:36864
    v_mfma_f32_16x16x32_bf16 v[76:79], v[44:47], v[36:39], v[76:79]
    s_waitcnt lgkmcnt(0)
    v_mfma_f32_16x16x32_bf16 v[64:67], v[56:59], v[48:51], v[64:67]
    ds_read_b64_tr_b16 v[40:41], v24 offset:40960
    ds_read_b64_tr_b16 v[42:43], v24 offset:41472
    v_mfma_f32_16x16x32_bf16 v[68:71], v[56:59], v[52:55], v[68:71]
    ds_read_b64_tr_b16 v[44:45], v25 offset:40960
    ds_read_b64_tr_b16 v[46:47], v25 offset:41472
    v_mfma_f32_16x16x32_bf16 v[72:75], v[60:63], v[48:51], v[72:75]
    ds_read_b128 v[32:35], v22 offset:32768
    ds_read_b128 v[36:39], v22 offset:36864
    v_mfma_f32_16x16x32_bf16 v[76:79], v[60:63], v[52:55], v[76:79]
    s_waitcnt lgkmcnt(0)
    v_mfma_f32_16x16x32_bf16 v[64:67], v[40:43], v[32:35], v[64:67]
    ds_read_b64_tr_b16 v[56:57], v24 offset:45056
    ds_read_b64_tr_b16 v[58:59], v24 offset:45568
    v_mfma_f32_16x16x32_bf16 v[68:71], v[40:43], v[36:39], v[68:71]
    ds_read_b64_tr_b16 v[60:61], v25 offset:45056
    ds_read_b64_tr_b16 v[62:63], v25 offset:45568
    v_mfma_f32_16x16x32_bf16 v[72:75], v[44:47], v[32:35], v[72:75]
    ds_read_b128 v[48:51], v23 offset:32768
    ds_read_b128 v[52:55], v23 offset:36864
    v_mfma_f32_16x16x32_bf16 v[76:79], v[44:47], v[36:39], v[76:79]
    s_waitcnt lgkmcnt(0)
    s_waitcnt vmcnt(16)
    s_barrier
    s_add_u32 s34, s32, 32768
    s_mov_b32 m0, s34
    s_add_u32 s35, s30, 2304
    buffer_load_dwordx4 v10, s[12:15], s35 offen lds
    s_add_u32 s34, s32, 33792
    s_mov_b32 m0, s34
    s_add_u32 s35, s30, 16640
    buffer_load_dwordx4 v11, s[12:15], s35 offen lds
    s_add_u32 s34, s32, 34816
    s_mov_b32 m0, s34
    s_add_u32 s35, s30, 30976
    buffer_load_dwordx4 v12, s[12:15], s35 offen lds
    s_add_u32 s34, s32, 35840
    s_mov_b32 m0, s34
    s_add_u32 s35, s30, 45312
    buffer_load_dwordx4 v13, s[12:15], s35 offen lds
    s_add_u32 s34, s33, 49152
    s_mov_b32 m0, s34
    s_add_u32 s35, s31, 1179648
    buffer_load_dwordx4 v14, s[16:19], s35 offen lds
    s_add_u32 s34, s33, 50176
    s_mov_b32 m0, s34
    s_add_u32 s35, s31, 1187840
    buffer_load_dwordx4 v15, s[16:19], s35 offen lds
    s_add_u32 s34, s33, 51200
    s_mov_b32 m0, s34
    s_add_u32 s35, s31, 1196032
    buffer_load_dwordx4 v14, s[16:19], s35 offen lds
    s_add_u32 s34, s33, 52224
    s_mov_b32 m0, s34
    s_add_u32 s35, s31, 1204224
    buffer_load_dwordx4 v15, s[16:19], s35 offen lds
    v_mfma_f32_16x16x32_bf16 v[64:67], v[56:59], v[48:51], v[64:67]
    ds_read_b64_tr_b16 v[40:41], v30 offset:0
    ds_read_b64_tr_b16 v[42:43], v30 offset:512
    v_mfma_f32_16x16x32_bf16 v[68:71], v[56:59], v[52:55], v[68:71]
    ds_read_b64_tr_b16 v[44:45], v31 offset:0
    ds_read_b64_tr_b16 v[46:47], v31 offset:512
    v_mfma_f32_16x16x32_bf16 v[72:75], v[60:63], v[48:51], v[72:75]
    ds_read_b128 v[32:35], v26 offset:0
    ds_read_b128 v[36:39], v26 offset:4096
    v_mfma_f32_16x16x32_bf16 v[76:79], v[60:63], v[52:55], v[76:79]
    s_waitcnt lgkmcnt(0)
    v_mfma_f32_16x16x32_bf16 v[64:67], v[40:43], v[32:35], v[64:67]
    ds_read_b64_tr_b16 v[56:57], v30 offset:4096
    ds_read_b64_tr_b16 v[58:59], v30 offset:4608
    v_mfma_f32_16x16x32_bf16 v[68:71], v[40:43], v[36:39], v[68:71]
    ds_read_b64_tr_b16 v[60:61], v31 offset:4096
    ds_read_b64_tr_b16 v[62:63], v31 offset:4608
    v_mfma_f32_16x16x32_bf16 v[72:75], v[44:47], v[32:35], v[72:75]
    ds_read_b128 v[48:51], v27 offset:0
    ds_read_b128 v[52:55], v27 offset:4096
    v_mfma_f32_16x16x32_bf16 v[76:79], v[44:47], v[36:39], v[76:79]
    s_waitcnt lgkmcnt(0)
    v_mfma_f32_16x16x32_bf16 v[64:67], v[56:59], v[48:51], v[64:67]
    ds_read_b64_tr_b16 v[40:41], v30 offset:8192
    ds_read_b64_tr_b16 v[42:43], v30 offset:8704
    v_mfma_f32_16x16x32_bf16 v[68:71], v[56:59], v[52:55], v[68:71]
    ds_read_b64_tr_b16 v[44:45], v31 offset:8192
    ds_read_b64_tr_b16 v[46:47], v31 offset:8704
    v_mfma_f32_16x16x32_bf16 v[72:75], v[60:63], v[48:51], v[72:75]
    ds_read_b128 v[32:35], v28 offset:0
    ds_read_b128 v[36:39], v28 offset:4096
    v_mfma_f32_16x16x32_bf16 v[76:79], v[60:63], v[52:55], v[76:79]
    s_waitcnt lgkmcnt(0)
    v_mfma_f32_16x16x32_bf16 v[64:67], v[40:43], v[32:35], v[64:67]
    ds_read_b64_tr_b16 v[56:57], v30 offset:12288
    ds_read_b64_tr_b16 v[58:59], v30 offset:12800
    v_mfma_f32_16x16x32_bf16 v[68:71], v[40:43], v[36:39], v[68:71]
    ds_read_b64_tr_b16 v[60:61], v31 offset:12288
    ds_read_b64_tr_b16 v[62:63], v31 offset:12800
    v_mfma_f32_16x16x32_bf16 v[72:75], v[44:47], v[32:35], v[72:75]
    ds_read_b128 v[48:51], v29 offset:0
    ds_read_b128 v[52:55], v29 offset:4096
    v_mfma_f32_16x16x32_bf16 v[76:79], v[44:47], v[36:39], v[76:79]
    s_waitcnt lgkmcnt(0)
    s_waitcnt vmcnt(16)
    s_barrier
    s_add_u32 s34, s32, 65536
    s_mov_b32 m0, s34
    s_add_u32 s35, s30, 2560
    buffer_load_dwordx4 v10, s[12:15], s35 offen lds
    s_add_u32 s34, s32, 66560
    s_mov_b32 m0, s34
    s_add_u32 s35, s30, 16896
    buffer_load_dwordx4 v11, s[12:15], s35 offen lds
    s_add_u32 s34, s32, 67584
    s_mov_b32 m0, s34
    s_add_u32 s35, s30, 31232
    buffer_load_dwordx4 v12, s[12:15], s35 offen lds
    s_add_u32 s34, s32, 68608
    s_mov_b32 m0, s34
    s_add_u32 s35, s30, 45568
    buffer_load_dwordx4 v13, s[12:15], s35 offen lds
    s_add_u32 s34, s33, 81920
    s_mov_b32 m0, s34
    s_add_u32 s35, s31, 1310720
    buffer_load_dwordx4 v14, s[16:19], s35 offen lds
    s_add_u32 s34, s33, 82944
    s_mov_b32 m0, s34
    s_add_u32 s35, s31, 1318912
    buffer_load_dwordx4 v15, s[16:19], s35 offen lds
    s_add_u32 s34, s33, 83968
    s_mov_b32 m0, s34
    s_add_u32 s35, s31, 1327104
    buffer_load_dwordx4 v14, s[16:19], s35 offen lds
    s_add_u32 s34, s33, 84992
    s_mov_b32 m0, s34
    s_add_u32 s35, s31, 1335296
    buffer_load_dwordx4 v15, s[16:19], s35 offen lds
    v_mfma_f32_16x16x32_bf16 v[64:67], v[56:59], v[48:51], v[64:67]
    ds_read_b64_tr_b16 v[40:41], v30 offset:32768
    ds_read_b64_tr_b16 v[42:43], v30 offset:33280
    v_mfma_f32_16x16x32_bf16 v[68:71], v[56:59], v[52:55], v[68:71]
    ds_read_b64_tr_b16 v[44:45], v31 offset:32768
    ds_read_b64_tr_b16 v[46:47], v31 offset:33280
    v_mfma_f32_16x16x32_bf16 v[72:75], v[60:63], v[48:51], v[72:75]
    ds_read_b128 v[32:35], v26 offset:32768
    ds_read_b128 v[36:39], v26 offset:36864
    v_mfma_f32_16x16x32_bf16 v[76:79], v[60:63], v[52:55], v[76:79]
    s_waitcnt lgkmcnt(0)
    v_mfma_f32_16x16x32_bf16 v[64:67], v[40:43], v[32:35], v[64:67]
    ds_read_b64_tr_b16 v[56:57], v30 offset:36864
    ds_read_b64_tr_b16 v[58:59], v30 offset:37376
    v_mfma_f32_16x16x32_bf16 v[68:71], v[40:43], v[36:39], v[68:71]
    ds_read_b64_tr_b16 v[60:61], v31 offset:36864
    ds_read_b64_tr_b16 v[62:63], v31 offset:37376
    v_mfma_f32_16x16x32_bf16 v[72:75], v[44:47], v[32:35], v[72:75]
    ds_read_b128 v[48:51], v27 offset:32768
    ds_read_b128 v[52:55], v27 offset:36864
    v_mfma_f32_16x16x32_bf16 v[76:79], v[44:47], v[36:39], v[76:79]
    s_waitcnt lgkmcnt(0)
    v_mfma_f32_16x16x32_bf16 v[64:67], v[56:59], v[48:51], v[64:67]
    ds_read_b64_tr_b16 v[40:41], v30 offset:40960
    ds_read_b64_tr_b16 v[42:43], v30 offset:41472
    v_mfma_f32_16x16x32_bf16 v[68:71], v[56:59], v[52:55], v[68:71]
    ds_read_b64_tr_b16 v[44:45], v31 offset:40960
    ds_read_b64_tr_b16 v[46:47], v31 offset:41472
    v_mfma_f32_16x16x32_bf16 v[72:75], v[60:63], v[48:51], v[72:75]
    ds_read_b128 v[32:35], v28 offset:32768
    ds_read_b128 v[36:39], v28 offset:36864
    v_mfma_f32_16x16x32_bf16 v[76:79], v[60:63], v[52:55], v[76:79]
    s_waitcnt lgkmcnt(0)
    v_mfma_f32_16x16x32_bf16 v[64:67], v[40:43], v[32:35], v[64:67]
    ds_read_b64_tr_b16 v[56:57], v30 offset:45056
    ds_read_b64_tr_b16 v[58:59], v30 offset:45568
    v_mfma_f32_16x16x32_bf16 v[68:71], v[40:43], v[36:39], v[68:71]
    ds_read_b64_tr_b16 v[60:61], v31 offset:45056
    ds_read_b64_tr_b16 v[62:63], v31 offset:45568
    v_mfma_f32_16x16x32_bf16 v[72:75], v[44:47], v[32:35], v[72:75]
    ds_read_b128 v[48:51], v29 offset:32768
    ds_read_b128 v[52:55], v29 offset:36864
    v_mfma_f32_16x16x32_bf16 v[76:79], v[44:47], v[36:39], v[76:79]
    s_waitcnt lgkmcnt(0)
    s_waitcnt vmcnt(16)
    s_barrier
    s_add_u32 s34, s32, 98304
    s_mov_b32 m0, s34
    s_add_u32 s35, s30, 2816
    buffer_load_dwordx4 v10, s[12:15], s35 offen lds
    s_add_u32 s34, s32, 99328
    s_mov_b32 m0, s34
    s_add_u32 s35, s30, 17152
    buffer_load_dwordx4 v11, s[12:15], s35 offen lds
    s_add_u32 s34, s32, 100352
    s_mov_b32 m0, s34
    s_add_u32 s35, s30, 31488
    buffer_load_dwordx4 v12, s[12:15], s35 offen lds
    s_add_u32 s34, s32, 101376
    s_mov_b32 m0, s34
    s_add_u32 s35, s30, 45824
    buffer_load_dwordx4 v13, s[12:15], s35 offen lds
    s_add_u32 s34, s33, 114688
    s_mov_b32 m0, s34
    s_add_u32 s35, s31, 1441792
    buffer_load_dwordx4 v14, s[16:19], s35 offen lds
    s_add_u32 s34, s33, 115712
    s_mov_b32 m0, s34
    s_add_u32 s35, s31, 1449984
    buffer_load_dwordx4 v15, s[16:19], s35 offen lds
    s_add_u32 s34, s33, 116736
    s_mov_b32 m0, s34
    s_add_u32 s35, s31, 1458176
    buffer_load_dwordx4 v14, s[16:19], s35 offen lds
    s_add_u32 s34, s33, 117760
    s_mov_b32 m0, s34
    s_add_u32 s35, s31, 1466368
    buffer_load_dwordx4 v15, s[16:19], s35 offen lds
    v_mfma_f32_16x16x32_bf16 v[64:67], v[56:59], v[48:51], v[64:67]
    ds_read_b64_tr_b16 v[40:41], v24 offset:0
    ds_read_b64_tr_b16 v[42:43], v24 offset:512
    v_mfma_f32_16x16x32_bf16 v[68:71], v[56:59], v[52:55], v[68:71]
    ds_read_b64_tr_b16 v[44:45], v25 offset:0
    ds_read_b64_tr_b16 v[46:47], v25 offset:512
    v_mfma_f32_16x16x32_bf16 v[72:75], v[60:63], v[48:51], v[72:75]
    ds_read_b128 v[32:35], v20 offset:0
    ds_read_b128 v[36:39], v20 offset:4096
    v_mfma_f32_16x16x32_bf16 v[76:79], v[60:63], v[52:55], v[76:79]
    s_waitcnt lgkmcnt(0)
    v_mfma_f32_16x16x32_bf16 v[64:67], v[40:43], v[32:35], v[64:67]
    ds_read_b64_tr_b16 v[56:57], v24 offset:4096
    ds_read_b64_tr_b16 v[58:59], v24 offset:4608
    v_mfma_f32_16x16x32_bf16 v[68:71], v[40:43], v[36:39], v[68:71]
    ds_read_b64_tr_b16 v[60:61], v25 offset:4096
    ds_read_b64_tr_b16 v[62:63], v25 offset:4608
    v_mfma_f32_16x16x32_bf16 v[72:75], v[44:47], v[32:35], v[72:75]
    ds_read_b128 v[48:51], v21 offset:0
    ds_read_b128 v[52:55], v21 offset:4096
    v_mfma_f32_16x16x32_bf16 v[76:79], v[44:47], v[36:39], v[76:79]
    s_waitcnt lgkmcnt(0)
    v_mfma_f32_16x16x32_bf16 v[64:67], v[56:59], v[48:51], v[64:67]
    ds_read_b64_tr_b16 v[40:41], v24 offset:8192
    ds_read_b64_tr_b16 v[42:43], v24 offset:8704
    v_mfma_f32_16x16x32_bf16 v[68:71], v[56:59], v[52:55], v[68:71]
    ds_read_b64_tr_b16 v[44:45], v25 offset:8192
    ds_read_b64_tr_b16 v[46:47], v25 offset:8704
    v_mfma_f32_16x16x32_bf16 v[72:75], v[60:63], v[48:51], v[72:75]
    ds_read_b128 v[32:35], v22 offset:0
    ds_read_b128 v[36:39], v22 offset:4096
    v_mfma_f32_16x16x32_bf16 v[76:79], v[60:63], v[52:55], v[76:79]
    s_waitcnt lgkmcnt(0)
    v_mfma_f32_16x16x32_bf16 v[64:67], v[40:43], v[32:35], v[64:67]
    ds_read_b64_tr_b16 v[56:57], v24 offset:12288
    ds_read_b64_tr_b16 v[58:59], v24 offset:12800
    v_mfma_f32_16x16x32_bf16 v[68:71], v[40:43], v[36:39], v[68:71]
    ds_read_b64_tr_b16 v[60:61], v25 offset:12288
    ds_read_b64_tr_b16 v[62:63], v25 offset:12800
    v_mfma_f32_16x16x32_bf16 v[72:75], v[44:47], v[32:35], v[72:75]
    ds_read_b128 v[48:51], v23 offset:0
    ds_read_b128 v[52:55], v23 offset:4096
    v_mfma_f32_16x16x32_bf16 v[76:79], v[44:47], v[36:39], v[76:79]
    s_waitcnt lgkmcnt(0)
    s_waitcnt vmcnt(16)
    s_barrier
    s_add_u32 s34, s32, 0
    s_mov_b32 m0, s34
    s_add_u32 s35, s30, 3072
    buffer_load_dwordx4 v10, s[12:15], s35 offen lds
    s_add_u32 s34, s32, 1024
    s_mov_b32 m0, s34
    s_add_u32 s35, s30, 17408
    buffer_load_dwordx4 v11, s[12:15], s35 offen lds
    s_add_u32 s34, s32, 2048
    s_mov_b32 m0, s34
    s_add_u32 s35, s30, 31744
    buffer_load_dwordx4 v12, s[12:15], s35 offen lds
    s_add_u32 s34, s32, 3072
    s_mov_b32 m0, s34
    s_add_u32 s35, s30, 46080
    buffer_load_dwordx4 v13, s[12:15], s35 offen lds
    s_add_u32 s34, s33, 16384
    s_mov_b32 m0, s34
    s_add_u32 s35, s31, 1572864
    buffer_load_dwordx4 v14, s[16:19], s35 offen lds
    s_add_u32 s34, s33, 17408
    s_mov_b32 m0, s34
    s_add_u32 s35, s31, 1581056
    buffer_load_dwordx4 v15, s[16:19], s35 offen lds
    s_add_u32 s34, s33, 18432
    s_mov_b32 m0, s34
    s_add_u32 s35, s31, 1589248
    buffer_load_dwordx4 v14, s[16:19], s35 offen lds
    s_add_u32 s34, s33, 19456
    s_mov_b32 m0, s34
    s_add_u32 s35, s31, 1597440
    buffer_load_dwordx4 v15, s[16:19], s35 offen lds
    v_mfma_f32_16x16x32_bf16 v[64:67], v[56:59], v[48:51], v[64:67]
    ds_read_b64_tr_b16 v[40:41], v24 offset:32768
    ds_read_b64_tr_b16 v[42:43], v24 offset:33280
    v_mfma_f32_16x16x32_bf16 v[68:71], v[56:59], v[52:55], v[68:71]
    ds_read_b64_tr_b16 v[44:45], v25 offset:32768
    ds_read_b64_tr_b16 v[46:47], v25 offset:33280
    v_mfma_f32_16x16x32_bf16 v[72:75], v[60:63], v[48:51], v[72:75]
    ds_read_b128 v[32:35], v20 offset:32768
    ds_read_b128 v[36:39], v20 offset:36864
    v_mfma_f32_16x16x32_bf16 v[76:79], v[60:63], v[52:55], v[76:79]
    s_waitcnt lgkmcnt(0)
    v_mfma_f32_16x16x32_bf16 v[64:67], v[40:43], v[32:35], v[64:67]
    ds_read_b64_tr_b16 v[56:57], v24 offset:36864
    ds_read_b64_tr_b16 v[58:59], v24 offset:37376
    v_mfma_f32_16x16x32_bf16 v[68:71], v[40:43], v[36:39], v[68:71]
    ds_read_b64_tr_b16 v[60:61], v25 offset:36864
    ds_read_b64_tr_b16 v[62:63], v25 offset:37376
    v_mfma_f32_16x16x32_bf16 v[72:75], v[44:47], v[32:35], v[72:75]
    ds_read_b128 v[48:51], v21 offset:32768
    ds_read_b128 v[52:55], v21 offset:36864
    v_mfma_f32_16x16x32_bf16 v[76:79], v[44:47], v[36:39], v[76:79]
    s_waitcnt lgkmcnt(0)
    v_mfma_f32_16x16x32_bf16 v[64:67], v[56:59], v[48:51], v[64:67]
    ds_read_b64_tr_b16 v[40:41], v24 offset:40960
    ds_read_b64_tr_b16 v[42:43], v24 offset:41472
    v_mfma_f32_16x16x32_bf16 v[68:71], v[56:59], v[52:55], v[68:71]
    ds_read_b64_tr_b16 v[44:45], v25 offset:40960
    ds_read_b64_tr_b16 v[46:47], v25 offset:41472
    v_mfma_f32_16x16x32_bf16 v[72:75], v[60:63], v[48:51], v[72:75]
    ds_read_b128 v[32:35], v22 offset:32768
    ds_read_b128 v[36:39], v22 offset:36864
    v_mfma_f32_16x16x32_bf16 v[76:79], v[60:63], v[52:55], v[76:79]
    s_waitcnt lgkmcnt(0)
    v_mfma_f32_16x16x32_bf16 v[64:67], v[40:43], v[32:35], v[64:67]
    ds_read_b64_tr_b16 v[56:57], v24 offset:45056
    ds_read_b64_tr_b16 v[58:59], v24 offset:45568
    v_mfma_f32_16x16x32_bf16 v[68:71], v[40:43], v[36:39], v[68:71]
    ds_read_b64_tr_b16 v[60:61], v25 offset:45056
    ds_read_b64_tr_b16 v[62:63], v25 offset:45568
    v_mfma_f32_16x16x32_bf16 v[72:75], v[44:47], v[32:35], v[72:75]
    ds_read_b128 v[48:51], v23 offset:32768
    ds_read_b128 v[52:55], v23 offset:36864
    v_mfma_f32_16x16x32_bf16 v[76:79], v[44:47], v[36:39], v[76:79]
    s_waitcnt lgkmcnt(0)
    s_waitcnt vmcnt(16)
    s_barrier
    s_add_u32 s34, s32, 32768
    s_mov_b32 m0, s34
    s_add_u32 s35, s30, 3328
    buffer_load_dwordx4 v10, s[12:15], s35 offen lds
    s_add_u32 s34, s32, 33792
    s_mov_b32 m0, s34
    s_add_u32 s35, s30, 17664
    buffer_load_dwordx4 v11, s[12:15], s35 offen lds
    s_add_u32 s34, s32, 34816
    s_mov_b32 m0, s34
    s_add_u32 s35, s30, 32000
    buffer_load_dwordx4 v12, s[12:15], s35 offen lds
    s_add_u32 s34, s32, 35840
    s_mov_b32 m0, s34
    s_add_u32 s35, s30, 46336
    buffer_load_dwordx4 v13, s[12:15], s35 offen lds
    s_add_u32 s34, s33, 49152
    s_mov_b32 m0, s34
    s_add_u32 s35, s31, 1703936
    buffer_load_dwordx4 v14, s[16:19], s35 offen lds
    s_add_u32 s34, s33, 50176
    s_mov_b32 m0, s34
    s_add_u32 s35, s31, 1712128
    buffer_load_dwordx4 v15, s[16:19], s35 offen lds
    s_add_u32 s34, s33, 51200
    s_mov_b32 m0, s34
    s_add_u32 s35, s31, 1720320
    buffer_load_dwordx4 v14, s[16:19], s35 offen lds
    s_add_u32 s34, s33, 52224
    s_mov_b32 m0, s34
    s_add_u32 s35, s31, 1728512
    buffer_load_dwordx4 v15, s[16:19], s35 offen lds
    v_mfma_f32_16x16x32_bf16 v[64:67], v[56:59], v[48:51], v[64:67]
    ds_read_b64_tr_b16 v[40:41], v30 offset:0
    ds_read_b64_tr_b16 v[42:43], v30 offset:512
    v_mfma_f32_16x16x32_bf16 v[68:71], v[56:59], v[52:55], v[68:71]
    ds_read_b64_tr_b16 v[44:45], v31 offset:0
    ds_read_b64_tr_b16 v[46:47], v31 offset:512
    v_mfma_f32_16x16x32_bf16 v[72:75], v[60:63], v[48:51], v[72:75]
    ds_read_b128 v[32:35], v26 offset:0
    ds_read_b128 v[36:39], v26 offset:4096
    v_mfma_f32_16x16x32_bf16 v[76:79], v[60:63], v[52:55], v[76:79]
    s_waitcnt lgkmcnt(0)
    v_mfma_f32_16x16x32_bf16 v[64:67], v[40:43], v[32:35], v[64:67]
    ds_read_b64_tr_b16 v[56:57], v30 offset:4096
    ds_read_b64_tr_b16 v[58:59], v30 offset:4608
    v_mfma_f32_16x16x32_bf16 v[68:71], v[40:43], v[36:39], v[68:71]
    ds_read_b64_tr_b16 v[60:61], v31 offset:4096
    ds_read_b64_tr_b16 v[62:63], v31 offset:4608
    v_mfma_f32_16x16x32_bf16 v[72:75], v[44:47], v[32:35], v[72:75]
    ds_read_b128 v[48:51], v27 offset:0
    ds_read_b128 v[52:55], v27 offset:4096
    v_mfma_f32_16x16x32_bf16 v[76:79], v[44:47], v[36:39], v[76:79]
    s_waitcnt lgkmcnt(0)
    v_mfma_f32_16x16x32_bf16 v[64:67], v[56:59], v[48:51], v[64:67]
    ds_read_b64_tr_b16 v[40:41], v30 offset:8192
    ds_read_b64_tr_b16 v[42:43], v30 offset:8704
    v_mfma_f32_16x16x32_bf16 v[68:71], v[56:59], v[52:55], v[68:71]
    ds_read_b64_tr_b16 v[44:45], v31 offset:8192
    ds_read_b64_tr_b16 v[46:47], v31 offset:8704
    v_mfma_f32_16x16x32_bf16 v[72:75], v[60:63], v[48:51], v[72:75]
    ds_read_b128 v[32:35], v28 offset:0
    ds_read_b128 v[36:39], v28 offset:4096
    v_mfma_f32_16x16x32_bf16 v[76:79], v[60:63], v[52:55], v[76:79]
    s_waitcnt lgkmcnt(0)
    v_mfma_f32_16x16x32_bf16 v[64:67], v[40:43], v[32:35], v[64:67]
    ds_read_b64_tr_b16 v[56:57], v30 offset:12288
    ds_read_b64_tr_b16 v[58:59], v30 offset:12800
    v_mfma_f32_16x16x32_bf16 v[68:71], v[40:43], v[36:39], v[68:71]
    ds_read_b64_tr_b16 v[60:61], v31 offset:12288
    ds_read_b64_tr_b16 v[62:63], v31 offset:12800
    v_mfma_f32_16x16x32_bf16 v[72:75], v[44:47], v[32:35], v[72:75]
    ds_read_b128 v[48:51], v29 offset:0
    ds_read_b128 v[52:55], v29 offset:4096
    v_mfma_f32_16x16x32_bf16 v[76:79], v[44:47], v[36:39], v[76:79]
    s_waitcnt lgkmcnt(0)
    s_waitcnt vmcnt(16)
    s_barrier
    v_mfma_f32_16x16x32_bf16 v[64:67], v[56:59], v[48:51], v[64:67]
    ds_read_b64_tr_b16 v[40:41], v30 offset:32768
    ds_read_b64_tr_b16 v[42:43], v30 offset:33280
    v_mfma_f32_16x16x32_bf16 v[68:71], v[56:59], v[52:55], v[68:71]
    ds_read_b64_tr_b16 v[44:45], v31 offset:32768
    ds_read_b64_tr_b16 v[46:47], v31 offset:33280
    v_mfma_f32_16x16x32_bf16 v[72:75], v[60:63], v[48:51], v[72:75]
    ds_read_b128 v[32:35], v26 offset:32768
    ds_read_b128 v[36:39], v26 offset:36864
    v_mfma_f32_16x16x32_bf16 v[76:79], v[60:63], v[52:55], v[76:79]
    s_waitcnt lgkmcnt(0)
    v_mfma_f32_16x16x32_bf16 v[64:67], v[40:43], v[32:35], v[64:67]
    ds_read_b64_tr_b16 v[56:57], v30 offset:36864
    ds_read_b64_tr_b16 v[58:59], v30 offset:37376
    v_mfma_f32_16x16x32_bf16 v[68:71], v[40:43], v[36:39], v[68:71]
    ds_read_b64_tr_b16 v[60:61], v31 offset:36864
    ds_read_b64_tr_b16 v[62:63], v31 offset:37376
    v_mfma_f32_16x16x32_bf16 v[72:75], v[44:47], v[32:35], v[72:75]
    ds_read_b128 v[48:51], v27 offset:32768
    ds_read_b128 v[52:55], v27 offset:36864
    v_mfma_f32_16x16x32_bf16 v[76:79], v[44:47], v[36:39], v[76:79]
    s_waitcnt lgkmcnt(0)
    v_mfma_f32_16x16x32_bf16 v[64:67], v[56:59], v[48:51], v[64:67]
    ds_read_b64_tr_b16 v[40:41], v30 offset:40960
    ds_read_b64_tr_b16 v[42:43], v30 offset:41472
    v_mfma_f32_16x16x32_bf16 v[68:71], v[56:59], v[52:55], v[68:71]
    ds_read_b64_tr_b16 v[44:45], v31 offset:40960
    ds_read_b64_tr_b16 v[46:47], v31 offset:41472
    v_mfma_f32_16x16x32_bf16 v[72:75], v[60:63], v[48:51], v[72:75]
    ds_read_b128 v[32:35], v28 offset:32768
    ds_read_b128 v[36:39], v28 offset:36864
    v_mfma_f32_16x16x32_bf16 v[76:79], v[60:63], v[52:55], v[76:79]
    s_waitcnt lgkmcnt(0)
    v_mfma_f32_16x16x32_bf16 v[64:67], v[40:43], v[32:35], v[64:67]
    ds_read_b64_tr_b16 v[56:57], v30 offset:45056
    ds_read_b64_tr_b16 v[58:59], v30 offset:45568
    v_mfma_f32_16x16x32_bf16 v[68:71], v[40:43], v[36:39], v[68:71]
    ds_read_b64_tr_b16 v[60:61], v31 offset:45056
    ds_read_b64_tr_b16 v[62:63], v31 offset:45568
    v_mfma_f32_16x16x32_bf16 v[72:75], v[44:47], v[32:35], v[72:75]
    ds_read_b128 v[48:51], v29 offset:32768
    ds_read_b128 v[52:55], v29 offset:36864
    v_mfma_f32_16x16x32_bf16 v[76:79], v[44:47], v[36:39], v[76:79]
    s_waitcnt lgkmcnt(0)
    s_waitcnt vmcnt(8)
    s_barrier
    v_mfma_f32_16x16x32_bf16 v[64:67], v[56:59], v[48:51], v[64:67]
    ds_read_b64_tr_b16 v[40:41], v24 offset:0
    ds_read_b64_tr_b16 v[42:43], v24 offset:512
    v_mfma_f32_16x16x32_bf16 v[68:71], v[56:59], v[52:55], v[68:71]
    ds_read_b64_tr_b16 v[44:45], v25 offset:0
    ds_read_b64_tr_b16 v[46:47], v25 offset:512
    v_mfma_f32_16x16x32_bf16 v[72:75], v[60:63], v[48:51], v[72:75]
    ds_read_b128 v[32:35], v20 offset:0
    ds_read_b128 v[36:39], v20 offset:4096
    v_mfma_f32_16x16x32_bf16 v[76:79], v[60:63], v[52:55], v[76:79]
    s_waitcnt lgkmcnt(0)
    v_mfma_f32_16x16x32_bf16 v[64:67], v[40:43], v[32:35], v[64:67]
    ds_read_b64_tr_b16 v[56:57], v24 offset:4096
    ds_read_b64_tr_b16 v[58:59], v24 offset:4608
    v_mfma_f32_16x16x32_bf16 v[68:71], v[40:43], v[36:39], v[68:71]
    ds_read_b64_tr_b16 v[60:61], v25 offset:4096
    ds_read_b64_tr_b16 v[62:63], v25 offset:4608
    v_mfma_f32_16x16x32_bf16 v[72:75], v[44:47], v[32:35], v[72:75]
    ds_read_b128 v[48:51], v21 offset:0
    ds_read_b128 v[52:55], v21 offset:4096
    v_mfma_f32_16x16x32_bf16 v[76:79], v[44:47], v[36:39], v[76:79]
    s_waitcnt lgkmcnt(0)
    v_mfma_f32_16x16x32_bf16 v[64:67], v[56:59], v[48:51], v[64:67]
    ds_read_b64_tr_b16 v[40:41], v24 offset:8192
    ds_read_b64_tr_b16 v[42:43], v24 offset:8704
    v_mfma_f32_16x16x32_bf16 v[68:71], v[56:59], v[52:55], v[68:71]
    ds_read_b64_tr_b16 v[44:45], v25 offset:8192
    ds_read_b64_tr_b16 v[46:47], v25 offset:8704
    v_mfma_f32_16x16x32_bf16 v[72:75], v[60:63], v[48:51], v[72:75]
    ds_read_b128 v[32:35], v22 offset:0
    ds_read_b128 v[36:39], v22 offset:4096
    v_mfma_f32_16x16x32_bf16 v[76:79], v[60:63], v[52:55], v[76:79]
    s_waitcnt lgkmcnt(0)
    v_mfma_f32_16x16x32_bf16 v[64:67], v[40:43], v[32:35], v[64:67]
    ds_read_b64_tr_b16 v[56:57], v24 offset:12288
    ds_read_b64_tr_b16 v[58:59], v24 offset:12800
    v_mfma_f32_16x16x32_bf16 v[68:71], v[40:43], v[36:39], v[68:71]
    ds_read_b64_tr_b16 v[60:61], v25 offset:12288
    ds_read_b64_tr_b16 v[62:63], v25 offset:12800
    v_mfma_f32_16x16x32_bf16 v[72:75], v[44:47], v[32:35], v[72:75]
    ds_read_b128 v[48:51], v23 offset:0
    ds_read_b128 v[52:55], v23 offset:4096
    v_mfma_f32_16x16x32_bf16 v[76:79], v[44:47], v[36:39], v[76:79]
    s_waitcnt lgkmcnt(0)
    s_waitcnt vmcnt(0)
    s_barrier
    v_mfma_f32_16x16x32_bf16 v[64:67], v[56:59], v[48:51], v[64:67]
    ds_read_b64_tr_b16 v[40:41], v24 offset:32768
    ds_read_b64_tr_b16 v[42:43], v24 offset:33280
    v_mfma_f32_16x16x32_bf16 v[68:71], v[56:59], v[52:55], v[68:71]
    ds_read_b64_tr_b16 v[44:45], v25 offset:32768
    ds_read_b64_tr_b16 v[46:47], v25 offset:33280
    v_mfma_f32_16x16x32_bf16 v[72:75], v[60:63], v[48:51], v[72:75]
    ds_read_b128 v[32:35], v20 offset:32768
    ds_read_b128 v[36:39], v20 offset:36864
    v_mfma_f32_16x16x32_bf16 v[76:79], v[60:63], v[52:55], v[76:79]
    s_waitcnt lgkmcnt(0)
    v_mfma_f32_16x16x32_bf16 v[64:67], v[40:43], v[32:35], v[64:67]
    ds_read_b64_tr_b16 v[56:57], v24 offset:36864
    ds_read_b64_tr_b16 v[58:59], v24 offset:37376
    v_mfma_f32_16x16x32_bf16 v[68:71], v[40:43], v[36:39], v[68:71]
    ds_read_b64_tr_b16 v[60:61], v25 offset:36864
    ds_read_b64_tr_b16 v[62:63], v25 offset:37376
    v_mfma_f32_16x16x32_bf16 v[72:75], v[44:47], v[32:35], v[72:75]
    ds_read_b128 v[48:51], v21 offset:32768
    ds_read_b128 v[52:55], v21 offset:36864
    v_mfma_f32_16x16x32_bf16 v[76:79], v[44:47], v[36:39], v[76:79]
    s_waitcnt lgkmcnt(0)
    v_mfma_f32_16x16x32_bf16 v[64:67], v[56:59], v[48:51], v[64:67]
    ds_read_b64_tr_b16 v[40:41], v24 offset:40960
    ds_read_b64_tr_b16 v[42:43], v24 offset:41472
    v_mfma_f32_16x16x32_bf16 v[68:71], v[56:59], v[52:55], v[68:71]
    ds_read_b64_tr_b16 v[44:45], v25 offset:40960
    ds_read_b64_tr_b16 v[46:47], v25 offset:41472
    v_mfma_f32_16x16x32_bf16 v[72:75], v[60:63], v[48:51], v[72:75]
    ds_read_b128 v[32:35], v22 offset:32768
    ds_read_b128 v[36:39], v22 offset:36864
    v_mfma_f32_16x16x32_bf16 v[76:79], v[60:63], v[52:55], v[76:79]
    s_waitcnt lgkmcnt(0)
    v_mfma_f32_16x16x32_bf16 v[64:67], v[40:43], v[32:35], v[64:67]
    ds_read_b64_tr_b16 v[56:57], v24 offset:45056
    ds_read_b64_tr_b16 v[58:59], v24 offset:45568
    v_mfma_f32_16x16x32_bf16 v[68:71], v[40:43], v[36:39], v[68:71]
    ds_read_b64_tr_b16 v[60:61], v25 offset:45056
    ds_read_b64_tr_b16 v[62:63], v25 offset:45568
    v_mfma_f32_16x16x32_bf16 v[72:75], v[44:47], v[32:35], v[72:75]
    ds_read_b128 v[48:51], v23 offset:32768
    ds_read_b128 v[52:55], v23 offset:36864
    v_mfma_f32_16x16x32_bf16 v[76:79], v[44:47], v[36:39], v[76:79]
    s_waitcnt lgkmcnt(0)
    v_mfma_f32_16x16x32_bf16 v[64:67], v[56:59], v[48:51], v[64:67]
    v_mfma_f32_16x16x32_bf16 v[68:71], v[56:59], v[52:55], v[68:71]
    v_mfma_f32_16x16x32_bf16 v[72:75], v[60:63], v[48:51], v[72:75]
    v_mfma_f32_16x16x32_bf16 v[76:79], v[60:63], v[52:55], v[76:79]
    s_nop 7
    s_nop 7
    s_lshl_b32 s34, s24, 6
    s_lshl_b32 s35, s28, 5
    s_add_u32 s34, s34, s35
    s_lshl_b32 s35, s25, 6
    s_lshl_b32 s36, s29, 5
    s_add_u32 s35, s35, s36
    v_add_u32 v90, s34, v6
    v_lshlrev_b32 v91, 2, v5
    v_add_u32 v91, s35, v91
    v_lshlrev_b32 v92, 10, v90
    v_lshl_add_u32 v92, v91, 1, v92
    v_lshlrev_b32 v93, 2, v91
    s_mov_b32 s40, s4
    s_mov_b32 s41, s5
    s_mov_b32 s42, 2097152
    s_mov_b32 s43, 0x00020000
    s_add_u32 s36, s8, 3145728
    s_addc_u32 s37, s9, 0
    s_mov_b32 s38, 2097152
    s_mov_b32 s39, 0x00020000

    v_add_u32 v94, 0x4000, v92
    buffer_load_dwordx2 v[100:101], v92, s[36:39], 0 offen offset:0
    buffer_load_dwordx2 v[102:103], v94, s[36:39], 0 offen offset:0
    s_mov_b32 s44, 10240
    buffer_load_dwordx4 v[120:123], v93, s[20:23], s44 offen offset:0
    buffer_load_dwordx2 v[104:105], v92, s[36:39], 0 offen offset:32
    buffer_load_dwordx2 v[106:107], v94, s[36:39], 0 offen offset:32
    s_mov_b32 s44, 10240
    buffer_load_dwordx4 v[124:127], v93, s[20:23], s44 offen offset:64
    s_waitcnt vmcnt(0)
    v_lshlrev_b32 v110, 16, v100
    v_and_b32 v111, 0xffff0000, v100
    v_lshlrev_b32 v112, 16, v101
    v_and_b32 v113, 0xffff0000, v101
    v_fmac_f32 v110, v64, v120
    v_fmac_f32 v111, v65, v121
    v_fmac_f32 v112, v66, v122
    v_fmac_f32 v113, v67, v123
    v_cvt_pk_bf16_f32 v114, v110, v111
    v_cvt_pk_bf16_f32 v115, v112, v113
    buffer_store_dwordx2 v[114:115], v92, s[40:43], 0 offen offset:0
    v_lshlrev_b32 v110, 16, v102
    v_and_b32 v111, 0xffff0000, v102
    v_lshlrev_b32 v112, 16, v103
    v_and_b32 v113, 0xffff0000, v103
    v_fmac_f32 v110, v68, v120
    v_fmac_f32 v111, v69, v121
    v_fmac_f32 v112, v70, v122
    v_fmac_f32 v113, v71, v123
    v_cvt_pk_bf16_f32 v114, v110, v111
    v_cvt_pk_bf16_f32 v115, v112, v113
    buffer_store_dwordx2 v[114:115], v94, s[40:43], 0 offen offset:0
    v_lshlrev_b32 v110, 16, v104
    v_and_b32 v111, 0xffff0000, v104
    v_lshlrev_b32 v112, 16, v105
    v_and_b32 v113, 0xffff0000, v105
    v_fmac_f32 v110, v72, v124
    v_fmac_f32 v111, v73, v125
    v_fmac_f32 v112, v74, v126
    v_fmac_f32 v113, v75, v127
    v_cvt_pk_bf16_f32 v114, v110, v111
    v_cvt_pk_bf16_f32 v115, v112, v113
    buffer_store_dwordx2 v[114:115], v92, s[40:43], 0 offen offset:32
    v_lshlrev_b32 v110, 16, v106
    v_and_b32 v111, 0xffff0000, v106
    v_lshlrev_b32 v112, 16, v107
    v_and_b32 v113, 0xffff0000, v107
    v_fmac_f32 v110, v76, v124
    v_fmac_f32 v111, v77, v125
    v_fmac_f32 v112, v78, v126
    v_fmac_f32 v113, v79, v127
    v_cvt_pk_bf16_f32 v114, v110, v111
    v_cvt_pk_bf16_f32 v115, v112, v113
    buffer_store_dwordx2 v[114:115], v94, s[40:43], 0 offen offset:32
K4_END:
    s_endpgm

.section .rodata,"a"
.p2align 6
.amdhsa_kernel k0_kernel
  .amdhsa_next_free_vgpr 80
  .amdhsa_next_free_sgpr 40
  .amdhsa_accum_offset 80
  .amdhsa_group_segment_fixed_size 0
  .amdhsa_kernarg_size 96
  .amdhsa_user_sgpr_count 2
  .amdhsa_user_sgpr_kernarg_segment_ptr 1
  .amdhsa_system_sgpr_workgroup_id_x 1
.end_amdhsa_kernel
.p2align 6
.amdhsa_kernel k1_kernel
  .amdhsa_next_free_vgpr 240
  .amdhsa_next_free_sgpr 96
  .amdhsa_accum_offset 240
  .amdhsa_group_segment_fixed_size 0
  .amdhsa_kernarg_size 96
  .amdhsa_user_sgpr_count 2
  .amdhsa_user_sgpr_kernarg_segment_ptr 1
  .amdhsa_system_sgpr_workgroup_id_x 1
.end_amdhsa_kernel
.p2align 6
.amdhsa_kernel k2_kernel
  .amdhsa_next_free_vgpr 240
  .amdhsa_next_free_sgpr 100
  .amdhsa_accum_offset 240
  .amdhsa_group_segment_fixed_size 0
  .amdhsa_kernarg_size 96
  .amdhsa_user_sgpr_count 2
  .amdhsa_user_sgpr_kernarg_segment_ptr 1
  .amdhsa_system_sgpr_workgroup_id_x 1
.end_amdhsa_kernel
.p2align 6
.amdhsa_kernel k3_kernel
  .amdhsa_next_free_vgpr 340
  .amdhsa_next_free_sgpr 100
  .amdhsa_accum_offset 228
  .amdhsa_group_segment_fixed_size 0
  .amdhsa_kernarg_size 96
  .amdhsa_user_sgpr_count 2
  .amdhsa_user_sgpr_kernarg_segment_ptr 1
  .amdhsa_system_sgpr_workgroup_id_x 1
.end_amdhsa_kernel
.p2align 6
.amdhsa_kernel k4_kernel
  .amdhsa_next_free_vgpr 240
  .amdhsa_next_free_sgpr 100
  .amdhsa_accum_offset 240
  .amdhsa_group_segment_fixed_size 0
  .amdhsa_kernarg_size 96
  .amdhsa_user_sgpr_count 2
  .amdhsa_user_sgpr_kernarg_segment_ptr 1
  .amdhsa_system_sgpr_workgroup_id_x 1
.end_amdhsa_kernel
```
